```python
import torch

def _softmax(x, axis=-1):
    return torch.softmax(x, dim=axis)
def _gelu(x):
    return torch.nn.functional.gelu(x, approximate="tanh")
def _silu(x):
    return torch.nn.functional.silu(x)
def _sigmoid(x):
    return torch.sigmoid(x)
def _layernorm(x, axis=-1, eps=1e-5):
    m = x.mean(dim=axis, keepdim=True)
    v = x.var(dim=axis, keepdim=True, unbiased=False)
    return (x - m) / torch.sqrt(v + eps)
def _scatter_add(tgt, idx, src, axis=0):
    return tgt.clone().index_add_(axis, idx, src)
def _segment_sum(src, seg, n):
    out = torch.zeros((n,) + src.shape[1:], dtype=src.dtype)
    return out.index_add_(0, seg, src)
def _pad(x, pw):
    flat = tuple(v for pair in reversed(pw) for v in pair)
    return torch.nn.functional.pad(x, flat)

kernel_name = 'interleave_layers__ssm_conv_h3__dense_activation_gelu__prompt'

def setup_inputs():

    _w = (lambda a: (lambda t: t.to(torch.bfloat16) if t.is_floating_point() else t)(torch.as_tensor(a)))
    def _A_setup():
        B, S, D = 1, 2048, 512
        ks = 4
        return {
            "q": _w((lambda *s: torch.randn(*s, dtype=torch.bfloat16) * 0.05)(B, S, D)),
            "k": _w((lambda *s: torch.randn(*s, dtype=torch.bfloat16) * 0.2)(B, S, D)),
            "v": _w((lambda *s: torch.randn(*s, dtype=torch.bfloat16) * 0.2)(B, S, D)),
            "shift_k": _w((lambda *s: torch.randn(*s, dtype=torch.bfloat16) * 0.2)(D, ks) * 0.5),
            "ssm_k": _w((lambda *s: torch.randn(*s, dtype=torch.bfloat16) * 0.4)(D, S) * (1.0 / S ** 0.5)),
            "ssm_D": _w((lambda *s: torch.randn(*s, dtype=torch.bfloat16) * 0.2)(D)),
        }
    _A_in = _A_setup()

    def _B_setup():
        B, S, D, F = 1, 2048, 512, 1376
        return {
            "x": _w((lambda *s: torch.randn(*s, dtype=torch.bfloat16) * 0.05)(B, S, D)),
            "w1": _w((lambda *s: torch.randn(*s, dtype=torch.bfloat16) * 0.4)(D, F) * (D ** -0.5)),
            "b1": _w((lambda *s: torch.randn(*s, dtype=torch.bfloat16) * 12.8)(F) * 0.01),
            "w2": _w((lambda *s: torch.randn(*s, dtype=torch.bfloat16) * 0.1)(F, D) * (F ** -0.5)),
            "b2": _w((lambda *s: torch.randn(*s, dtype=torch.bfloat16) * 0.8)(D) * 0.01),
        }
    _B_in = _B_setup()

    return {
        "A_q": _A_in["q"],
        "A_k": _A_in["k"],
        "A_v": _A_in["v"],
        "A_shift_k": _A_in["shift_k"],
        "A_ssm_k": _A_in["ssm_k"],
        "A_ssm_D": _A_in["ssm_D"],
        "B_x": _B_in["x"],
        "B_w1": _B_in["w1"],
        "B_b1": _B_in["b1"],
        "B_w2": _B_in["w2"],
        "B_b2": _B_in["b2"],
    }

def reference(A_q, A_k, A_v, A_shift_k, A_ssm_k, A_ssm_D, B_x, B_w1, B_b1, B_w2, B_b2):
    def _A_ref(q, k, v, shift_k, ssm_k, ssm_D):
        B, S, D = q.shape
        ks = shift_k.shape[-1]
        k_pad = _pad(k, ((0, 0), (ks - 1, 0), (0, 0)))
        k_shift = torch.zeros_like(k)
        for t in range(ks):
            k_shift = k_shift + k_pad[:, t:t + S, :] * shift_k[:, ks - 1 - t][None, None, :]
        kv = k_shift * v
        L = 2 * S
        kv_pad = _pad(kv, ((0, 0), (0, S), (0, 0)))
        kf_pad = _pad(ssm_k, ((0, 0), (0, S)))
        kv_f = (lambda x, axes=(-2,-1): torch.fft.rfft2(x.float(), dim=axes))(kv_pad[:, None, :, :], axes=(1, 2))
        kf_f = (lambda x, axes=(-2,-1): torch.fft.rfft2(x.float(), dim=axes))(kf_pad[:, None, :], axes=(1, 2))
        kf_f = (lambda x, *d: x.permute(*d))(kf_f, 1, 2, 0)
        y_f = kv_f * kf_f[None, :, :, :]
        y = (lambda x, s, axes=(-2,-1): torch.fft.irfft2(x, s=s, dim=axes).to(torch.bfloat16))(y_f, (1, L), axes=(1, 2))[:, 0, :S, :]
        y = y + kv * ssm_D[None, None, :]
        return q * y

    def _B_ref(x, w1, b1, w2, b2):
        h = torch.einsum("bsd,df->bsf", x, w1) + b1
        h = _gelu(h)
        return torch.einsum("bsf,fd->bsd", h, w2) + b2

    x = A_q
    x = x + _A_ref(_layernorm(x, axis=-1), A_k, A_v, A_shift_k, A_ssm_k, A_ssm_D)
    x = x + _B_ref(_layernorm(x, axis=-1), B_w1, B_b1, B_w2, B_b2)
    x = x + _A_ref(_layernorm(x, axis=-1), A_k, A_v, A_shift_k, A_ssm_k, A_ssm_D)
    x = x + _B_ref(_layernorm(x, axis=-1), B_w1, B_b1, B_w2, B_b2)
    return x
```

```asm
; @launch grid=(256,1,1) block=(256,1,1) lds=163840
.amdgcn_target "amdgcn-amd-amdhsa--gfx950"
.text
.globl interleave_layers__ssm_conv_h3__dense_activation_gelu__prompt_kernel
.p2align 8
.type interleave_layers__ssm_conv_h3__dense_activation_gelu__prompt_kernel,@function
interleave_layers__ssm_conv_h3__dense_activation_gelu__prompt_kernel:
 s_cmp_ge_u32 s2, 256
 s_cbranch_scc1 Lend
 s_load_dwordx16 s[16:31], s[0:1], 0
 s_load_dwordx4 s[40:43], s[0:1], 96
 s_load_dwordx8 s[32:39], s[0:1], 64
 s_getpc_b64 s[92:93]
Lpc:
 s_lshr_b32 s4, s2, 3
 s_lshl_b32 s4, s4, 11
 v_lshrrev_b32_e64 v2, 4, v0
 v_lshl_add_u32 v2, v2, 7, s4
 v_min_u32 v2, Lslow-Lpc, v2
 global_load_dword a172, v2, s[92:93]
 s_and_b32 s4, s2, 7
 s_lshr_b32 s5, s2, 3
 s_lshl_b32 s14, s5, 16
 s_lshl_b32 s15, s4, 7
 s_add_u32 s14, s14, s15
 v_lshrrev_b32 v7, 3, v0
 v_and_b32 v8, 7, v0
 v_lshlrev_b32 v5, 11, v7
 v_lshl_add_u32 v5, v8, 4, v5
 v_add_u32_e64 v5, s14, v5
 v_add_u32 v6, 0x400, v5
 v_add_u32 v4, 0xfffffc00, v5
 v_add_u32 v3, 0xfffff800, v5
 v_add_u32 v9, 0xfffff400, v5
 s_lshl_b32 s15, s4, 9
 v_and_b32 v10, 31, v0
 v_lshl_add_u32 v10, v10, 4, s15
 s_mov_b32 s46, 0x200000
 s_mov_b32 s47, 0x20000
 s_mov_b32 s50, 0x200000
 s_mov_b32 s51, 0x20000
 s_mov_b32 s54, 4096
 s_mov_b32 s55, 0x20000
 v_lshrrev_b32 v11, 6, v0
 s_waitcnt lgkmcnt(0)
 s_mov_b32 s52, s22
 s_mov_b32 s53, s23
 buffer_load_dwordx4 v[40:43], v10, s[52:55], 0 offen
 s_mov_b32 s44, s18
 s_mov_b32 s45, s19
 buffer_load_dwordx4 v[12:15], v9, s[44:47], 0 offen
 buffer_load_dwordx4 v[16:19], v3, s[44:47], 0 offen
 buffer_load_dwordx4 v[20:23], v4, s[44:47], 0 offen
 buffer_load_dwordx4 v[24:27], v5, s[44:47], 0 offen
 buffer_load_dwordx4 v[28:31], v6, s[44:47], 0 offen
 s_mov_b32 s48, s20
 s_mov_b32 s49, s21
 buffer_load_dwordx4 v[32:35], v5, s[48:51], 0 offen
 buffer_load_dwordx4 v[36:39], v6, s[48:51], 0 offen
 s_add_u32 s42, s42, 239075328
 s_addc_u32 s43, s43, 0
 s_load_dword s7, s[42:43], 0
 s_mov_b64 s[28:29], s[92:93]
 v_readfirstlane_b32 s3, v11
 s_getreg_b32 s11, hwreg(HW_REG_XCC_ID, 0, 3)
 v_and_b32 v1, 63, v0
 s_lshl_b32 s6, s4, 5
 s_add_u32 s6, s6, s5
 s_and_b32 s9, s5, 7
 s_lshr_b32 s10, s6, 3
 v_lshlrev_b32 v139, 4, v1
 v_mul_u32_u24 v11, 1056, v8
 v_lshlrev_b32 v7, 2, v7
 v_sub_u32 v11, v11, v7
 v_add_u32 v11, 76924, v11
 v_lshlrev_b32_e64 v154, 6, v8
 s_mov_b32 s60, s42
 s_mov_b32 s61, s43
 s_mov_b32 s62, 0x1c00000
 s_mov_b32 s63, 0x20000
 s_lshl_b32 s14, s6, 13
 s_lshr_b32 s15, s3, 1
 s_mul_i32 s99, s15, 33280
 s_lshl_b32 s15, s15, 12
 s_add_u32 s14, s14, s15
 s_add_u32 s56, s24, s14
 s_addc_u32 s57, s25, 0
 s_mov_b32 s58, 4096
 s_mov_b32 s59, 0x20000
 s_and_b32 s15, s3, 1
 s_lshl_b32 s15, s15, 11
 v_add_u32 v6, s15, v139
 v_add_u32 v7, -16, v6
 v_add_u32 v8, 1008, v6
 s_lshl_b32 s14, s6, 14
 s_lshl_b32 s15, s3, 12
 s_add_u32 s14, s14, s15
 s_add_u32 s86, s14, 8388608
 v_and_b32 v9, 31, v1
 v_lshlrev_b32 v9, 7, v9
 v_and_b32 v144, 15, v1
 v_lshrrev_b32_e64 v145, 4, v1
 v_and_b32 v146, 31, v1
 v_lshrrev_b32_e64 v147, 5, v1
 s_mul_i32 s14, s3, 15360
 s_add_u32 s84, s14, 102400
 s_lshl_b32 s14, s3, 9
 s_add_u32 s14, s14, 89600
 v_lshl_add_u32 v156, v146, 4, s14
 v_add_u32_e64 v154, s14, v154
 s_mov_b32 s96, 0x05040100
 s_mov_b32 s97, 0x07060302
 s_mov_b32 s98, 0xffff0000
 s_lshl_b32 s14, s4, 19
 s_sub_u32 s15, 31, s5
 s_lshl_b32 s15, s15, 8
 s_add_u32 s14, s14, s15
 s_add_u32 s87, s14, 8388608
 s_lshl_b32 s14, s3, 4
 v_add_u32 v149, s14, v145
 v_mul_u32_u24 v152, 132, v149
 v_lshl_add_u32 v152, v144, 3, v152
 v_add_u32 v152, 76800, v152
 v_lshlrev_b32_e64 v149, 13, v149
 v_lshl_add_u32 v153, v144, 4, v149
 s_mov_b32 s68, s34
 s_mov_b32 s69, s35
 s_mov_b32 s70, 0x158000
 s_mov_b32 s71, 0x20000
 s_mov_b32 s64, s30
 s_mov_b32 s65, s31
 s_mov_b32 s66, 0x158000
 s_mov_b32 s67, 0x20000
 s_and_b32 s12, s10, 3
 s_mul_i32 s15, s3, 22016
 s_mov_b32 s14, s12
 s_mul_i32 s14, s14, 352256
 s_add_u32 s31, s14, s15
 s_mul_i32 s0, s3, 3072
 s_mul_i32 s14, s9, 352
 s_mul_i32 s88, s12, 3
 s_movk_i32 s94, 0xaab
 s_and_b32 s15, s3, 1
 s_lshl_b32 s15, s15, 1
 v_mov_b32 v151, 0x7fffffff
 v_mov_b32 v157, 2752
 v_mul_u32_u24 v149, s94, v1
 v_lshrrev_b32_e64 v149, 16, v149
 v_mul_i32_i24 v150, -24, v149
 v_add_u32 v148, v1, v150
 v_lshrrev_b32 v150, 1, v148
 v_bfe_u32 v155, v149, 1, 1
 v_or_b32 v155, s15, v155
 v_xor_b32 v150, v150, v155
 v_cmp_gt_u32 s[90:91], 11, v150
 v_add_u32 v150, s88, v150
 v_add_u32 v155, -11, v150
 v_min_u32 v150, v150, v155
 v_and_b32 v148, 1, v148
 v_lshl_add_u32 v148, v148, 4, s14
 buffer_load_dword a172, v9, s[60:63], s86 offen sc1
 v_lshl_add_u32 v148, v150, 5, v148
 v_cmp_gt_i32 vcc, 2752, v148
 v_mad_u32_u24 v149, v149, v157, v148
 s_and_b64 vcc, vcc, s[90:91]
 v_cndmask_b32 v88, v151, v149, vcc
 v_add_u32 v148, 64, v1
 s_sub_u32 s14, s14, 1024
 v_mul_u32_u24 v149, s94, v148
 v_lshrrev_b32_e64 v149, 16, v149
 v_mul_i32_i24 v150, -24, v149
 v_add_u32 v148, v148, v150
 v_lshrrev_b32 v150, 1, v148
 v_bfe_u32 v155, v149, 1, 1
 v_or_b32 v155, s15, v155
 v_xor_b32 v150, v150, v155
 v_cmp_gt_u32 s[90:91], 11, v150
 v_add_u32 v150, s88, v150
 v_add_u32 v155, -11, v150
 v_min_u32 v150, v150, v155
 v_and_b32 v148, 1, v148
 v_lshl_add_u32 v148, v148, 4, s14
 v_lshl_add_u32 v148, v150, 5, v148
 v_cmp_gt_i32 vcc, 1728, v148
 v_mad_u32_u24 v149, v149, v157, v148
 s_and_b64 vcc, vcc, s[90:91]
 v_cndmask_b32 v89, v151, v149, vcc
 v_add_u32 v148, 128, v1
 s_sub_u32 s14, s14, 1024
 v_mul_u32_u24 v149, s94, v148
 v_lshrrev_b32 v149, 16, v149
 v_mul_i32_i24 v150, -24, v149
 v_add_u32 v148, v148, v150
 v_lshrrev_b32 v150, 1, v148
 v_bfe_u32 v155, v149, 1, 1
 v_or_b32 v155, s15, v155
 v_xor_b32 v150, v150, v155
 v_cmp_gt_u32 s[90:91], 11, v150
 v_add_u32 v150, s88, v150
 v_add_u32 v155, -11, v150
 v_min_u32 v150, v150, v155
 v_and_b32 v148, 1, v148
 v_lshl_add_u32 v148, v148, 4, s14
 v_lshl_add_u32 v148, v150, 5, v148
 v_cmp_gt_i32 vcc, 704, v148
 v_mad_u32_u24 v149, v149, v157, v148
 s_and_b64 vcc, vcc, s[90:91]
 v_cndmask_b32 v90, v151, v149, vcc
 v_and_b32_e64 v148, 7, v1
 v_mul_u32_u24 v108, 4160, v148
 v_bfe_u32 v148, v1, 3, 1
 v_add_u32 v148, v148, v145
 v_lshl_add_u32 v108, v148, 4, v108
 s_and_b32 s15, s3, 1
 s_lshl_b32 s15, s15, 8
 s_add_u32 s12, s99, s15
 v_add_u32_e64 v108, s12, v108
 s_lshr_b32 s14, s3, 1
 s_mul_i32 s14, s14, 4608
 s_add_u32 s12, s14, s15
 s_add_u32 s12, s12, 68064
 v_lshlrev_b32_e64 v109, 4, v145
 buffer_load_dwordx4 v[56:59], v7, s[56:59], 0 offen
 buffer_load_dwordx4 v[60:63], v6, s[56:59], 0 offen
 buffer_load_dwordx4 v[64:67], v8, s[56:59], 0 offen
 buffer_load_dwordx4 v[68:71], v6, s[56:59], 0 offen offset:1024
 v_lshlrev_b32 v148, 5, v144
 v_sub_u32 v109, v109, v148
 v_add_u32 v109, s12, v109
 s_lshl_b32 s15, s15, 3
 s_add_u32 s14, s14, s15
 s_add_u32 s14, s14, 67584
 v_lshl_add_u32 v114, v1, 3, s14
 v_mov_b32 v113, 87296
 v_lshl_add_u32 v115, s3, 2, v113
 s_waitcnt vmcnt(12)
 ds_write_b128 v156, v[40:43]
 ds_read_b128 v[40:43], v154 offset:0
 ds_read_b128 v[44:47], v154 offset:16
 ds_read_b128 v[48:51], v154 offset:32
 ds_read_b128 v[52:55], v154 offset:48
 s_add_u32 s14, s99, 16
 v_add_u32 v6, s14, v6
 v_and_b32_e64 v3, 7, v1
 v_mul_u32_u24 v3, 4160, v3
 v_add_u32 v3, s99, v3
 s_lshr_b32 s14, s3, 1
 s_mul_i32 s14, s14, 4608
 s_add_u32 s14, s14, 71680
 v_lshl_add_u32 v7, v146, 4, s14
 v_mov_b32 v200, 0
 v_mov_b32 v201, 0
 v_mov_b32_e64 v202, 0
 v_mov_b32_e64 v203, 0
 ds_write_b128 v3, v[200:203]
 ds_write_b128 v7, v[200:203]
 s_waitcnt lgkmcnt(0)
 s_add_u32 s7, s7, 8
 s_and_b32 s7, s7, -8
 s_or_b32 s8, s7, s11
 v_mov_b32_e64 v143, s7
 s_waitcnt vmcnt(10)
 v_perm_b32 v156, v12, v16, s96
 s_waitcnt vmcnt(9)
 v_perm_b32 v157, v16, v20, s96
 s_waitcnt vmcnt(8)
 v_perm_b32 v158, v20, v24, s96
 s_waitcnt vmcnt(7)
 v_perm_b32 v159, v24, v28, s96
 v_perm_b32 v160, v12, v16, s97
 v_perm_b32 v161, v16, v20, s97
 v_perm_b32 v162, v20, v24, s97
 v_perm_b32 v163, v24, v28, s97
 v_dot2_f32_bf16 v164, v156, v41, 0
 v_dot2_f32_bf16 v165, v157, v41, 0
 v_dot2_f32_bf16 v164, v158, v40, v164
 v_dot2_f32_bf16 v165, v159, v40, v165
 v_dot2_f32_bf16 v166, v160, v43, 0
 v_dot2_f32_bf16 v167, v161, v43, 0
 v_dot2_f32_bf16 v166, v162, v42, v166
 v_dot2_f32_bf16 v167, v163, v42, v167
 s_waitcnt vmcnt(6)
 v_lshlrev_b32 v168, 16, v32
 s_waitcnt vmcnt(5)
 v_lshlrev_b32 v169, 16, v36
 v_and_b32 v170, s98, v32
 v_and_b32 v171, s98, v36
 v_pk_mul_f32 v[164:165], v[164:165], v[168:169]
 v_pk_mul_f32 v[166:167], v[166:167], v[170:171]
 v_cvt_pk_bf16_f32 v172, v165, v164
 v_cvt_pk_bf16_f32 v173, v167, v166
 ds_write_b32 v11, v172 offset:0
 ds_write_b32 v11, v173 offset:132
 v_perm_b32 v156, v13, v17, s96
 v_perm_b32 v157, v17, v21, s96
 v_perm_b32 v158, v21, v25, s96
 v_perm_b32 v159, v25, v29, s96
 v_perm_b32 v160, v13, v17, s97
 v_perm_b32 v161, v17, v21, s97
 v_perm_b32 v162, v21, v25, s97
 v_perm_b32 v163, v25, v29, s97
 v_dot2_f32_bf16 v164, v156, v45, 0
 v_dot2_f32_bf16 v165, v157, v45, 0
 v_dot2_f32_bf16 v164, v158, v44, v164
 v_dot2_f32_bf16 v165, v159, v44, v165
 v_dot2_f32_bf16 v166, v160, v47, 0
 v_dot2_f32_bf16 v167, v161, v47, 0
 v_dot2_f32_bf16 v166, v162, v46, v166
 v_dot2_f32_bf16 v167, v163, v46, v167
 v_lshlrev_b32 v168, 16, v33
 v_lshlrev_b32 v169, 16, v37
 v_and_b32 v170, s98, v33
 v_and_b32 v171, s98, v37
 v_pk_mul_f32 v[164:165], v[164:165], v[168:169]
 v_pk_mul_f32 v[166:167], v[166:167], v[170:171]
 v_cvt_pk_bf16_f32 v172, v165, v164
 v_cvt_pk_bf16_f32 v173, v167, v166
 ds_write_b32 v11, v172 offset:264
 ds_write_b32 v11, v173 offset:396
 v_perm_b32 v156, v14, v18, s96
 v_perm_b32 v157, v18, v22, s96
 v_perm_b32 v158, v22, v26, s96
 v_perm_b32 v159, v26, v30, s96
 v_perm_b32 v160, v14, v18, s97
 v_perm_b32 v161, v18, v22, s97
 v_perm_b32 v162, v22, v26, s97
 v_perm_b32 v163, v26, v30, s97
 v_dot2_f32_bf16 v164, v156, v49, 0
 v_dot2_f32_bf16 v165, v157, v49, 0
 v_dot2_f32_bf16 v164, v158, v48, v164
 v_dot2_f32_bf16 v165, v159, v48, v165
 v_dot2_f32_bf16 v166, v160, v51, 0
 v_dot2_f32_bf16 v167, v161, v51, 0
 v_dot2_f32_bf16 v166, v162, v50, v166
 v_dot2_f32_bf16 v167, v163, v50, v167
 v_lshlrev_b32 v168, 16, v34
 v_lshlrev_b32 v169, 16, v38
 v_and_b32 v170, s98, v34
 v_and_b32 v171, s98, v38
 v_pk_mul_f32 v[164:165], v[164:165], v[168:169]
 v_pk_mul_f32 v[166:167], v[166:167], v[170:171]
 v_cvt_pk_bf16_f32 v172, v165, v164
 v_cvt_pk_bf16_f32 v173, v167, v166
 ds_write_b32 v11, v172 offset:528
 ds_write_b32 v11, v173 offset:660
 v_perm_b32 v156, v15, v19, s96
 v_perm_b32 v157, v19, v23, s96
 v_perm_b32 v158, v23, v27, s96
 v_perm_b32 v159, v27, v31, s96
 v_perm_b32 v160, v15, v19, s97
 v_perm_b32 v161, v19, v23, s97
 v_perm_b32 v162, v23, v27, s97
 v_perm_b32 v163, v27, v31, s97
 v_dot2_f32_bf16 v164, v156, v53, 0
 v_dot2_f32_bf16 v165, v157, v53, 0
 v_dot2_f32_bf16 v164, v158, v52, v164
 v_dot2_f32_bf16 v165, v159, v52, v165
 v_dot2_f32_bf16 v166, v160, v55, 0
 v_dot2_f32_bf16 v167, v161, v55, 0
 v_dot2_f32_bf16 v166, v162, v54, v166
 v_dot2_f32_bf16 v167, v163, v54, v167
 v_lshlrev_b32 v168, 16, v35
 v_lshlrev_b32 v169, 16, v39
 v_and_b32 v170, s98, v35
 v_and_b32 v171, s98, v39
 v_pk_mul_f32 v[164:165], v[164:165], v[168:169]
 v_pk_mul_f32 v[166:167], v[166:167], v[170:171]
 v_cvt_pk_bf16_f32 v172, v165, v164
 v_cvt_pk_bf16_f32 v173, v167, v166
 ds_write_b32 v11, v172 offset:792
 ds_write_b32 v11, v173 offset:924
 v_mov_b32 v13, s8
 v_mov_b32 v15, s8
 v_mov_b32 v17, s8
 v_mov_b32 v19, s8
 v_mov_b32 v21, s8
 v_mov_b32 v23, s8
 v_mov_b32 v25, s8
 v_mov_b32 v27, s8
 s_waitcnt lgkmcnt(0)
 s_barrier
 ds_read_b32 v12, v152 offset:0
 ds_read_b32 v14, v152 offset:4
 ds_read_b32 v16, v152 offset:528
 ds_read_b32 v18, v152 offset:532
 ds_read_b32 v20, v152 offset:1056
 ds_read_b32 v22, v152 offset:1060
 ds_read_b32 v24, v152 offset:1584
 ds_read_b32 v26, v152 offset:1588
 s_mov_b32 s88, s87
 s_waitcnt lgkmcnt(6)
 buffer_store_dwordx4 v[12:15], v153, s[60:63], s88 offen
 s_add_u32 s88, s88, 0x8000
 s_waitcnt lgkmcnt(4)
 buffer_store_dwordx4 v[16:19], v153, s[60:63], s88 offen
 s_add_u32 s88, s88, 0x8000
 s_waitcnt lgkmcnt(2)
 buffer_store_dwordx4 v[20:23], v153, s[60:63], s88 offen
 s_add_u32 s88, s88, 0x8000
 s_waitcnt lgkmcnt(0)
 buffer_store_dwordx4 v[24:27], v153, s[60:63], s88 offen
 buffer_load_dwordx4 v[72:75], v139, s[60:63], s86 offen offset:0 sc1
 buffer_load_dwordx4 v[76:79], v139, s[60:63], s86 offen offset:1024 sc1
 buffer_load_dwordx4 v[80:83], v139, s[60:63], s86 offen offset:2048 sc1
 buffer_load_dwordx4 v[84:87], v139, s[60:63], s86 offen offset:3072 sc1
 v_mov_b32 v200, -1
 v_mov_b32 v201, -1
 v_mov_b32 v202, -1
 v_mov_b32_e64 v203, -1
 v_lshrrev_b32_e64 v111, 4, v0
 v_lshlrev_b32_e64 v111, 16, v111
 v_lshl_add_u32 v111, v144, 4, v111
 s_lshl_b32 s14, s6, 8
 s_add_u32 s14, s14, 6291456
 s_add_u32 s15, s14, 0x100000
 s_mov_b32 s72, s16
 s_mov_b32 s73, s17
 s_mov_b32 s74, 0x200000
 s_mov_b32 s75, 0x20000
 s_lshl_b32 s12, s6, 13
 s_lshl_b32 s100, s3, 10
 s_add_u32 s12, s12, s100
 s_add_u32 s100, s12, 0x1000
 buffer_load_dwordx4 v[100:103], v139, s[72:75], s12 offen
 buffer_load_dwordx4 v[104:107], v139, s[72:75], s100 offen
 s_mov_b32 s48, s26
 s_mov_b32 s49, s27
 s_mov_b32 s50, 0x400
 s_mov_b32 s51, 0x20000
 s_lshl_b32 s12, s6, 2
 buffer_load_dword v36, off, s[48:51], s12
 s_waitcnt vmcnt(13)
 ds_write_b128 v6, v[58:61] offset:12480
 ds_write_b128 v6, v[60:63] offset:29120
 v_alignbit_b32 v162, v57, v56, 16
 v_alignbit_b32 v163, v58, v57, 16
 v_alignbit_b32 v164, v59, v58, 16
 v_alignbit_b32 v165, v60, v59, 16
 v_alignbit_b32 v166, v61, v60, 16
 v_alignbit_b32 v167, v62, v61, 16
 ds_write_b128 v6, v[162:165] offset:0
 ds_write_b128 v6, v[164:167] offset:16640
 v_alignbit_b32 v168, v58, v57, 16
 v_alignbit_b32 v169, v59, v58, 16
 v_alignbit_b32 v170, v60, v59, 16
 v_alignbit_b32 v171, v61, v60, 16
 v_alignbit_b32 v172, v62, v61, 16
 v_alignbit_b32 v173, v63, v62, 16
 ds_write_b128 v6, v[168:171] offset:8320
 ds_write_b128 v6, v[170:173] offset:24960
 v_mov_b32 v174, v57
 v_mov_b32 v175, v58
 v_mov_b32 v176, v59
 v_mov_b32 v177, v60
 v_mov_b32_e64 v178, v61
 v_mov_b32 v179, v62
 ds_write_b128 v6, v[174:177] offset:4160
 ds_write_b128 v6, v[176:179] offset:20800
 buffer_store_dwordx4 v[200:203], v111, s[60:63], s14 offen sc0 sc1
 s_waitcnt vmcnt(12)
 ds_write_b128 v6, v[66:69] offset:13504
 ds_write_b128 v6, v[68:71] offset:30144
 v_alignbit_b32 v180, v65, v64, 16
 v_alignbit_b32 v181, v66, v65, 16
 v_alignbit_b32 v182, v67, v66, 16
 v_alignbit_b32 v183, v68, v67, 16
 v_alignbit_b32 v184, v69, v68, 16
 v_alignbit_b32 v185, v70, v69, 16
 ds_write_b128 v6, v[180:183] offset:1024
 ds_write_b128 v6, v[182:185] offset:17664
 v_alignbit_b32 v186, v66, v65, 16
 v_alignbit_b32 v187, v67, v66, 16
 v_alignbit_b32 v188, v68, v67, 16
 v_alignbit_b32 v189, v69, v68, 16
 v_alignbit_b32 v190, v70, v69, 16
 v_alignbit_b32 v191, v71, v70, 16
 ds_write_b128 v6, v[186:189] offset:9344
 ds_write_b128 v6, v[188:191] offset:25984
 v_mov_b32 v192, v65
 v_mov_b32 v193, v66
 v_mov_b32 v194, v67
 v_mov_b32 v195, v68
 v_mov_b32 v196, v69
 v_mov_b32 v197, v70
 ds_write_b128 v6, v[192:195] offset:5184
 ds_write_b128 v6, v[194:197] offset:21824
 buffer_store_dwordx4 v[200:203], v111, s[60:63], s15 offen sc0 sc1
 v_mov_b32 v4, 0
 s_mov_b32 s85, 0
 s_waitcnt vmcnt(5)
 s_branch Lc_3
Lp_1:
 buffer_load_dwordx4 v[72:75], v139, s[60:63], s86 offen offset:0 sc1
 buffer_load_dwordx4 v[76:79], v139, s[60:63], s86 offen offset:1024 sc1
 buffer_load_dwordx4 v[80:83], v139, s[60:63], s86 offen offset:2048 sc1
 buffer_load_dwordx4 v[84:87], v139, s[60:63], s86 offen offset:3072 sc1
 s_waitcnt vmcnt(0)
Lc_3:
 v_min_u32 v2, v73, v75
 v_max_u32_e64 v3, v73, v75
 v_min3_u32 v2, v2, v77, v79
 v_max3_u32 v3, v3, v77, v79
 v_min3_u32 v2, v2, v81, v83
 v_max3_u32 v3, v3, v81, v83
 v_min3_u32 v2, v2, v85, v87
 v_max3_u32 v3, v3, v85, v87
 v_xor_b32 v2, s8, v2
 v_xor_b32 v3, s8, v3
 v_or_b32 v2, v2, v3
 v_cmp_ne_u32 vcc, 0, v2
 s_nop 3
 s_cbranch_vccz Lok_2
 s_add_u32 s85, s85, 1
 s_cmp_lt_u32 s85, 64
 s_cbranch_scc1 Lp_1
 v_mov_b32_e64 v4, 1
 s_nop 2
Lok_2:
 v_mov_b32_e64 v73, v74
 ds_write_b64 v114, v[72:73] offset:0
 v_mov_b32_e64 v77, v78
 ds_write_b64 v114, v[76:77] offset:512
 v_mov_b32_e64 v81, v82
 ds_write_b64 v114, v[80:81] offset:1024
 v_mov_b32_e64 v85, v86
 ds_write_b64 v114, v[84:85] offset:1536
 ds_write_b32 v115, v4
 s_waitcnt lgkmcnt(0)
 s_barrier
 ds_read_b128 v[4:7], v113
 ds_read_b128 a[0:3], v108 offset:0
 ds_read_b128 a[32:35], v109 offset:3584
 ds_read_b128 a[4:7], v108 offset:512
 ds_read_b128 a[36:39], v109 offset:3072
 ds_read_b128 a[8:11], v108 offset:1024
 ds_read_b128 a[40:43], v109 offset:2560
 ds_read_b128 a[12:15], v108 offset:1536
 ds_read_b128 a[44:47], v109 offset:2048
 ds_read_b128 a[16:19], v108 offset:2048
 ds_read_b128 a[48:51], v109 offset:1536
 ds_read_b128 a[20:23], v108 offset:2560
 ds_read_b128 a[52:55], v109 offset:1024
 ds_read_b128 a[24:27], v108 offset:3072
 ds_read_b128 a[56:59], v109 offset:512
 ds_read_b128 a[28:31], v108 offset:3584
 ds_read_b128 a[60:63], v109 offset:0
 s_waitcnt lgkmcnt(15)
 v_or3_b32 v4, v4, v5, v6
 v_or_b32_e64 v4, v4, v7
 s_nop 0
 v_readfirstlane_b32 s14, v4
 s_nop 0
 s_cmp_lg_u32 s14, 0
 s_cbranch_scc1 Lslow
 s_waitcnt lgkmcnt(14)
 v_mfma_f32_16x16x32_bf16 v[2:5], a[0:3], a[32:35], 0
 s_lshl_b32 s14, s6, 14
 s_lshl_b32 s15, s3, 10
 s_waitcnt lgkmcnt(12)
 v_mfma_f32_16x16x32_bf16 v[6:9], a[0:3], a[36:39], 0
 s_add_u32 s76, s14, s15
 s_add_u32 s76, s76, 8388608
 v_mfma_f32_16x16x32_bf16 v[6:9], a[4:7], a[32:35], v[6:9]
 s_add_u32 m0, s0, 102400
 s_add_u32 s94, s31, 0
 v_mfma_f32_16x16x32_bf16 v[10:13], a[4:7], a[36:39], 0
 buffer_load_dwordx4 v88, s[64:67], s94 offen offset:0 lds
 v_mov_b32 v40, -1
 s_waitcnt lgkmcnt(10)
 v_mfma_f32_16x16x32_bf16 v[10:13], a[0:3], a[40:43], v[10:13]
 buffer_store_dwordx4 v[40:43], v139, s[60:63], s76 offen
 s_nop 1
 v_mov_b32 v41, -1
 v_mfma_f32_16x16x32_bf16 v[10:13], a[8:11], a[32:35], v[10:13]
 v_mov_b32_e64 v42, -1
 v_mov_b32 v43, -1
 v_mfma_f32_16x16x32_bf16 v[14:17], a[4:7], a[40:43], 0
 ds_read_b128 a[64:67], v108 offset:64
 ds_read_b128 a[96:99], v109 offset:3648
 v_mfma_f32_16x16x32_bf16 v[14:17], a[8:11], a[36:39], v[14:17]
 ds_read_b128 a[68:71], v108 offset:576
 ds_read_b128 a[100:103], v109 offset:3136
 v_mfma_f32_16x16x32_bf16 v[18:21], a[8:11], a[40:43], 0
 s_add_u32 s15, s76, 4096
 buffer_load_dwordx4 v89, s[64:67], s94 offen offset:1024 lds
 s_waitcnt lgkmcnt(12)
 v_mfma_f32_16x16x32_bf16 v[14:17], a[0:3], a[44:47], v[14:17]
 ds_read_b128 a[72:75], v108 offset:1088
 ds_read_b128 a[104:107], v109 offset:2624
 v_mfma_f32_16x16x32_bf16 v[14:17], a[12:15], a[32:35], v[14:17]
 ds_read_b128 a[76:79], v108 offset:1600
 ds_read_b128 a[108:111], v109 offset:2112
 v_mfma_f32_16x16x32_bf16 v[18:21], a[4:7], a[44:47], v[18:21]
 ds_read_b128 a[80:83], v108 offset:2112
 ds_read_b128 a[112:115], v109 offset:1600
 v_mfma_f32_16x16x32_bf16 v[18:21], a[12:15], a[36:39], v[18:21]
 ds_read_b128 a[84:87], v108 offset:2624
 ds_read_b128 a[116:119], v109 offset:1088
 v_mfma_f32_16x16x32_bf16 v[22:25], a[8:11], a[44:47], 0
 buffer_load_dwordx4 v90, s[64:67], s94 offen offset:2048 lds
 ds_read_b128 a[88:91], v108 offset:3136
 v_mfma_f32_16x16x32_bf16 v[22:25], a[12:15], a[40:43], v[22:25]
 s_add_u32 m0, s0, 114688
 s_add_u32 s94, s31, 88064
 v_mfma_f32_16x16x32_bf16 v[26:29], a[12:15], a[44:47], 0
 ds_read_b128 a[120:123], v109 offset:576
 ds_read_b128 a[92:95], v108 offset:3648
 s_waitcnt lgkmcnt(15)
 v_mfma_f32_16x16x32_bf16 v[18:21], a[0:3], a[48:51], v[18:21]
 buffer_store_dwordx4 v[40:43], v139, s[60:63], s15 offen
 ds_read_b128 a[124:127], v109 offset:64
 v_mfma_f32_16x16x32_bf16 v[18:21], a[16:19], a[32:35], v[18:21]
 s_lshl_b32 s14, s6, 4
 s_lshl_b32 s12, s3, 2
 v_mfma_f32_16x16x32_bf16 v[22:25], a[4:7], a[48:51], v[22:25]
 s_add_u32 s14, s14, s12
 s_add_u32 s14, s14, 4096
 v_mfma_f32_16x16x32_bf16 v[22:25], a[16:19], a[36:39], v[22:25]
 buffer_load_dwordx4 v88, s[64:67], s94 offen offset:0 lds
 s_waitcnt vmcnt(6)
 v_mfma_f32_16x16x32_bf16 v[26:29], a[8:11], a[48:51], v[26:29]
 buffer_store_dword v143, off, s[60:63], s14 sc0 sc1
 s_and_b32 s12, s10, 3
 v_mfma_f32_16x16x32_bf16 v[26:29], a[16:19], a[40:43], v[26:29]
 s_add_u32 s88, s12, s3
 s_mul_i32 s88, s88, 3
 v_mfma_f32_16x16x32_bf16 v[30:33], a[12:15], a[48:51], 0
 s_mul_i32 s14, s9, 352
 v_lshl_add_u32 v120, v145, 3, s14
 v_mfma_f32_16x16x32_bf16 v[30:33], a[16:19], a[44:47], v[30:33]
 s_add_u32 s14, s88, 0
 s_sub_u32 s12, s14, 11
 v_mfma_f32_16x16x32_bf16 v[22:25], a[0:3], a[52:55], v[22:25]
 buffer_load_dwordx4 v89, s[64:67], s94 offen offset:1024 lds
 s_min_u32 s14, s14, s12
 v_mfma_f32_16x16x32_bf16 v[22:25], a[20:23], a[32:35], v[22:25]
 s_lshl_b32 s86, s14, 5
 s_add_u32 s14, s88, 1
 v_mfma_f32_16x16x32_bf16 v[26:29], a[4:7], a[52:55], v[26:29]
 s_sub_u32 s12, s14, 11
 s_min_u32 s14, s14, s12
 v_mfma_f32_16x16x32_bf16 v[26:29], a[20:23], a[36:39], v[26:29]
 s_lshl_b32 s87, s14, 5
 s_add_u32 s14, s88, 2
 v_mfma_f32_16x16x32_bf16 v[30:33], a[8:11], a[52:55], v[30:33]
 s_sub_u32 s12, s14, 11
 s_min_u32 s14, s14, s12
 v_mfma_f32_16x16x32_bf16 v[30:33], a[20:23], a[40:43], v[30:33]
 buffer_load_dwordx4 v90, s[64:67], s94 offen offset:2048 lds
 s_lshl_b32 s88, s14, 5
 v_mfma_f32_16x16x32_bf16 v[26:29], a[0:3], a[56:59], v[26:29]
 s_add_u32 m0, s0, 126976
 s_add_u32 s94, s31, 176128
 v_mfma_f32_16x16x32_bf16 v[26:29], a[24:27], a[32:35], v[26:29]
 s_cmp_eq_u32 s3, 3
 s_cselect_b32 s88, 0x10000, s88
 v_mfma_f32_16x16x32_bf16 v[30:33], a[4:7], a[56:59], v[30:33]
 s_mov_b32 s52, s36
 s_mov_b32 s53, s37
 v_mfma_f32_16x16x32_bf16 v[30:33], a[24:27], a[36:39], v[30:33]
 s_mov_b32 s54, 0x400
 s_mov_b32 s55, 0x20000
 v_mfma_f32_16x16x32_bf16 v[30:33], a[0:3], a[60:63], v[30:33]
 s_mov_b32 s44, s32
 s_mov_b32 s45, s33
 v_mfma_f32_16x16x32_bf16 v[30:33], a[28:31], a[32:35], v[30:33]
 s_mov_b32 s46, 0xac0
 s_mov_b32 s47, 0x20000
 s_waitcnt lgkmcnt(0)
 v_mfma_f32_16x16x32_bf16 v[2:5], a[64:67], a[96:99], v[2:5]
 ds_read_b128 a[0:3], v108 offset:128
 ds_read_b128 a[32:35], v109 offset:3712
 v_mfma_f32_16x16x32_bf16 v[6:9], a[64:67], a[100:103], v[6:9]
 ds_read_b128 a[4:7], v108 offset:640
 ds_read_b128 a[36:39], v109 offset:3200
 v_mfma_f32_16x16x32_bf16 v[6:9], a[68:71], a[96:99], v[6:9]
 ds_read_b128 a[8:11], v108 offset:1152
 ds_read_b128 a[40:43], v109 offset:2688
 v_mfma_f32_16x16x32_bf16 v[10:13], a[68:71], a[100:103], v[10:13]
 ds_read_b128 a[12:15], v108 offset:1664
 ds_read_b128 a[44:47], v109 offset:2176
 v_mfma_f32_16x16x32_bf16 v[10:13], a[64:67], a[104:107], v[10:13]
 ds_read_b128 a[16:19], v108 offset:2176
 ds_read_b128 a[48:51], v109 offset:1664
 v_mfma_f32_16x16x32_bf16 v[10:13], a[72:75], a[96:99], v[10:13]
 ds_read_b128 a[20:23], v108 offset:2688
 ds_read_b128 a[52:55], v109 offset:1152
 v_mfma_f32_16x16x32_bf16 v[14:17], a[68:71], a[104:107], v[14:17]
 ds_read_b128 a[24:27], v108 offset:3200
 ds_read_b128 a[56:59], v109 offset:640
 v_mfma_f32_16x16x32_bf16 v[14:17], a[72:75], a[100:103], v[14:17]
 ds_read_b128 a[28:31], v108 offset:3712
 ds_read_b128 a[60:63], v109 offset:128
 v_mfma_f32_16x16x32_bf16 v[18:21], a[72:75], a[104:107], v[18:21]
 buffer_load_dwordx4 v88, s[64:67], s94 offen offset:0 lds
 buffer_load_dwordx4 v[116:119], v139, s[52:55], 0 offen
 v_mfma_f32_16x16x32_bf16 v[14:17], a[64:67], a[108:111], v[14:17]
 buffer_load_dwordx2 v[130:131], v120, s[44:47], s88 offen
 buffer_load_dwordx2 v[126:127], v120, s[44:47], s87 offen
 v_mfma_f32_16x16x32_bf16 v[14:17], a[76:79], a[96:99], v[14:17]
 buffer_load_dwordx2 v[122:123], v120, s[44:47], s86 offen
 v_bfe_u32 v149, v1, 2, 2
 v_mfma_f32_16x16x32_bf16 v[18:21], a[68:71], a[108:111], v[18:21]
 v_mul_u32_u24 v95, 3072, v145
 v_mul_u32_u24 v148, 384, v149
 v_mfma_f32_16x16x32_bf16 v[18:21], a[76:79], a[100:103], v[18:21]
 v_and_b32_e64 v150, 3, v1
 v_lshl_add_u32 v148, v150, 3, v148
 v_mfma_f32_16x16x32_bf16 v[22:25], a[72:75], a[108:111], v[22:25]
 s_mov_b32 s12, 102400
 v_add3_u32 v148, v95, v148, s12
 v_mfma_f32_16x16x32_bf16 v[22:25], a[76:79], a[104:107], v[22:25]
 v_bfe_u32 v150, v1, 3, 2
 s_mul_i32 s12, s3, 3
 v_mfma_f32_16x16x32_bf16 v[26:29], a[76:79], a[108:111], v[26:29]
 v_xor_b32 v95, s12, v150
 v_lshl_add_u32 v95, v95, 5, v148
 v_mfma_f32_16x16x32_bf16 v[18:21], a[64:67], a[112:115], v[18:21]
 s_add_u32 s12, s12, 1
 v_xor_b32_e64 v87, s12, v150
 v_mfma_f32_16x16x32_bf16 v[18:21], a[80:83], a[96:99], v[18:21]
 v_lshl_add_u32 v87, v87, 5, v148
 s_add_u32 s12, s12, 1
 v_mfma_f32_16x16x32_bf16 v[22:25], a[68:71], a[112:115], v[22:25]
 v_xor_b32_e64 v69, s12, v150
 v_lshl_add_u32 v69, v69, 5, v148
 v_mfma_f32_16x16x32_bf16 v[22:25], a[80:83], a[100:103], v[22:25]
 v_bfe_u32 v148, v1, 4, 1
 v_bfe_u32 v150, v1, 1, 1
 v_mfma_f32_16x16x32_bf16 v[26:29], a[72:75], a[112:115], v[26:29]
 v_lshl_add_u32 v148, v148, 1, v150
 v_lshl_add_u32 v148, v149, 2, v148
 v_mfma_f32_16x16x32_bf16 v[26:29], a[80:83], a[104:107], v[26:29]
 v_lshlrev_b32 v148, 4, v148
 v_and_b32 v150, 1, v1
 v_mfma_f32_16x16x32_bf16 v[30:33], a[76:79], a[112:115], v[30:33]
 v_lshl_add_u32 v148, v150, 3, v148
 v_lshl_add_u32 v150, v147, 3, v149
 v_mfma_f32_16x16x32_bf16 v[30:33], a[80:83], a[108:111], v[30:33]
 buffer_load_dwordx4 v89, s[64:67], s94 offen offset:1024 lds
 v_lshl_add_u32 v148, v150, 8, v148
 v_mfma_f32_16x16x32_bf16 v[22:25], a[64:67], a[116:119], v[22:25]
 v_add_u32 v96, s84, v148
 v_xor_b32 v97, 64, v96
 v_mfma_f32_16x16x32_bf16 v[22:25], a[84:87], a[96:99], v[22:25]
 v_xor_b32 v98, 0x80, v96
 v_xor_b32 v99, 0xc0, v96
 v_mfma_f32_16x16x32_bf16 v[26:29], a[68:71], a[116:119], v[26:29]
 v_lshlrev_b32 v110, 2, v145
 v_xor_b32 v110, v110, v1
 v_mfma_f32_16x16x32_bf16 v[26:29], a[84:87], a[100:103], v[26:29]
 s_lshl_b32 s12, s3, 13
 v_lshl_add_u32 v110, v110, 4, s12
 v_mfma_f32_16x16x32_bf16 v[30:33], a[72:75], a[116:119], v[30:33]
 v_and_b32 v148, 3, v1
 v_lshlrev_b32 v115, 2, v148
 v_mfma_f32_16x16x32_bf16 v[30:33], a[84:87], a[104:107], v[30:33]
 v_lshrrev_b32 v149, 2, v1
 v_xor_b32_e64 v115, v115, v149
 v_mfma_f32_16x16x32_bf16 v[26:29], a[64:67], a[120:123], v[26:29]
 v_lshl_add_u32 v115, v148, 4, v115
 s_lshl_b32 s12, s3, 10
 v_mfma_f32_16x16x32_bf16 v[26:29], a[88:91], a[96:99], v[26:29]
 v_lshl_add_u32 v115, v115, 4, s12
 v_lshlrev_b32 v112, 3, v0
 v_mfma_f32_16x16x32_bf16 v[30:33], a[68:71], a[120:123], v[30:33]
 v_sub_u32 v112, 69624, v112
 s_mul_i32 s101, s3, 8448
 v_mfma_f32_16x16x32_bf16 v[30:33], a[88:91], a[100:103], v[30:33]
 s_add_u32 s95, s101, 33792
 s_and_b32 s12, s3, 1
 v_mfma_f32_16x16x32_bf16 v[30:33], a[64:67], a[124:127], v[30:33]
 s_lshl_b32 s27, s12, 12
 s_lshr_b32 s12, s3, 1
 v_mfma_f32_16x16x32_bf16 v[30:33], a[92:95], a[96:99], v[30:33]
 s_mul_i32 s12, s12, 33792
 s_add_u32 s27, s27, s12
 s_waitcnt lgkmcnt(0)
 v_mfma_f32_16x16x32_bf16 v[2:5], a[0:3], a[32:35], v[2:5]
 s_add_u32 s27, s27, 24576
 s_mul_i32 s1, s3, 16896
 v_mfma_f32_16x16x32_bf16 v[6:9], a[0:3], a[36:39], v[6:9]
 s_mul_i32 s11, s3, 6400
 s_add_u32 s11, s11, 76800
 v_mfma_f32_16x16x32_bf16 v[6:9], a[4:7], a[32:35], v[6:9]
 buffer_load_dwordx4 v90, s[64:67], s94 offen offset:2048 lds
 s_lshl_b32 s12, s10, 17
 v_mfma_f32_16x16x32_bf16 v[10:13], a[4:7], a[36:39], v[10:13]
 s_add_u32 m0, s0, 139264
 s_add_u32 s94, s31, 264192
 v_mfma_f32_16x16x32_bf16 v[10:13], a[0:3], a[40:43], v[10:13]
 s_lshl_b32 s77, s3, 15
 s_add_u32 s77, s77, s12
 v_mfma_f32_16x16x32_bf16 v[10:13], a[8:11], a[32:35], v[10:13]
 s_add_u32 s77, s77, 8388608
 s_add_u32 s78, s77, 0x4000
 v_mfma_f32_16x16x32_bf16 v[14:17], a[4:7], a[40:43], v[14:17]
 ds_read_b128 a[64:67], v108 offset:192
 ds_read_b128 a[96:99], v109 offset:3776
 v_mfma_f32_16x16x32_bf16 v[14:17], a[8:11], a[36:39], v[14:17]
 ds_read_b128 a[68:71], v108 offset:704
 ds_read_b128 a[100:103], v109 offset:3264
 v_mfma_f32_16x16x32_bf16 v[18:21], a[8:11], a[40:43], v[18:21]
 ds_read_b128 a[72:75], v108 offset:1216
 ds_read_b128 a[104:107], v109 offset:2752
 v_mfma_f32_16x16x32_bf16 v[14:17], a[0:3], a[44:47], v[14:17]
 ds_read_b128 a[76:79], v108 offset:1728
 ds_read_b128 a[108:111], v109 offset:2240
 v_mfma_f32_16x16x32_bf16 v[14:17], a[12:15], a[32:35], v[14:17]
 ds_read_b128 a[80:83], v108 offset:2240
 ds_read_b128 a[112:115], v109 offset:1728
 v_mfma_f32_16x16x32_bf16 v[18:21], a[4:7], a[44:47], v[18:21]
 ds_read_b128 a[84:87], v108 offset:2752
 ds_read_b128 a[116:119], v109 offset:1216
 v_mfma_f32_16x16x32_bf16 v[18:21], a[12:15], a[36:39], v[18:21]
 ds_read_b128 a[88:91], v108 offset:3264
 ds_read_b128 a[120:123], v109 offset:704
 v_mfma_f32_16x16x32_bf16 v[22:25], a[8:11], a[44:47], v[22:25]
 ds_read_b128 a[92:95], v108 offset:3776
 ds_read_b128 a[124:127], v109 offset:192
 v_mfma_f32_16x16x32_bf16 v[22:25], a[12:15], a[40:43], v[22:25]
 s_and_b32 s12, s10, 3
 s_mul_i32 s15, s3, 22016
 v_mfma_f32_16x16x32_bf16 v[26:29], a[12:15], a[44:47], v[26:29]
 s_add_u32 s14, s12, 1
 s_and_b32 s14, s14, 3
 v_mfma_f32_16x16x32_bf16 v[18:21], a[0:3], a[48:51], v[18:21]
 s_mul_i32 s14, s14, 352256
 s_add_u32 s34, s14, s15
 v_mfma_f32_16x16x32_bf16 v[18:21], a[16:19], a[32:35], v[18:21]
 buffer_load_dwordx4 v88, s[64:67], s94 offen offset:0 lds
 s_add_u32 s14, s12, 2
 v_mfma_f32_16x16x32_bf16 v[22:25], a[4:7], a[48:51], v[22:25]
 s_and_b32 s14, s14, 3
 s_mul_i32 s14, s14, 352256
 v_mfma_f32_16x16x32_bf16 v[22:25], a[16:19], a[36:39], v[22:25]
 s_add_u32 s35, s14, s15
 s_add_u32 s14, s12, 3
 v_mfma_f32_16x16x32_bf16 v[26:29], a[8:11], a[48:51], v[26:29]
 s_and_b32 s14, s14, 3
 s_mul_i32 s14, s14, 352256
 v_mfma_f32_16x16x32_bf16 v[26:29], a[16:19], a[40:43], v[26:29]
 s_add_u32 s13, s14, s15
 s_and_b32 s12, s10, 3
 v_mfma_f32_16x16x32_bf16 v[30:33], a[12:15], a[48:51], v[30:33]
 s_mul_i32 s15, s12, 49152
 s_add_u32 s14, s15, 0
 v_mfma_f32_16x16x32_bf16 v[30:33], a[16:19], a[44:47], v[30:33]
 s_sub_u32 s18, s14, 180224
 s_min_u32 s18, s18, s14
 v_mfma_f32_16x16x32_bf16 v[22:25], a[0:3], a[52:55], v[22:25]
 s_add_u32 s14, s15, 16384
 s_sub_u32 s19, s14, 180224
 v_mfma_f32_16x16x32_bf16 v[22:25], a[20:23], a[32:35], v[22:25]
 s_min_u32 s19, s19, s14
 s_add_u32 s14, s15, 32768
 v_mfma_f32_16x16x32_bf16 v[26:29], a[4:7], a[52:55], v[26:29]
 s_sub_u32 s20, s14, 180224
 s_min_u32 s20, s20, s14
 v_mfma_f32_16x16x32_bf16 v[26:29], a[20:23], a[36:39], v[26:29]
 s_add_u32 s14, s15, 49152
 s_sub_u32 s21, s14, 180224
 v_mfma_f32_16x16x32_bf16 v[30:33], a[8:11], a[52:55], v[30:33]
 s_min_u32 s21, s21, s14
 s_add_u32 s14, s15, 65536
 v_mfma_f32_16x16x32_bf16 v[30:33], a[20:23], a[40:43], v[30:33]
 s_sub_u32 s22, s14, 180224
 s_min_u32 s22, s22, s14
 v_mfma_f32_16x16x32_bf16 v[26:29], a[0:3], a[56:59], v[26:29]
 s_add_u32 s14, s15, 81920
 s_sub_u32 s23, s14, 180224
 v_mfma_f32_16x16x32_bf16 v[26:29], a[24:27], a[32:35], v[26:29]
 s_min_u32 s23, s23, s14
 s_add_u32 s14, s15, 98304
 v_mfma_f32_16x16x32_bf16 v[30:33], a[4:7], a[56:59], v[30:33]
 buffer_load_dwordx4 v89, s[64:67], s94 offen offset:1024 lds
 s_sub_u32 s24, s14, 180224
 v_mfma_f32_16x16x32_bf16 v[30:33], a[24:27], a[36:39], v[30:33]
 s_min_u32 s24, s24, s14
 s_add_u32 s14, s15, 114688
 v_mfma_f32_16x16x32_bf16 v[30:33], a[0:3], a[60:63], v[30:33]
 s_sub_u32 s25, s14, 180224
 s_min_u32 s25, s25, s14
 v_mfma_f32_16x16x32_bf16 v[30:33], a[28:31], a[32:35], v[30:33]
 s_add_u32 s14, s15, 131072
 s_sub_u32 s16, s14, 180224
 s_waitcnt lgkmcnt(0)
 v_mfma_f32_16x16x32_bf16 v[2:5], a[64:67], a[96:99], v[2:5]
 s_min_u32 s16, s16, s14
 s_add_u32 s14, s15, 147456
 v_mfma_f32_16x16x32_bf16 v[6:9], a[64:67], a[100:103], v[6:9]
 s_sub_u32 s17, s14, 180224
 s_min_u32 s17, s17, s14
 v_mfma_f32_16x16x32_bf16 v[6:9], a[68:71], a[96:99], v[6:9]
 s_add_u32 s14, s15, 163840
 s_sub_u32 s30, s14, 180224
 v_mfma_f32_16x16x32_bf16 v[10:13], a[68:71], a[100:103], v[10:13]
 s_min_u32 s30, s30, s14
 v_lshlrev_b32_e64 v149, 2, v145
 v_mfma_f32_16x16x32_bf16 v[10:13], a[64:67], a[104:107], v[10:13]
 v_xor_b32_e64 v149, v144, v149
 v_lshlrev_b32_e64 v91, 10, v145
 v_mfma_f32_16x16x32_bf16 v[10:13], a[72:75], a[96:99], v[10:13]
 v_lshl_add_u32 v91, v149, 4, v91
 s_mul_i32 s14, s9, 180224
 v_mfma_f32_16x16x32_bf16 v[14:17], a[68:71], a[104:107], v[14:17]
 s_lshl_b32 s15, s3, 8
 s_add_u32 s14, s14, s15
 v_mfma_f32_16x16x32_bf16 v[14:17], a[72:75], a[100:103], v[14:17]
 v_add_u32_e64 v91, s14, v91
 v_add_u32 v92, 3072, v91
 v_mfma_f32_16x16x32_bf16 v[18:21], a[72:75], a[104:107], v[18:21]
 v_add_u32 v93, 6144, v91
 v_add_u32 v94, 9216, v91
 v_mfma_f32_16x16x32_bf16 v[14:17], a[64:67], a[108:111], v[14:17]
 v_lshrrev_b32_e64 v84, 1, v0
 v_lshlrev_b32_e64 v84, 4, v84
 v_mfma_f32_16x16x32_bf16 v[14:17], a[76:79], a[96:99], v[14:17]
 s_and_b32 s12, s10, 12
 s_add_u32 s89, s12, 4096
 v_mfma_f32_16x16x32_bf16 v[18:21], a[68:71], a[108:111], v[18:21]
 buffer_load_dwordx4 v90, s[64:67], s94 offen offset:2048 lds
 s_lshl_b32 s12, s5, 2
 v_mfma_f32_16x16x32_bf16 v[18:21], a[76:79], a[100:103], v[18:21]
 s_add_u32 s12, s12, s3
 s_lshl_b32 s12, s12, 9
 v_mfma_f32_16x16x32_bf16 v[22:25], a[72:75], a[108:111], v[22:25]
 v_lshrrev_b32_e64 v85, 4, v1
 v_lshl_add_u32 v85, v85, 7, s12
 v_mfma_f32_16x16x32_bf16 v[22:25], a[76:79], a[104:107], v[22:25]
 v_min_u32 v85, Lslow-Lpc, v85
 global_load_dword a172, v85, s[28:29]
 v_mfma_f32_16x16x32_bf16 v[26:29], a[76:79], a[108:111], v[26:29]
 ds_read_b64 v[38:39], v112 offset:2048
 ds_read_b64 v[40:41], v112 offset:6656
 v_mfma_f32_16x16x32_bf16 v[18:21], a[64:67], a[112:115], v[18:21]
 ds_read_b64 v[42:43], v112 offset:0
 ds_read_b64 v[44:45], v112 offset:4608
 v_mfma_f32_16x16x32_bf16 v[18:21], a[80:83], a[96:99], v[18:21]
 v_readfirstlane_b32 s99, v36
 s_lshl_b32 s14, s6, 8
 v_mfma_f32_16x16x32_bf16 v[22:25], a[68:71], a[112:115], v[22:25]
 s_add_u32 s14, s14, 6291456
 s_add_u32 s15, s14, 0x100000
 v_mfma_f32_16x16x32_bf16 v[22:25], a[80:83], a[100:103], v[22:25]
 s_lshl_b32 s100, s99, 16
 s_and_b32 s99, s99, 0xffff0000
 v_mfma_f32_16x16x32_bf16 v[26:29], a[72:75], a[112:115], v[26:29]
 s_waitcnt lgkmcnt(0)
 v_and_b32_e64 v46, s98, v39
 v_mfma_f32_16x16x32_bf16 v[26:29], a[80:83], a[104:107], v[26:29]
 v_lshlrev_b32 v47, 16, v39
 v_and_b32 v48, s98, v38
 v_mfma_f32_16x16x32_bf16 v[30:33], a[76:79], a[112:115], v[30:33]
 v_lshlrev_b32 v49, 16, v38
 v_mul_f32 v46, s100, v46
 v_mfma_f32_16x16x32_bf16 v[30:33], a[80:83], a[108:111], v[30:33]
 v_mul_f32 v47, s100, v47
 v_mul_f32 v48, s100, v48
 v_mfma_f32_16x16x32_bf16 v[22:25], a[64:67], a[116:119], v[22:25]
 v_mul_f32 v49, s100, v49
 v_and_b32 v50, s98, v41
 v_mfma_f32_16x16x32_bf16 v[22:25], a[84:87], a[96:99], v[22:25]
 v_lshlrev_b32 v51, 16, v41
 v_and_b32 v52, s98, v40
 v_mfma_f32_16x16x32_bf16 v[26:29], a[68:71], a[116:119], v[26:29]
 v_lshlrev_b32 v53, 16, v40
 v_mul_f32 v50, s99, v50
 v_mfma_f32_16x16x32_bf16 v[26:29], a[84:87], a[100:103], v[26:29]
 v_mul_f32 v51, s99, v51
 v_mul_f32 v52, s99, v52
 v_mfma_f32_16x16x32_bf16 v[30:33], a[72:75], a[116:119], v[30:33]
 v_mul_f32 v53, s99, v53
 v_and_b32 v54, s98, v43
 v_mfma_f32_16x16x32_bf16 v[30:33], a[84:87], a[104:107], v[30:33]
 v_lshlrev_b32 v55, 16, v43
 v_and_b32 v56, s98, v42
 v_mfma_f32_16x16x32_bf16 v[26:29], a[64:67], a[120:123], v[26:29]
 v_lshlrev_b32 v57, 16, v42
 v_mul_f32 v54, s100, v54
 v_mfma_f32_16x16x32_bf16 v[26:29], a[88:91], a[96:99], v[26:29]
 v_mul_f32 v55, s100, v55
 v_mul_f32 v56, s100, v56
 v_mfma_f32_16x16x32_bf16 v[30:33], a[68:71], a[120:123], v[30:33]
 v_mul_f32 v57, s100, v57
 v_and_b32 v58, s98, v45
 v_mfma_f32_16x16x32_bf16 v[30:33], a[88:91], a[100:103], v[30:33]
 v_lshlrev_b32 v59, 16, v45
 v_and_b32 v60, s98, v44
 v_mfma_f32_16x16x32_bf16 v[30:33], a[64:67], a[124:127], v[30:33]
 v_lshlrev_b32 v61, 16, v44
 v_mul_f32 v58, s99, v58
 v_mfma_f32_16x16x32_bf16 v[30:33], a[92:95], a[96:99], v[30:33]
 v_mul_f32 v59, s99, v59
 v_mul_f32 v60, s99, v60
 v_mul_f32_e64 v61, s99, v61
 s_waitcnt lgkmcnt(0)
 s_barrier
 ds_write_b128 v110, v[2:5] offset:0
 ds_write_b128 v110, v[6:9] offset:1024
 ds_write_b128 v110, v[10:13] offset:2048
 ds_write_b128 v110, v[14:17] offset:3072
 ds_write_b128 v110, v[18:21] offset:4096
 ds_write_b128 v110, v[22:25] offset:5120
 ds_write_b128 v110, v[26:29] offset:6144
 ds_write_b128 v110, v[30:33] offset:7168
 s_waitcnt lgkmcnt(0)
 s_barrier
 ds_read_b128 v[2:5], v115 offset:0
 ds_read_b128 v[6:9], v115 offset:8192
 ds_read_b128 v[10:13], v115 offset:16384
 ds_read_b128 v[14:17], v115 offset:24576
 ds_read_b128 v[18:21], v115 offset:4096
 ds_read_b128 v[22:25], v115 offset:12288
 ds_read_b128 v[26:29], v115 offset:20480
 ds_read_b128 v[30:33], v115 offset:28672
 s_waitcnt vmcnt(15)
 s_waitcnt lgkmcnt(6)
 v_pk_add_f32 v[46:47], v[46:47], v[2:3]
 v_pk_add_f32 v[48:49], v[48:49], v[4:5]
 v_pk_add_f32 v[46:47], v[46:47], v[6:7]
 v_pk_add_f32 v[48:49], v[48:49], v[8:9]
 s_waitcnt lgkmcnt(4)
 v_pk_add_f32 v[50:51], v[50:51], v[10:11]
 v_pk_add_f32 v[52:53], v[52:53], v[12:13]
 v_pk_add_f32 v[50:51], v[50:51], v[14:15]
 v_pk_add_f32 v[52:53], v[52:53], v[16:17]
 v_cvt_pk_bf16_f32 v72, v46, v50
 v_cvt_pk_bf16_f32 v73, v47, v51
 v_cvt_pk_bf16_f32 v74, v48, v52
 v_cvt_pk_bf16_f32 v75, v49, v53
 v_min_u32 v72, -2, v72
 v_min_u32_e64 v73, -2, v73
 v_min_u32_e64 v74, -2, v74
 v_min_u32_e64 v75, -2, v75
 buffer_store_dwordx4 v[72:75], v111, s[60:63], s14 offen sc0 sc1
 s_waitcnt lgkmcnt(2)
 v_pk_add_f32 v[54:55], v[54:55], v[18:19]
 v_pk_add_f32 v[56:57], v[56:57], v[20:21]
 v_pk_add_f32 v[54:55], v[54:55], v[22:23]
 v_pk_add_f32 v[56:57], v[56:57], v[24:25]
 s_waitcnt lgkmcnt(0)
 v_pk_add_f32 v[58:59], v[58:59], v[26:27]
 v_pk_add_f32 v[60:61], v[60:61], v[28:29]
 v_pk_add_f32 v[58:59], v[58:59], v[30:31]
 v_pk_add_f32 v[60:61], v[60:61], v[32:33]
 v_cvt_pk_bf16_f32 v76, v54, v58
 v_cvt_pk_bf16_f32 v77, v55, v59
 v_cvt_pk_bf16_f32 v78, v56, v60
 v_cvt_pk_bf16_f32 v79, v57, v61
 v_min_u32_e64 v76, -2, v76
 v_min_u32_e64 v77, -2, v77
 v_min_u32_e64 v78, -2, v78
 v_min_u32_e64 v79, -2, v79
 buffer_store_dwordx4 v[76:79], v111, s[60:63], s15 offen sc0 sc1
 buffer_load_dword v82, v84, s[60:63], s89 offen sc1
 buffer_load_dword v83, v84, s[60:63], s89 offen offset:2048 sc1
 s_add_u32 m0, s0, 33792
 s_add_u32 s94, s34, 0
 buffer_load_dwordx4 v88, s[64:67], s94 offen offset:0 lds
 buffer_load_dwordx4 v89, s[64:67], s94 offen offset:1024 lds
 buffer_load_dwordx4 v90, s[64:67], s94 offen offset:2048 lds
 v_lshrrev_b32 v75, 1, v0
 v_lshlrev_b32 v74, 8, v75
 v_and_b32_e64 v72, 1, v0
 v_lshl_add_u32 v74, v72, 4, v74
 s_lshl_b32 s88, s10, 16
 s_lshl_b32 s87, s9, 5
 s_add_u32 s88, s88, s87
 s_add_u32 s88, s88, 6291456
 s_add_u32 s87, s88, 0x8000
 s_mov_b32 s96, 0x3b000000
 s_waitcnt vmcnt(8)
 s_barrier
 s_add_u32 m0, s0, 46080
 s_add_u32 s94, s34, 88064
 buffer_load_dwordx4 v88, s[64:67], s94 offen offset:0 lds
 ds_read_b64_tr_b16 a[176:177], v95 offset:0
 ds_read_b64_tr_b16 a[178:179], v95 offset:1536
 ds_read_b64_tr_b16 a[180:181], v87 offset:0
 ds_read_b64_tr_b16 a[182:183], v87 offset:1536
 ds_read_b64_tr_b16 a[184:185], v69 offset:0
 ds_read_b64_tr_b16 a[186:187], v69 offset:1536
 ds_read_b64_tr_b16 a[188:189], v95 offset:12288
 ds_read_b64_tr_b16 a[190:191], v95 offset:13824
 ds_read_b64_tr_b16 a[192:193], v87 offset:12288
 ds_read_b64_tr_b16 a[194:195], v87 offset:13824
 ds_read_b64_tr_b16 a[196:197], v69 offset:12288
 buffer_load_dwordx4 v89, s[64:67], s94 offen offset:1024 lds
 ds_read_b64_tr_b16 a[198:199], v69 offset:13824
 ds_read_b64_tr_b16 a[200:201], v95 offset:24576
 ds_read_b64_tr_b16 a[202:203], v95 offset:26112
 ds_read_b64_tr_b16 a[204:205], v87 offset:24576
 ds_read_b64_tr_b16 a[206:207], v87 offset:26112
 ds_read_b64_tr_b16 a[208:209], v69 offset:24576
 ds_read_b64_tr_b16 a[210:211], v69 offset:26112
 ds_read_b64_tr_b16 a[212:213], v95 offset:36864
 ds_read_b64_tr_b16 a[214:215], v95 offset:38400
 ds_read_b64_tr_b16 a[216:217], v87 offset:36864
 ds_read_b64_tr_b16 a[218:219], v87 offset:38400
 ds_read_b64_tr_b16 a[220:221], v69 offset:36864
 buffer_load_dwordx4 v90, s[64:67], s94 offen offset:2048 lds
 s_add_u32 m0, s0, 76800
 s_add_u32 s94, s34, 176128
 ds_read_b64_tr_b16 a[222:223], v69 offset:38400
 v_lshlrev_b32 v2, 16, v100
 v_lshlrev_b32 v34, 16, v104
 v_and_b32 v3, s98, v100
 v_and_b32 v35, s98, v104
 v_lshlrev_b32 v4, 16, v101
 v_lshlrev_b32 v36, 16, v105
 v_and_b32 v5, s98, v101
 v_and_b32 v37, s98, v105
 v_lshlrev_b32 v6, 16, v102
 v_lshlrev_b32 v38, 16, v106
 v_and_b32 v7, s98, v102
 buffer_load_dwordx4 v88, s[64:67], s94 offen offset:0 lds
 v_and_b32 v39, s98, v106
 v_lshlrev_b32 v8, 16, v103
 v_lshlrev_b32 v40, 16, v107
 v_and_b32 v9, s98, v103
 v_and_b32 v41, s98, v107
 v_pk_add_f32 v[10:11], v[2:3], v[4:5]
 v_pk_add_f32 v[42:43], v[34:35], v[36:37]
 v_pk_mul_f32 v[12:13], v[2:3], v[2:3]
 v_pk_mul_f32 v[44:45], v[34:35], v[34:35]
 v_pk_add_f32 v[14:15], v[6:7], v[8:9]
 v_pk_add_f32 v[46:47], v[38:39], v[40:41]
 v_pk_fma_f32 v[12:13], v[4:5], v[4:5], v[12:13]
 buffer_load_dwordx4 v89, s[64:67], s94 offen offset:1024 lds
 v_pk_fma_f32 v[44:45], v[36:37], v[36:37], v[44:45]
 v_pk_add_f32 v[10:11], v[10:11], v[14:15]
 v_pk_add_f32 v[42:43], v[42:43], v[46:47]
 v_pk_fma_f32 v[12:13], v[6:7], v[6:7], v[12:13]
 v_pk_fma_f32 v[44:45], v[38:39], v[38:39], v[44:45]
 v_add_f32 v10, v10, v11
 v_add_f32 v42, v42, v43
 v_pk_fma_f32 v[12:13], v[8:9], v[8:9], v[12:13]
 v_pk_fma_f32 v[44:45], v[40:41], v[40:41], v[44:45]
 v_add_f32 v11, v12, v13
 v_add_f32 v43, v44, v45
 v_add_f32_dpp v10, v10, v10 quad_perm:[1,0,3,2] row_mask:0xf bank_mask:0xf
 buffer_load_dwordx4 v90, s[64:67], s94 offen offset:2048 lds
 s_add_u32 m0, s0, 89088
 s_add_u32 s94, s34, 264192
 v_add_f32_dpp v42, v42, v42 quad_perm:[1,0,3,2] row_mask:0xf bank_mask:0xf
 v_add_f32_dpp v11, v11, v11 quad_perm:[1,0,3,2] row_mask:0xf bank_mask:0xf
 v_add_f32_dpp v43, v43, v43 quad_perm:[1,0,3,2] row_mask:0xf bank_mask:0xf
 v_add_f32_dpp v10, v10, v10 quad_perm:[2,3,0,1] row_mask:0xf bank_mask:0xf
 v_add_f32_dpp v42, v42, v42 quad_perm:[2,3,0,1] row_mask:0xf bank_mask:0xf
 v_add_f32_dpp v11, v11, v11 quad_perm:[2,3,0,1] row_mask:0xf bank_mask:0xf
 v_add_f32_dpp v43, v43, v43 quad_perm:[2,3,0,1] row_mask:0xf bank_mask:0xf
 v_add_f32_dpp v10, v10, v10 row_half_mirror row_mask:0xf bank_mask:0xf
 v_add_f32_dpp v42, v42, v42 row_half_mirror row_mask:0xf bank_mask:0xf
 v_add_f32_dpp v11, v11, v11 row_half_mirror row_mask:0xf bank_mask:0xf
 v_add_f32_dpp v43, v43, v43 row_half_mirror row_mask:0xf bank_mask:0xf
 v_add_f32_dpp v10, v10, v10 row_mirror row_mask:0xf bank_mask:0xf
 buffer_load_dwordx4 v88, s[64:67], s94 offen offset:0 lds
 v_add_f32_dpp v42, v42, v42 row_mirror row_mask:0xf bank_mask:0xf
 v_add_f32_dpp v11, v11, v11 row_mirror row_mask:0xf bank_mask:0xf
 v_add_f32_dpp v43, v43, v43 row_mirror row_mask:0xf bank_mask:0xf
 v_add_f32_dpp v10, v10, v10 row_bcast:15 row_mask:0xa bank_mask:0xf
 v_add_f32_dpp v42, v42, v42 row_bcast:15 row_mask:0xa bank_mask:0xf
 v_add_f32_dpp v11, v11, v11 row_bcast:15 row_mask:0xa bank_mask:0xf
 v_add_f32_dpp v43, v43, v43 row_bcast:15 row_mask:0xa bank_mask:0xf
 v_add_f32_dpp v10, v10, v10 row_bcast:31 row_mask:0xc bank_mask:0xf
 v_add_f32_dpp v42, v42, v42 row_bcast:31 row_mask:0xc bank_mask:0xf
 v_add_f32_dpp v11, v11, v11 row_bcast:31 row_mask:0xc bank_mask:0xf
 v_add_f32_dpp v43, v43, v43 row_bcast:31 row_mask:0xc bank_mask:0xf
 v_readlane_b32 s92, v10, 63
 buffer_load_dwordx4 v89, s[64:67], s94 offen offset:1024 lds
 v_readlane_b32 s90, v42, 63
 v_readlane_b32 s93, v11, 63
 v_readlane_b32 s91, v43, 63
 v_mov_b32 v13, s96
 v_mov_b32 v45, s96
 v_mul_f32 v10, s92, v13
 v_mul_f32 v42, s90, v45
 v_mul_f32 v11, s93, v13
 v_mul_f32 v43, s91, v45
 v_fma_f32 v11, -v10, v10, v11
 v_fma_f32 v43, -v42, v42, v43
 v_max_f32_e64 v11, 0, v11
 buffer_load_dwordx4 v90, s[64:67], s94 offen offset:2048 lds
 s_add_u32 m0, s0, 0
 s_add_u32 s94, s35, 0
 v_max_f32_e64 v43, 0, v43
 v_add_f32 v11, 0x3727c5ac, v11
 v_add_f32 v43, 0x3727c5ac, v43
 v_rsq_f32 v11, v11
 v_rsq_f32 v43, v43
 v_mul_f32_e64 v10, v10, v11
 v_mul_f32_e64 v42, v42, v43
 v_pk_fma_f32 v[26:27], v[2:3], v[10:11], v[10:11] op_sel:[0,1,0] op_sel_hi:[1,1,0] neg_lo:[0,0,1] neg_hi:[0,0,1]
 v_pk_fma_f32 v[28:29], v[4:5], v[10:11], v[10:11] op_sel:[0,1,0] op_sel_hi:[1,1,0] neg_lo:[0,0,1] neg_hi:[0,0,1]
 v_pk_fma_f32 v[30:31], v[6:7], v[10:11], v[10:11] op_sel:[0,1,0] op_sel_hi:[1,1,0] neg_lo:[0,0,1] neg_hi:[0,0,1]
 v_pk_fma_f32 v[32:33], v[8:9], v[10:11], v[10:11] op_sel:[0,1,0] op_sel_hi:[1,1,0] neg_lo:[0,0,1] neg_hi:[0,0,1]
 v_pk_fma_f32 v[58:59], v[34:35], v[42:43], v[42:43] op_sel:[0,1,0] op_sel_hi:[1,1,0] neg_lo:[0,0,1] neg_hi:[0,0,1]
 buffer_load_dwordx4 v88, s[64:67], s94 offen offset:0 lds
 v_pk_fma_f32 v[60:61], v[36:37], v[42:43], v[42:43] op_sel:[0,1,0] op_sel_hi:[1,1,0] neg_lo:[0,0,1] neg_hi:[0,0,1]
 v_pk_fma_f32 v[62:63], v[38:39], v[42:43], v[42:43] op_sel:[0,1,0] op_sel_hi:[1,1,0] neg_lo:[0,0,1] neg_hi:[0,0,1]
 v_pk_fma_f32 v[64:65], v[40:41], v[42:43], v[42:43] op_sel:[0,1,0] op_sel_hi:[1,1,0] neg_lo:[0,0,1] neg_hi:[0,0,1]
 v_and_b32_e64 v18, 15, v1
 v_lshrrev_b32_e64 v19, 4, v1
 v_and_b32_e64 v20, 31, v1
 v_lshrrev_b32_e64 v21, 5, v1
 s_and_b32 s12, s10, 3
 s_lshl_b32 s14, s12, 8
 v_add_u32_e64 v138, s14, v139
 v_and_b32 v138, 0x3ff, v138
 s_lshl_b32 s14, s10, 19
 buffer_load_dwordx4 v89, s[64:67], s94 offen offset:1024 lds
 s_lshl_b32 s15, s3, 10
 s_add_u32 s14, s14, s15
 s_add_u32 s14, s14, 12582912
 s_lshl_b32 s15, s9, 13
 s_add_u32 s79, s14, s15
 s_lshl_b32 s15, s9, 16
 s_add_u32 s80, s14, s15
 s_add_u32 s81, s80, 0x8000
 s_lshl_b32 s14, s10, 4
 s_add_u32 s14, s14, s3
 s_lshl_b32 s14, s14, 7
 s_add_u32 s82, s14, 65536
 buffer_load_dwordx4 v90, s[64:67], s94 offen offset:2048 lds
 s_add_u32 m0, s0, 12288
 s_add_u32 s94, s35, 88064
 v_mul_u32_u24 v132, 1056, v18
 v_lshl_add_u32 v132, v19, 4, v132
 v_mul_u32_u24 v133, 400, v18
 v_lshl_add_u32 v133, v19, 3, v133
 s_mul_i32 s14, s3, 96
 s_add_u32 s14, s14, 76800
 v_add_u32_e64 v133, s14, v133
 v_mul_u32_u24 v134, 400, v20
 v_lshl_add_u32 v134, v21, 4, v134
 v_add_u32 v134, 76800, v134
 v_lshrrev_b32 v22, 2, v20
 v_lshlrev_b32 v135, 16, v22
 buffer_load_dwordx4 v88, s[64:67], s94 offen offset:0 lds
 v_and_b32 v22, 3, v20
 v_lshl_add_u32 v135, v22, 5, v135
 v_lshl_add_u32 v135, v21, 4, v135
 v_lshlrev_b32 v136, 13, v19
 v_lshl_add_u32 v136, v18, 4, v136
 v_bfe_u32 v22, v1, 1, 2
 v_mul_u32_u24 v137, 2080, v22
 v_lshl_add_u32 v137, v21, 7, v137
 v_bfe_u32 v22, v1, 3, 1
 v_lshl_add_u32 v137, v22, 6, v137
 v_and_b32_e64 v22, 1, v1
 v_lshl_add_u32 v137, v22, 5, v137
 buffer_load_dwordx4 v89, s[64:67], s94 offen offset:1024 lds
 v_bfe_u32 v22, v1, 4, 1
 v_lshl_add_u32 v137, v22, 4, v137
 s_lshl_b32 s14, s3, 9
 s_add_u32 s14, s14, 67584
 v_add_u32 v137, s14, v137
 v_and_b32 v22, 7, v1
 v_lshlrev_b32 v142, 2, v22
 v_mov_b32 v140, 0xc0135761
 s_mov_b32 s72, s38
 s_mov_b32 s73, s39
 s_mov_b32 s74, 0x200000
 s_mov_b32 s75, 0x20000
 s_waitcnt vmcnt(18)
 v_xor_b32 v82, s7, v82
 s_waitcnt vmcnt(17)
 v_xor_b32 v83, s7, v83
 v_or_b32_e64 v82, v82, v83
 v_cmp_ne_u32 vcc, 0, v82
 s_cbranch_vccnz Lrt_6
Lbk_7:
 buffer_load_dwordx4 v[76:79], v74, s[60:63], s88 offen sc1
 buffer_load_dwordx4 v[80:83], v74, s[60:63], s87 offen sc1
 v_mul_u32_u24 v84, 4096, v72
 v_lshl_add_u32 v84, v75, 2, v84
 v_add_u32 v84, 67584, v84
 s_mov_b32 s100, 0xbdd2d3e8
 buffer_load_dwordx4 v90, s[64:67], s94 offen offset:2048 lds
 v_lshlrev_b32 v120, 16, v122
 v_and_b32 v121, s98, v122
 v_lshlrev_b32 v122, 16, v123
 v_and_b32 v123, s98, v123
 v_lshlrev_b32 v124, 16, v126
 v_and_b32 v125, s98, v126
 v_lshlrev_b32 v126, 16, v127
 v_and_b32 v127, s98, v127
 v_lshlrev_b32 v128, 16, v130
 v_and_b32 v129, s98, v130
 v_lshlrev_b32 v130, 16, v131
 v_and_b32 v131, s98, v131
 s_mul_i32 s12, s3, 1024
 s_add_u32 s12, s12, 67584
 v_add_u32_e64 v86, s12, v139
 s_waitcnt vmcnt(2)
 v_max3_u32 v75, v76, v77, v78
 s_waitcnt vmcnt(1)
 v_max3_u32 v85, v79, v80, v81
 v_max3_u32 v75, v75, v82, v83
 v_max_u32_e64 v75, v75, v85
 v_cmp_eq_u32 vcc, -1, v75
 s_cbranch_vccnz Lrt_9
Lbk_10:
 ds_write_b32 v84, v76 offset:0
 ds_write_b32 v84, v77 offset:1024
 ds_write_b32 v84, v78 offset:2048
 ds_write_b32 v84, v79 offset:3072
 ds_write_b32 v84, v80 offset:512
 ds_write_b32 v84, v81 offset:1536
 ds_write_b32 v84, v82 offset:2560
 ds_write_b32 v84, v83 offset:3584
 s_waitcnt vmcnt(0)
 s_waitcnt lgkmcnt(0)
 s_barrier
 ds_read_b128 v[108:111], v86
 ds_read_b128 v[112:115], v86 offset:4096
 s_add_u32 m0, s0, 102400
 s_add_u32 s94, s35, 176128
 buffer_load_dwordx4 v88, s[64:67], s94 offen offset:0 lds
 s_waitcnt lgkmcnt(1)
 v_lshlrev_b32 v18, 16, v108
 v_and_b32 v19, s98, v108
 v_lshlrev_b32 v20, 16, v109
 v_and_b32 v21, s98, v109
 v_lshlrev_b32 v22, 16, v110
 v_and_b32 v23, s98, v110
 buffer_load_dwordx4 v89, s[64:67], s94 offen offset:1024 lds
 v_lshlrev_b32 v24, 16, v111
 v_and_b32 v25, s98, v111
 v_pk_fma_f32 v[2:3], v[26:27], v[18:19], v[2:3]
 v_pk_fma_f32 v[4:5], v[28:29], v[20:21], v[4:5]
 v_pk_fma_f32 v[6:7], v[30:31], v[22:23], v[6:7]
 v_pk_fma_f32 v[8:9], v[32:33], v[24:25], v[8:9]
 v_pk_add_f32 v[10:11], v[2:3], v[4:5]
 buffer_load_dwordx4 v90, s[64:67], s94 offen offset:2048 lds
 s_add_u32 m0, s0, 114688
 s_add_u32 s94, s35, 264192
 v_pk_mul_f32 v[12:13], v[2:3], v[2:3]
 v_pk_add_f32 v[14:15], v[6:7], v[8:9]
 v_pk_fma_f32 v[12:13], v[4:5], v[4:5], v[12:13]
 v_pk_add_f32 v[10:11], v[10:11], v[14:15]
 v_pk_fma_f32 v[12:13], v[6:7], v[6:7], v[12:13]
 v_add_f32 v10, v10, v11
 v_pk_fma_f32 v[12:13], v[8:9], v[8:9], v[12:13]
 buffer_load_dwordx4 v88, s[64:67], s94 offen offset:0 lds
 v_add_f32 v11, v12, v13
 v_add_f32_dpp v10, v10, v10 quad_perm:[1,0,3,2] row_mask:0xf bank_mask:0xf
 s_waitcnt lgkmcnt(0)
 v_lshlrev_b32 v50, 16, v112
 v_add_f32_dpp v11, v11, v11 quad_perm:[1,0,3,2] row_mask:0xf bank_mask:0xf
 v_and_b32_e64 v51, s98, v112
 v_add_f32_dpp v10, v10, v10 quad_perm:[2,3,0,1] row_mask:0xf bank_mask:0xf
 buffer_load_dwordx4 v89, s[64:67], s94 offen offset:1024 lds
 v_lshlrev_b32 v52, 16, v113
 v_add_f32_dpp v11, v11, v11 quad_perm:[2,3,0,1] row_mask:0xf bank_mask:0xf
 v_and_b32 v53, s98, v113
 v_add_f32_dpp v10, v10, v10 row_half_mirror row_mask:0xf bank_mask:0xf
 v_lshlrev_b32 v54, 16, v114
 v_add_f32_dpp v11, v11, v11 row_half_mirror row_mask:0xf bank_mask:0xf
 v_and_b32 v55, s98, v114
 buffer_load_dwordx4 v90, s[64:67], s94 offen offset:2048 lds
 s_add_u32 m0, s0, 126976
 s_add_u32 s94, s13, 0
 v_add_f32_dpp v10, v10, v10 row_mirror row_mask:0xf bank_mask:0xf
 v_lshlrev_b32 v56, 16, v115
 v_add_f32_dpp v11, v11, v11 row_mirror row_mask:0xf bank_mask:0xf
 v_and_b32_e64 v57, s98, v115
 v_add_f32_dpp v10, v10, v10 row_bcast:15 row_mask:0xa bank_mask:0xf
 v_pk_fma_f32 v[34:35], v[58:59], v[50:51], v[34:35]
 v_add_f32_dpp v11, v11, v11 row_bcast:15 row_mask:0xa bank_mask:0xf
 buffer_load_dwordx4 v88, s[64:67], s94 offen offset:0 lds
 v_pk_fma_f32 v[36:37], v[60:61], v[52:53], v[36:37]
 v_add_f32_dpp v10, v10, v10 row_bcast:31 row_mask:0xc bank_mask:0xf
 v_pk_fma_f32 v[38:39], v[62:63], v[54:55], v[38:39]
 v_add_f32_dpp v11, v11, v11 row_bcast:31 row_mask:0xc bank_mask:0xf
 v_pk_fma_f32 v[40:41], v[64:65], v[56:57], v[40:41]
 v_readlane_b32 s92, v10, 63
 buffer_load_dwordx4 v89, s[64:67], s94 offen offset:1024 lds
 v_readlane_b32 s93, v11, 63
 v_mov_b32 v13, s96
 v_mul_f32 v10, s92, v13
 v_mul_f32 v11, s93, v13
 v_fma_f32 v11, -v10, v10, v11
 v_max_f32 v11, 0, v11
 v_add_f32 v11, 0x3727c5ac, v11
 buffer_load_dwordx4 v90, s[64:67], s94 offen offset:2048 lds
 v_rsq_f32 v11, v11
 s_nop 0
 v_mul_f32_e64 v10, v10, v11
 v_pk_fma_f32 v[26:27], v[2:3], v[10:11], v[10:11] op_sel:[0,1,0] op_sel_hi:[1,1,0] neg_lo:[0,0,1] neg_hi:[0,0,1]
 v_pk_fma_f32 v[28:29], v[4:5], v[10:11], v[10:11] op_sel:[0,1,0] op_sel_hi:[1,1,0] neg_lo:[0,0,1] neg_hi:[0,0,1]
 v_pk_fma_f32 v[30:31], v[6:7], v[10:11], v[10:11] op_sel:[0,1,0] op_sel_hi:[1,1,0] neg_lo:[0,0,1] neg_hi:[0,0,1]
 v_pk_fma_f32 v[32:33], v[8:9], v[10:11], v[10:11] op_sel:[0,1,0] op_sel_hi:[1,1,0] neg_lo:[0,0,1] neg_hi:[0,0,1]
 v_cvt_pk_bf16_f32 v18, v26, v27
 v_cvt_pk_bf16_f32 v19, v28, v29
 v_cvt_pk_bf16_f32 v20, v30, v31
 v_cvt_pk_bf16_f32 v21, v32, v33
 v_min_u32 v18, -2, v18
 v_min_u32 v19, -2, v19
 v_min_u32 v20, -2, v20
 v_min_u32_e64 v21, -2, v21
 s_add_u32 s14, s76, 0
 buffer_store_dwordx4 v[18:21], v139, s[60:63], s14 offen
 v_add_u32 v66, 4294864896, v95
 v_add_u32 v67, 4294864896, v87
 v_add_u32 v68, 4294864896, v69
 ds_read_b64_tr_b16 v[160:161], v66 offset:0
 ds_read_b64_tr_b16 v[162:163], v66 offset:1536
 ds_read_b64_tr_b16 v[164:165], v67 offset:0
 ds_read_b64_tr_b16 v[166:167], v67 offset:1536
 ds_read_b64_tr_b16 v[168:169], v68 offset:0
 ds_read_b64_tr_b16 v[170:171], v68 offset:1536
 ds_read_b64_tr_b16 v[172:173], v66 offset:12288
 ds_read_b64_tr_b16 v[174:175], v66 offset:13824
 ds_read_b64_tr_b16 v[176:177], v67 offset:12288
 ds_read_b64_tr_b16 v[178:179], v67 offset:13824
 ds_read_b64_tr_b16 v[180:181], v68 offset:12288
 ds_read_b64_tr_b16 v[182:183], v68 offset:13824
 ds_read_b64_tr_b16 a[224:225], v66 offset:33792
 ds_read_b64_tr_b16 a[226:227], v66 offset:35328
 ds_read_b64_tr_b16 a[228:229], v67 offset:33792
 ds_read_b64_tr_b16 a[230:231], v67 offset:35328
 ds_read_b64_tr_b16 a[232:233], v68 offset:33792
 ds_read_b64_tr_b16 a[234:235], v68 offset:35328
 ds_read_b64_tr_b16 a[236:237], v66 offset:46080
 ds_read_b64_tr_b16 a[238:239], v66 offset:47616
 ds_read_b64_tr_b16 a[240:241], v67 offset:46080
 ds_read_b64_tr_b16 a[242:243], v67 offset:47616
 ds_read_b64_tr_b16 a[244:245], v68 offset:46080
 ds_read_b64_tr_b16 a[246:247], v68 offset:47616
 v_add_u32 v66, 4294941696, v95
 v_add_u32 v67, 4294941696, v87
 v_add_u32 v68, 4294941696, v69
 ds_read_b64_tr_b16 a[248:249], v66 offset:0
 ds_read_b64_tr_b16 a[250:251], v66 offset:1536
 ds_read_b64_tr_b16 a[252:253], v67 offset:0
 ds_read_b64_tr_b16 a[254:255], v67 offset:1536
 ds_read_b64_tr_b16 v[144:145], v68 offset:0
 ds_read_b64_tr_b16 v[146:147], v68 offset:1536
 ds_read_b64_tr_b16 v[148:149], v66 offset:12288
 ds_read_b64_tr_b16 v[150:151], v66 offset:13824
 ds_read_b64_tr_b16 v[152:153], v67 offset:12288
 ds_read_b64_tr_b16 v[154:155], v67 offset:13824
 ds_read_b64_tr_b16 v[156:157], v68 offset:12288
 ds_read_b64_tr_b16 v[158:159], v68 offset:13824
 v_cvt_pk_bf16_f32 v100, v2, v3
 v_cvt_pk_bf16_f32 v101, v4, v5
 v_cvt_pk_bf16_f32 v102, v6, v7
 v_cvt_pk_bf16_f32 v103, v8, v9
 s_waitcnt lgkmcnt(0)
 s_barrier
 v_pk_add_f32 v[42:43], v[34:35], v[36:37]
 v_pk_mul_f32 v[44:45], v[34:35], v[34:35]
 v_pk_add_f32 v[46:47], v[38:39], v[40:41]
 v_pk_fma_f32 v[44:45], v[36:37], v[36:37], v[44:45]
 v_pk_add_f32 v[42:43], v[42:43], v[46:47]
 v_pk_fma_f32 v[44:45], v[38:39], v[38:39], v[44:45]
 v_add_f32_e64 v42, v42, v43
 v_pk_fma_f32 v[44:45], v[40:41], v[40:41], v[44:45]
 s_add_u32 s86, s77, 0
 s_add_u32 s87, s78, 0
 s_add_u32 m0, s101, 0
 s_nop 0
 buffer_load_dwordx4 v138, s[60:63], s86 offen offset:0 sc1 lds
 s_add_u32 m0, s101, 32
 v_add_f32 v43, v44, v45
 v_add_f32_dpp v42, v42, v42 quad_perm:[1,0,3,2] row_mask:0xf bank_mask:0xf
 buffer_load_dwordx4 v138, s[60:63], s86 offen offset:1024 sc1 lds
 s_add_u32 m0, s101, 64
 v_add_f32_dpp v43, v43, v43 quad_perm:[1,0,3,2] row_mask:0xf bank_mask:0xf
 v_add_f32_dpp v42, v42, v42 quad_perm:[2,3,0,1] row_mask:0xf bank_mask:0xf
 s_nop 0
 v_add_f32_dpp v43, v43, v43 quad_perm:[2,3,0,1] row_mask:0xf bank_mask:0xf
 buffer_load_dwordx4 v138, s[60:63], s86 offen offset:2048 sc1 lds
 s_add_u32 m0, s101, 96
 v_add_f32_dpp v42, v42, v42 row_half_mirror row_mask:0xf bank_mask:0xf
 v_add_f32_dpp v43, v43, v43 row_half_mirror row_mask:0xf bank_mask:0xf
 s_nop 0
 v_add_f32_dpp v42, v42, v42 row_mirror row_mask:0xf bank_mask:0xf
 buffer_load_dwordx4 v138, s[60:63], s86 offen offset:3072 sc1 lds
 s_add_u32 m0, s101, 4224
 v_add_f32_dpp v43, v43, v43 row_mirror row_mask:0xf bank_mask:0xf
 v_add_f32_dpp v42, v42, v42 row_bcast:15 row_mask:0xa bank_mask:0xf
 s_nop 0
 v_add_f32_dpp v43, v43, v43 row_bcast:15 row_mask:0xa bank_mask:0xf
 buffer_load_dwordx4 v138, s[60:63], s87 offen offset:0 sc1 lds
 s_add_u32 m0, s101, 4256
 v_add_f32_dpp v42, v42, v42 row_bcast:31 row_mask:0xc bank_mask:0xf
 v_add_f32_dpp v43, v43, v43 row_bcast:31 row_mask:0xc bank_mask:0xf
 buffer_load_dwordx4 v138, s[60:63], s87 offen offset:1024 sc1 lds
 s_add_u32 m0, s101, 4288
 v_readlane_b32 s90, v42, 63
 v_readlane_b32 s91, v43, 63
 v_mov_b32_e64 v45, s96
 buffer_load_dwordx4 v138, s[60:63], s87 offen offset:2048 sc1 lds
 s_add_u32 m0, s101, 4320
 v_mul_f32 v42, s90, v45
 v_mul_f32 v43, s91, v45
 v_fma_f32 v43, -v42, v42, v43
 buffer_load_dwordx4 v138, s[60:63], s87 offen offset:3072 sc1 lds
 v_max_f32 v43, 0, v43
 v_add_f32 v43, 0x3727c5ac, v43
 v_rsq_f32 v43, v43
 s_add_u32 m0, s0, 139264
 s_add_u32 s94, s13, 88064
 buffer_load_dwordx4 v88, s[64:67], s94 offen offset:0 lds
 v_mul_f32_e64 v42, v42, v43
 v_pk_fma_f32 v[58:59], v[34:35], v[42:43], v[42:43] op_sel:[0,1,0] op_sel_hi:[1,1,0] neg_lo:[0,0,1] neg_hi:[0,0,1]
 buffer_load_dwordx4 v89, s[64:67], s94 offen offset:1024 lds
 v_pk_fma_f32 v[60:61], v[36:37], v[42:43], v[42:43] op_sel:[0,1,0] op_sel_hi:[1,1,0] neg_lo:[0,0,1] neg_hi:[0,0,1]
 v_pk_fma_f32 v[62:63], v[38:39], v[42:43], v[42:43] op_sel:[0,1,0] op_sel_hi:[1,1,0] neg_lo:[0,0,1] neg_hi:[0,0,1]
 buffer_load_dwordx4 v90, s[64:67], s94 offen offset:2048 lds
 s_add_u32 m0, s0, 151552
 s_add_u32 s94, s13, 176128
 v_pk_fma_f32 v[64:65], v[40:41], v[42:43], v[42:43] op_sel:[0,1,0] op_sel_hi:[1,1,0] neg_lo:[0,0,1] neg_hi:[0,0,1]
 v_cvt_pk_bf16_f32 v50, v58, v59
 buffer_load_dwordx4 v88, s[64:67], s94 offen offset:0 lds
 v_cvt_pk_bf16_f32 v51, v60, v61
 v_cvt_pk_bf16_f32 v52, v62, v63
 buffer_load_dwordx4 v89, s[64:67], s94 offen offset:1024 lds
 v_cvt_pk_bf16_f32 v53, v64, v65
 v_min_u32_e64 v50, -2, v50
 buffer_load_dwordx4 v90, s[64:67], s94 offen offset:2048 lds
 v_min_u32_e64 v51, -2, v51
 v_min_u32_e64 v52, -2, v52
 v_min_u32_e64 v53, -2, v53
 s_add_u32 s15, s76, 4096
 buffer_store_dwordx4 v[50:53], v139, s[60:63], s15 offen
 s_add_u32 m0, s0, 76800
 s_add_u32 s94, s13, 264192
 buffer_load_dwordx4 v88, s[64:67], s94 offen offset:0 lds
 v_cvt_pk_bf16_f32 v104, v34, v35
 buffer_load_dwordx4 v89, s[64:67], s94 offen offset:1024 lds
 v_cvt_pk_bf16_f32 v105, v36, v37
 buffer_load_dwordx4 v90, s[64:67], s94 offen offset:2048 lds
 v_cvt_pk_bf16_f32 v106, v38, v39
 v_cvt_pk_bf16_f32 v107, v40, v41
 s_waitcnt vmcnt(10)
 v_add_u32 v71, s101, v139
 ds_read_b128 v[2:5], v71 offset:0
 ds_read_b128 v[6:9], v71 offset:1056
 ds_read_b128 v[10:13], v71 offset:2112
 ds_read_b128 v[14:17], v71 offset:3168
 ds_read_b128 v[18:21], v71 offset:4224
 ds_read_b128 v[22:25], v71 offset:5280
 ds_read_b128 v[26:29], v71 offset:6336
 ds_read_b128 v[30:33], v71 offset:7392
 s_waitcnt lgkmcnt(0)
 v_max_u32 v70, v2, v3
 v_max3_u32 v70, v70, v4, v5
 v_max3_u32 v70, v70, v6, v7
 v_max3_u32 v70, v70, v8, v9
 v_max3_u32 v70, v70, v10, v11
 v_max3_u32 v70, v70, v12, v13
 v_max3_u32 v70, v70, v14, v15
 v_max3_u32 v70, v70, v16, v17
 v_max3_u32 v70, v70, v18, v19
 v_max3_u32 v70, v70, v20, v21
 v_max3_u32 v70, v70, v22, v23
 v_max3_u32 v70, v70, v24, v25
 v_max3_u32 v70, v70, v26, v27
 v_max3_u32 v70, v70, v28, v29
 v_max3_u32 v70, v70, v30, v31
 v_max3_u32 v70, v70, v32, v33
 v_cmp_eq_u32 vcc, -1, v70
 s_cbranch_vccnz Lrt_12
Lbk_13:
 s_or_b32 s14, s2, s3
 s_cmp_lg_u32 s14, 0
 s_nop 0
 s_cbranch_scc1 Lep_15
 buffer_store_dword v143, off, s[60:63], 0 sc0 sc1
Lep_15:
 s_waitcnt lgkmcnt(0)
 s_barrier
 ds_read_b128 v[50:53], v132 offset:0
 ds_read_b128 v[54:57], v132 offset:64
 ds_read_b128 v[58:61], v132 offset:128
 s_waitcnt lgkmcnt(1)
 v_mfma_f32_16x16x32_bf16 v[2:5], a[176:179], v[50:53], v[120:123]
 ds_read_b128 v[62:65], v132 offset:192
 ds_read_b64_tr_b16 v[184:185], v95 offset:0
 v_mfma_f32_16x16x32_bf16 v[6:9], a[180:183], v[50:53], v[124:127]
 ds_read_b64_tr_b16 v[186:187], v95 offset:1536
 ds_read_b64_tr_b16 v[188:189], v87 offset:0
 v_mfma_f32_16x16x32_bf16 v[10:13], a[184:187], v[50:53], v[128:131]
 ds_read_b64_tr_b16 v[190:191], v87 offset:1536
 ds_read_b64_tr_b16 v[192:193], v69 offset:0
 v_mfma_f32_16x16x32_bf16 v[2:5], a[188:191], v[54:57], v[2:5]
 ds_read_b128 v[50:53], v132 offset:256
 ds_read_b64_tr_b16 v[194:195], v69 offset:1536
 v_mfma_f32_16x16x32_bf16 v[6:9], a[192:195], v[54:57], v[6:9]
 ds_read_b64_tr_b16 v[196:197], v95 offset:12288
 ds_read_b64_tr_b16 v[198:199], v95 offset:13824
 v_mfma_f32_16x16x32_bf16 v[10:13], a[196:199], v[54:57], v[10:13]
 ds_read_b64_tr_b16 v[200:201], v87 offset:12288
 s_waitcnt lgkmcnt(10)
 v_mfma_f32_16x16x32_bf16 v[2:5], a[200:203], v[58:61], v[2:5]
 ds_read_b128 v[54:57], v132 offset:320
 ds_read_b64_tr_b16 v[202:203], v87 offset:13824
 v_mfma_f32_16x16x32_bf16 v[6:9], a[204:207], v[58:61], v[6:9]
 ds_read_b64_tr_b16 v[204:205], v69 offset:12288
 ds_read_b64_tr_b16 v[206:207], v69 offset:13824
 v_mfma_f32_16x16x32_bf16 v[10:13], a[208:211], v[58:61], v[10:13]
 s_add_u32 s86, s77, 4096
 s_add_u32 s87, s78, 4096
 s_add_u32 m0, s101, 33792
 v_mfma_f32_16x16x32_bf16 v[2:5], a[212:215], v[62:65], v[2:5]
 ds_read_b128 v[58:61], v132 offset:384
 buffer_load_dwordx4 v138, s[60:63], s86 offen offset:0 sc1 lds
 s_add_u32 m0, s101, 33824
 v_mfma_f32_16x16x32_bf16 v[6:9], a[216:219], v[62:65], v[6:9]
 ds_read_b64_tr_b16 v[208:209], v95 offset:24576
 ds_read_b64_tr_b16 v[210:211], v95 offset:26112
 v_mfma_f32_16x16x32_bf16 v[10:13], a[220:223], v[62:65], v[10:13]
 ds_read_b64_tr_b16 v[212:213], v87 offset:24576
 s_waitcnt lgkmcnt(7)
 v_mfma_f32_16x16x32_bf16 v[2:5], a[224:227], v[50:53], v[2:5]
 ds_read_b128 v[62:65], v132 offset:448
 ds_read_b64_tr_b16 v[214:215], v87 offset:26112
 v_mfma_f32_16x16x32_bf16 v[6:9], a[228:231], v[50:53], v[6:9]
 buffer_load_dwordx4 v138, s[60:63], s86 offen offset:1024 sc1 lds
 s_add_u32 m0, s101, 33856
 v_mfma_f32_16x16x32_bf16 v[10:13], a[232:235], v[50:53], v[10:13]
 ds_read_b64_tr_b16 v[216:217], v69 offset:24576
 ds_read_b64_tr_b16 v[218:219], v69 offset:26112
 v_mfma_f32_16x16x32_bf16 v[2:5], a[236:239], v[54:57], v[2:5]
 ds_read_b128 v[50:53], v132 offset:512
 v_mfma_f32_16x16x32_bf16 v[6:9], a[240:243], v[54:57], v[6:9]
 s_waitcnt vmcnt(2)
 s_barrier
 v_mfma_f32_16x16x32_bf16 v[10:13], a[244:247], v[54:57], v[10:13]
 ds_read_b64_tr_b16 v[220:221], v95 offset:36864
 ds_read_b64_tr_b16 v[222:223], v95 offset:38400
 buffer_load_dwordx4 v138, s[60:63], s86 offen offset:2048 sc1 lds
 s_add_u32 m0, s101, 33888
 s_waitcnt lgkmcnt(6)
 v_mfma_f32_16x16x32_bf16 v[2:5], a[248:251], v[58:61], v[2:5]
 ds_read_b128 v[54:57], v132 offset:576
 ds_read_b64_tr_b16 v[224:225], v87 offset:36864
 ds_read_b64_tr_b16 v[226:227], v87 offset:38400
 v_mfma_f32_16x16x32_bf16 v[6:9], a[252:255], v[58:61], v[6:9]
 ds_read_b64_tr_b16 v[228:229], v69 offset:36864
 ds_read_b64_tr_b16 v[230:231], v69 offset:38400
 v_mfma_f32_16x16x32_bf16 v[10:13], v[144:147], v[58:61], v[10:13]
 ds_read_b64_tr_b16 v[232:233], v95 offset:49152
 ds_read_b64_tr_b16 v[234:235], v95 offset:50688
 v_mfma_f32_16x16x32_bf16 v[2:5], v[148:151], v[62:65], v[2:5]
 ds_read_b128 v[58:61], v132 offset:640
 ds_read_b64_tr_b16 v[236:237], v87 offset:49152
 ds_read_b64_tr_b16 v[238:239], v87 offset:50688
 buffer_load_dwordx4 v138, s[60:63], s86 offen offset:3072 sc1 lds
 s_add_u32 m0, s101, 38016
 v_mfma_f32_16x16x32_bf16 v[6:9], v[152:155], v[62:65], v[6:9]
 ds_read_b64_tr_b16 v[240:241], v69 offset:49152
 ds_read_b64_tr_b16 v[242:243], v69 offset:50688
 v_mfma_f32_16x16x32_bf16 v[10:13], v[156:159], v[62:65], v[10:13]
 v_add_u32 v84, 4294941696, v95
 v_add_u32 v85, 4294941696, v87
 s_waitcnt lgkmcnt(11)
 v_mfma_f32_16x16x32_bf16 v[2:5], v[160:163], v[50:53], v[2:5]
 ds_read_b128 v[62:65], v132 offset:704
 v_add_u32 v86, 4294941696, v69
 ds_read_b64_tr_b16 v[244:245], v84 offset:0
 v_mfma_f32_16x16x32_bf16 v[6:9], v[164:167], v[50:53], v[6:9]
 ds_read_b64_tr_b16 v[246:247], v84 offset:1536
 ds_read_b64_tr_b16 v[248:249], v85 offset:0
 buffer_load_dwordx4 v138, s[60:63], s87 offen offset:0 sc1 lds
 s_add_u32 m0, s101, 38048
 v_mfma_f32_16x16x32_bf16 v[10:13], v[168:171], v[50:53], v[10:13]
 ds_read_b64_tr_b16 v[250:251], v85 offset:1536
 ds_read_b64_tr_b16 v[252:253], v86 offset:0
 v_mfma_f32_16x16x32_bf16 v[2:5], v[172:175], v[54:57], v[2:5]
 ds_read_b128 v[50:53], v132 offset:768
 ds_read_b64_tr_b16 v[254:255], v86 offset:1536
 v_mfma_f32_16x16x32_bf16 v[6:9], v[176:179], v[54:57], v[6:9]
 v_mfma_f32_16x16x32_bf16 v[10:13], v[180:183], v[54:57], v[10:13]
 buffer_load_dwordx4 v138, s[60:63], s87 offen offset:1024 sc1 lds
 s_add_u32 m0, s101, 38080
 s_waitcnt lgkmcnt(7)
 v_mfma_f32_16x16x32_bf16 v[2:5], v[184:187], v[58:61], v[2:5]
 ds_read_b128 v[54:57], v132 offset:832
 v_mfma_f32_16x16x32_bf16 v[6:9], v[188:191], v[58:61], v[6:9]
 v_mfma_f32_16x16x32_bf16 v[10:13], v[192:195], v[58:61], v[10:13]
 v_mfma_f32_16x16x32_bf16 v[2:5], v[196:199], v[62:65], v[2:5]
 ds_read_b128 v[58:61], v132 offset:896
 buffer_load_dwordx4 v138, s[60:63], s87 offen offset:2048 sc1 lds
 s_add_u32 m0, s101, 38112
 v_mfma_f32_16x16x32_bf16 v[6:9], v[200:203], v[62:65], v[6:9]
 v_mfma_f32_16x16x32_bf16 v[10:13], v[204:207], v[62:65], v[10:13]
 s_waitcnt lgkmcnt(1)
 v_mfma_f32_16x16x32_bf16 v[2:5], v[208:211], v[50:53], v[2:5]
 ds_read_b128 v[62:65], v132 offset:960
 v_mfma_f32_16x16x32_bf16 v[6:9], v[212:215], v[50:53], v[6:9]
 s_waitcnt lgkmcnt(0)
 s_barrier
 buffer_load_dwordx4 v138, s[60:63], s87 offen offset:3072 sc1 lds
 v_add_u32 v75, s101, v139
 v_mfma_f32_16x16x32_bf16 v[10:13], v[216:219], v[50:53], v[10:13]
 s_waitcnt vmcnt(4)
 ds_read_b128 v[66:69], v75 offset:33792
 v_mfma_f32_16x16x32_bf16 v[2:5], v[220:223], v[54:57], v[2:5]
 ds_read_b128 v[50:53], v132 offset:16896
 ds_read_b128 v[70:73], v75 offset:34848
 ds_read_b128 v[76:79], v75 offset:35904
 s_add_u32 m0, s84, 0
 v_mfma_f32_16x16x32_bf16 v[6:9], v[224:227], v[54:57], v[6:9]
 ds_read_b128 v[80:83], v75 offset:36960
 buffer_load_dwordx4 v91, s[68:71], s18 offen offset:0 lds
 v_mfma_f32_16x16x32_bf16 v[10:13], v[228:231], v[54:57], v[10:13]
 v_mfma_f32_16x16x32_bf16 v[2:5], v[232:235], v[58:61], v[2:5]
 ds_read_b128 v[54:57], v132 offset:16960
 v_mfma_f32_16x16x32_bf16 v[6:9], v[236:239], v[58:61], v[6:9]
 v_mfma_f32_16x16x32_bf16 v[10:13], v[240:243], v[58:61], v[10:13]
 v_mfma_f32_16x16x32_bf16 v[2:5], v[244:247], v[62:65], v[2:5]
 ds_read_b128 v[58:61], v132 offset:17024
 buffer_load_dwordx4 v92, s[68:71], s18 offen offset:1024 lds
 v_mfma_f32_16x16x32_bf16 v[6:9], v[248:251], v[62:65], v[6:9]
 s_waitcnt lgkmcnt(2)
 v_max_u32_e64 v74, v66, v67
 v_max3_u32 v74, v74, v68, v69
 v_mfma_f32_16x16x32_bf16 v[10:13], v[252:255], v[62:65], v[10:13]
 v_max3_u32 v74, v74, v70, v71
 v_max3_u32 v74, v74, v72, v73
 s_waitcnt lgkmcnt(1)
 v_mfma_f32_16x16x32_bf16 v[14:17], a[176:179], v[50:53], v[120:123]
 ds_read_b128 v[62:65], v132 offset:17088
 v_max3_u32 v74, v74, v76, v77
 v_max3_u32 v74, v74, v78, v79
 v_mfma_f32_16x16x32_bf16 v[18:21], a[180:183], v[50:53], v[124:127]
 v_max3_u32 v74, v74, v80, v81
 v_max3_u32 v74, v74, v82, v83
 v_mfma_f32_16x16x32_bf16 v[22:25], a[184:187], v[50:53], v[128:131]
 buffer_load_dwordx4 v93, s[68:71], s18 offen offset:2048 lds
 v_mul_f32_e64 v66, v2, v2
 v_mfma_f32_16x16x32_bf16 v[14:17], a[188:191], v[54:57], v[14:17]
 ds_read_b128 v[50:53], v132 offset:17152
 v_mul_f32_e64 v67, v3, v3
 v_mfma_f32_16x16x32_bf16 v[18:21], a[192:195], v[54:57], v[18:21]
 v_mul_f32_e64 v68, v4, v4
 v_mul_f32 v69, v5, v5
 v_mfma_f32_16x16x32_bf16 v[22:25], a[196:199], v[54:57], v[22:25]
 v_fma_f32 v66, v66, s100, v140
 s_waitcnt lgkmcnt(1)
 v_mfma_f32_16x16x32_bf16 v[14:17], a[200:203], v[58:61], v[14:17]
 ds_read_b128 v[54:57], v132 offset:17216
 v_fma_f32 v67, v67, s100, v140
 v_mfma_f32_16x16x32_bf16 v[18:21], a[204:207], v[58:61], v[18:21]
 buffer_load_dwordx4 v94, s[68:71], s18 offen offset:3072 lds
 s_add_u32 m0, s84, 4096
 v_mfma_f32_16x16x32_bf16 v[22:25], a[208:211], v[58:61], v[22:25]
 v_fma_f32 v68, v68, s100, v140
 v_fma_f32 v69, v69, s100, v140
 v_mfma_f32_16x16x32_bf16 v[14:17], a[212:215], v[62:65], v[14:17]
 ds_read_b128 v[58:61], v132 offset:17280
 v_mul_f32_e64 v66, v66, v2
 v_mfma_f32_16x16x32_bf16 v[18:21], a[216:219], v[62:65], v[18:21]
 s_waitcnt vmcnt(4)
 ds_read_b128 v[76:79], v75 offset:38016
 v_mfma_f32_16x16x32_bf16 v[22:25], a[220:223], v[62:65], v[22:25]
 ds_read_b128 v[80:83], v75 offset:39072
 s_waitcnt lgkmcnt(3)
 v_mfma_f32_16x16x32_bf16 v[14:17], a[224:227], v[50:53], v[14:17]
 ds_read_b128 v[62:65], v132 offset:17344
 buffer_load_dwordx4 v91, s[68:71], s19 offen offset:0 lds
 v_mfma_f32_16x16x32_bf16 v[18:21], a[228:231], v[50:53], v[18:21]
 v_mul_f32 v67, v67, v3
 v_mul_f32 v68, v68, v4
 v_mfma_f32_16x16x32_bf16 v[22:25], a[232:235], v[50:53], v[22:25]
 v_mul_f32_e64 v69, v69, v5
 v_mfma_f32_16x16x32_bf16 v[14:17], a[236:239], v[54:57], v[14:17]
 ds_read_b128 v[50:53], v132 offset:17408
 v_mfma_f32_16x16x32_bf16 v[18:21], a[240:243], v[54:57], v[18:21]
 v_exp_f32_e64 v66, v66
 v_mfma_f32_16x16x32_bf16 v[22:25], a[244:247], v[54:57], v[22:25]
 s_waitcnt lgkmcnt(2)
 v_max3_u32 v74, v74, v76, v77
 v_max3_u32 v74, v74, v78, v79
 s_waitcnt lgkmcnt(1)
 v_mfma_f32_16x16x32_bf16 v[14:17], a[248:251], v[58:61], v[14:17]
 ds_read_b128 v[54:57], v132 offset:17472
 v_max3_u32 v74, v74, v80, v81
 v_max3_u32 v74, v74, v82, v83
 v_mfma_f32_16x16x32_bf16 v[18:21], a[252:255], v[58:61], v[18:21]
 ds_read_b128 v[76:79], v75 offset:40128
 ds_read_b128 v[80:83], v75 offset:41184
 v_mfma_f32_16x16x32_bf16 v[22:25], v[144:147], v[58:61], v[22:25]
 v_exp_f32_e64 v67, v67
 v_mfma_f32_16x16x32_bf16 v[14:17], v[148:151], v[62:65], v[14:17]
 ds_read_b128 v[58:61], v132 offset:17536
 v_add_f32 v66, 1.0, v66
 v_mfma_f32_16x16x32_bf16 v[18:21], v[152:155], v[62:65], v[18:21]
 v_exp_f32 v68, v68
 v_mfma_f32_16x16x32_bf16 v[22:25], v[156:159], v[62:65], v[22:25]
 v_add_f32 v67, 1.0, v67
 s_waitcnt lgkmcnt(3)
 v_mfma_f32_16x16x32_bf16 v[14:17], v[160:163], v[50:53], v[14:17]
 ds_read_b128 v[62:65], v132 offset:17600
 v_add_f32 v68, 1.0, v68
 v_mfma_f32_16x16x32_bf16 v[18:21], v[164:167], v[50:53], v[18:21]
 v_exp_f32_e64 v69, v69
 v_mfma_f32_16x16x32_bf16 v[22:25], v[168:171], v[50:53], v[22:25]
 s_waitcnt lgkmcnt(2)
 v_max3_u32 v74, v74, v76, v77
 v_max3_u32 v74, v74, v78, v79
 v_mfma_f32_16x16x32_bf16 v[14:17], v[172:175], v[54:57], v[14:17]
 ds_read_b128 v[50:53], v132 offset:17664
 v_max3_u32 v74, v74, v80, v81
 v_max3_u32 v74, v74, v82, v83
 buffer_load_dwordx4 v92, s[68:71], s19 offen offset:1024 lds
 v_mfma_f32_16x16x32_bf16 v[18:21], v[176:179], v[54:57], v[18:21]
 v_cmp_eq_u32 vcc, -1, v74
 s_cbranch_vccnz Lrt_16
Lbk_17:
 v_mfma_f32_16x16x32_bf16 v[22:25], v[180:183], v[54:57], v[22:25]
 s_barrier
 s_waitcnt lgkmcnt(1)
 v_mfma_f32_16x16x32_bf16 v[14:17], v[184:187], v[58:61], v[14:17]
 ds_read_b128 v[54:57], v132 offset:17728
 v_add_f32 v69, 1.0, v69
 v_mfma_f32_16x16x32_bf16 v[18:21], v[188:191], v[58:61], v[18:21]
 v_rcp_f32 v66, v66
 v_mfma_f32_16x16x32_bf16 v[22:25], v[192:195], v[58:61], v[22:25]
 v_rcp_f32 v67, v67
 v_mfma_f32_16x16x32_bf16 v[14:17], v[196:199], v[62:65], v[14:17]
 ds_read_b128 v[58:61], v132 offset:17792
 v_mul_f32 v66, v66, v2
 v_mfma_f32_16x16x32_bf16 v[18:21], v[200:203], v[62:65], v[18:21]
 v_rcp_f32 v68, v68
 v_mfma_f32_16x16x32_bf16 v[22:25], v[204:207], v[62:65], v[22:25]
 v_mul_f32_e64 v67, v67, v3
 s_waitcnt lgkmcnt(1)
 v_mfma_f32_16x16x32_bf16 v[14:17], v[208:211], v[50:53], v[14:17]
 ds_read_b128 v[62:65], v132 offset:17856
 v_mul_f32 v68, v68, v4
 v_mfma_f32_16x16x32_bf16 v[18:21], v[212:215], v[50:53], v[18:21]
 v_rcp_f32 v69, v69
 v_mfma_f32_16x16x32_bf16 v[22:25], v[216:219], v[50:53], v[22:25]
 v_mul_f32_e64 v69, v69, v5
 v_cvt_pk_bf16_f32 v66, v66, v67
 v_mfma_f32_16x16x32_bf16 v[14:17], v[220:223], v[54:57], v[14:17]
 ds_read_b128 v[50:53], v132 offset:33792
 v_cvt_pk_bf16_f32 v67, v68, v69
 v_mfma_f32_16x16x32_bf16 v[18:21], v[224:227], v[54:57], v[18:21]
 ds_write_b64 v133, v[66:67] offset:0
 v_mul_f32_e64 v70, v6, v6
 v_mfma_f32_16x16x32_bf16 v[22:25], v[228:231], v[54:57], v[22:25]
 v_mul_f32 v71, v7, v7
 s_waitcnt lgkmcnt(2)
 v_mfma_f32_16x16x32_bf16 v[14:17], v[232:235], v[58:61], v[14:17]
 ds_read_b128 v[54:57], v132 offset:33856
 buffer_load_dwordx4 v93, s[68:71], s19 offen offset:2048 lds
 v_mfma_f32_16x16x32_bf16 v[18:21], v[236:239], v[58:61], v[18:21]
 v_mul_f32 v72, v8, v8
 v_mul_f32 v73, v9, v9
 v_mfma_f32_16x16x32_bf16 v[22:25], v[240:243], v[58:61], v[22:25]
 v_fma_f32 v70, v70, s100, v140
 v_fma_f32 v71, v71, s100, v140
 v_mfma_f32_16x16x32_bf16 v[14:17], v[244:247], v[62:65], v[14:17]
 ds_read_b128 v[58:61], v132 offset:33920
 v_fma_f32 v72, v72, s100, v140
 v_mfma_f32_16x16x32_bf16 v[18:21], v[248:251], v[62:65], v[18:21]
 v_fma_f32 v73, v73, s100, v140
 v_mul_f32_e64 v70, v70, v6
 v_mfma_f32_16x16x32_bf16 v[22:25], v[252:255], v[62:65], v[22:25]
 v_mul_f32 v71, v71, v7
 v_mul_f32_e64 v72, v72, v8
 s_waitcnt lgkmcnt(1)
 v_mfma_f32_16x16x32_bf16 v[26:29], a[176:179], v[50:53], v[120:123]
 ds_read_b128 v[62:65], v132 offset:33984
 v_mul_f32 v73, v73, v9
 v_mfma_f32_16x16x32_bf16 v[30:33], a[180:183], v[50:53], v[124:127]
 v_exp_f32 v70, v70
 v_mfma_f32_16x16x32_bf16 v[34:37], a[184:187], v[50:53], v[128:131]
 v_exp_f32 v71, v71
 v_mfma_f32_16x16x32_bf16 v[26:29], a[188:191], v[54:57], v[26:29]
 ds_read_b128 v[50:53], v132 offset:34048
 v_add_f32 v70, 1.0, v70
 v_mfma_f32_16x16x32_bf16 v[30:33], a[192:195], v[54:57], v[30:33]
 v_exp_f32 v72, v72
 v_mfma_f32_16x16x32_bf16 v[34:37], a[196:199], v[54:57], v[34:37]
 v_add_f32_e64 v71, 1.0, v71
 s_waitcnt lgkmcnt(1)
 v_mfma_f32_16x16x32_bf16 v[26:29], a[200:203], v[58:61], v[26:29]
 ds_read_b128 v[54:57], v132 offset:34112
 v_add_f32 v72, 1.0, v72
 v_mfma_f32_16x16x32_bf16 v[30:33], a[204:207], v[58:61], v[30:33]
 v_exp_f32 v73, v73
 v_mfma_f32_16x16x32_bf16 v[34:37], a[208:211], v[58:61], v[34:37]
 v_add_f32_e64 v73, 1.0, v73
 v_mfma_f32_16x16x32_bf16 v[26:29], a[212:215], v[62:65], v[26:29]
 ds_read_b128 v[58:61], v132 offset:34176
 buffer_load_dwordx4 v94, s[68:71], s19 offen offset:3072 lds
 s_add_u32 m0, s84, 8192
 v_mfma_f32_16x16x32_bf16 v[30:33], a[216:219], v[62:65], v[30:33]
 v_rcp_f32 v70, v70
 v_mfma_f32_16x16x32_bf16 v[34:37], a[220:223], v[62:65], v[34:37]
 v_mul_f32 v70, v70, v6
 s_waitcnt lgkmcnt(1)
 v_mfma_f32_16x16x32_bf16 v[26:29], a[224:227], v[50:53], v[26:29]
 ds_read_b128 v[62:65], v132 offset:34240
 v_mfma_f32_16x16x32_bf16 v[30:33], a[228:231], v[50:53], v[30:33]
 v_rcp_f32 v71, v71
 v_mfma_f32_16x16x32_bf16 v[34:37], a[232:235], v[50:53], v[34:37]
 v_rcp_f32 v72, v72
 v_mfma_f32_16x16x32_bf16 v[26:29], a[236:239], v[54:57], v[26:29]
 ds_read_b128 v[50:53], v132 offset:34304
 v_mul_f32 v71, v71, v7
 v_mfma_f32_16x16x32_bf16 v[30:33], a[240:243], v[54:57], v[30:33]
 v_rcp_f32 v73, v73
 v_mfma_f32_16x16x32_bf16 v[34:37], a[244:247], v[54:57], v[34:37]
 v_mul_f32_e64 v72, v72, v8
 s_waitcnt lgkmcnt(1)
 v_mfma_f32_16x16x32_bf16 v[26:29], a[248:251], v[58:61], v[26:29]
 ds_read_b128 v[54:57], v132 offset:34368
 v_mul_f32_e64 v73, v73, v9
 v_mfma_f32_16x16x32_bf16 v[30:33], a[252:255], v[58:61], v[30:33]
 v_cvt_pk_bf16_f32 v70, v70, v71
 v_cvt_pk_bf16_f32 v71, v72, v73
 v_mfma_f32_16x16x32_bf16 v[34:37], v[144:147], v[58:61], v[34:37]
 ds_write_b64 v133, v[70:71] offset:32
 v_mul_f32 v66, v10, v10
 v_mfma_f32_16x16x32_bf16 v[26:29], v[148:151], v[62:65], v[26:29]
 ds_read_b128 v[58:61], v132 offset:34432
 v_mul_f32 v67, v11, v11
 v_mfma_f32_16x16x32_bf16 v[30:33], v[152:155], v[62:65], v[30:33]
 v_mul_f32 v68, v12, v12
 v_mul_f32_e64 v69, v13, v13
 v_mfma_f32_16x16x32_bf16 v[34:37], v[156:159], v[62:65], v[34:37]
 v_fma_f32 v66, v66, s100, v140
 s_waitcnt lgkmcnt(2)
 v_mfma_f32_16x16x32_bf16 v[26:29], v[160:163], v[50:53], v[26:29]
 ds_read_b128 v[62:65], v132 offset:34496
 buffer_load_dwordx4 v91, s[68:71], s20 offen offset:0 lds
 v_mfma_f32_16x16x32_bf16 v[30:33], v[164:167], v[50:53], v[30:33]
 v_fma_f32 v67, v67, s100, v140
 v_fma_f32 v68, v68, s100, v140
 v_mfma_f32_16x16x32_bf16 v[34:37], v[168:171], v[50:53], v[34:37]
 v_fma_f32 v69, v69, s100, v140
 v_mul_f32 v66, v66, v10
 v_mfma_f32_16x16x32_bf16 v[26:29], v[172:175], v[54:57], v[26:29]
 ds_read_b128 v[50:53], v132 offset:34560
 v_mul_f32 v67, v67, v11
 v_mfma_f32_16x16x32_bf16 v[30:33], v[176:179], v[54:57], v[30:33]
 v_mul_f32 v68, v68, v12
 v_mul_f32_e64 v69, v69, v13
 v_mfma_f32_16x16x32_bf16 v[34:37], v[180:183], v[54:57], v[34:37]
 s_waitcnt lgkmcnt(1)
 v_mfma_f32_16x16x32_bf16 v[26:29], v[184:187], v[58:61], v[26:29]
 ds_read_b128 v[54:57], v132 offset:34624
 v_mfma_f32_16x16x32_bf16 v[30:33], v[188:191], v[58:61], v[30:33]
 v_exp_f32 v66, v66
 v_mfma_f32_16x16x32_bf16 v[34:37], v[192:195], v[58:61], v[34:37]
 v_exp_f32 v67, v67
 v_mfma_f32_16x16x32_bf16 v[26:29], v[196:199], v[62:65], v[26:29]
 ds_read_b128 v[58:61], v132 offset:34688
 v_add_f32 v66, 1.0, v66
 v_mfma_f32_16x16x32_bf16 v[30:33], v[200:203], v[62:65], v[30:33]
 v_exp_f32 v68, v68
 v_mfma_f32_16x16x32_bf16 v[34:37], v[204:207], v[62:65], v[34:37]
 v_add_f32 v67, 1.0, v67
 s_waitcnt lgkmcnt(1)
 v_mfma_f32_16x16x32_bf16 v[26:29], v[208:211], v[50:53], v[26:29]
 ds_read_b128 v[62:65], v132 offset:34752
 v_add_f32 v68, 1.0, v68
 v_mfma_f32_16x16x32_bf16 v[30:33], v[212:215], v[50:53], v[30:33]
 v_exp_f32 v69, v69
 v_mfma_f32_16x16x32_bf16 v[34:37], v[216:219], v[50:53], v[34:37]
 v_add_f32_e64 v69, 1.0, v69
 v_mfma_f32_16x16x32_bf16 v[26:29], v[220:223], v[54:57], v[26:29]
 ds_read_b128 v[50:53], v132 offset:50688
 buffer_load_dwordx4 v92, s[68:71], s20 offen offset:1024 lds
 v_mfma_f32_16x16x32_bf16 v[30:33], v[224:227], v[54:57], v[30:33]
 v_rcp_f32 v66, v66
 v_mfma_f32_16x16x32_bf16 v[34:37], v[228:231], v[54:57], v[34:37]
 v_mul_f32_e64 v66, v66, v10
 s_waitcnt lgkmcnt(1)
 v_mfma_f32_16x16x32_bf16 v[26:29], v[232:235], v[58:61], v[26:29]
 ds_read_b128 v[54:57], v132 offset:50752
 v_mfma_f32_16x16x32_bf16 v[30:33], v[236:239], v[58:61], v[30:33]
 v_rcp_f32 v67, v67
 v_mfma_f32_16x16x32_bf16 v[34:37], v[240:243], v[58:61], v[34:37]
 v_rcp_f32 v68, v68
 v_mfma_f32_16x16x32_bf16 v[26:29], v[244:247], v[62:65], v[26:29]
 ds_read_b128 v[58:61], v132 offset:50816
 v_mul_f32 v67, v67, v11
 v_mfma_f32_16x16x32_bf16 v[30:33], v[248:251], v[62:65], v[30:33]
 v_rcp_f32 v69, v69
 v_mfma_f32_16x16x32_bf16 v[34:37], v[252:255], v[62:65], v[34:37]
 v_mul_f32 v68, v68, v12
 v_mul_f32_e64 v69, v69, v13
 s_waitcnt lgkmcnt(1)
 v_mfma_f32_16x16x32_bf16 v[38:41], a[176:179], v[50:53], v[120:123]
 ds_read_b128 v[62:65], v132 offset:50880
 v_cvt_pk_bf16_f32 v66, v66, v67
 v_mfma_f32_16x16x32_bf16 v[42:45], a[180:183], v[50:53], v[124:127]
 v_cvt_pk_bf16_f32 v67, v68, v69
 ds_write_b64 v133, v[66:67] offset:64
 v_mfma_f32_16x16x32_bf16 v[46:49], a[184:187], v[50:53], v[128:131]
 v_mul_f32_e64 v70, v14, v14
 v_mul_f32_e64 v71, v15, v15
 v_mfma_f32_16x16x32_bf16 v[38:41], a[188:191], v[54:57], v[38:41]
 ds_read_b128 v[50:53], v132 offset:50944
 v_mul_f32_e64 v72, v16, v16
 v_mfma_f32_16x16x32_bf16 v[42:45], a[192:195], v[54:57], v[42:45]
 v_mul_f32 v73, v17, v17
 v_fma_f32 v70, v70, s100, v140
 v_mfma_f32_16x16x32_bf16 v[46:49], a[196:199], v[54:57], v[46:49]
 v_fma_f32 v71, v71, s100, v140
 s_waitcnt lgkmcnt(2)
 v_mfma_f32_16x16x32_bf16 v[38:41], a[200:203], v[58:61], v[38:41]
 ds_read_b128 v[54:57], v132 offset:51008
 buffer_load_dwordx4 v93, s[68:71], s20 offen offset:2048 lds
 v_mfma_f32_16x16x32_bf16 v[42:45], a[204:207], v[58:61], v[42:45]
 v_fma_f32 v72, v72, s100, v140
 v_fma_f32 v73, v73, s100, v140
 v_mfma_f32_16x16x32_bf16 v[46:49], a[208:211], v[58:61], v[46:49]
 v_mul_f32 v70, v70, v14
 v_mul_f32 v71, v71, v15
 v_mfma_f32_16x16x32_bf16 v[38:41], a[212:215], v[62:65], v[38:41]
 ds_read_b128 v[58:61], v132 offset:51072
 v_mul_f32_e64 v72, v72, v16
 v_mfma_f32_16x16x32_bf16 v[42:45], a[216:219], v[62:65], v[42:45]
 v_mul_f32 v73, v73, v17
 v_mfma_f32_16x16x32_bf16 v[46:49], a[220:223], v[62:65], v[46:49]
 s_waitcnt lgkmcnt(1)
 v_mfma_f32_16x16x32_bf16 v[38:41], a[224:227], v[50:53], v[38:41]
 ds_read_b128 v[62:65], v132 offset:51136
 v_mfma_f32_16x16x32_bf16 v[42:45], a[228:231], v[50:53], v[42:45]
 v_exp_f32 v70, v70
 v_mfma_f32_16x16x32_bf16 v[46:49], a[232:235], v[50:53], v[46:49]
 v_exp_f32 v71, v71
 v_mfma_f32_16x16x32_bf16 v[38:41], a[236:239], v[54:57], v[38:41]
 ds_read_b128 v[50:53], v132 offset:51200
 v_add_f32 v70, 1.0, v70
 v_mfma_f32_16x16x32_bf16 v[42:45], a[240:243], v[54:57], v[42:45]
 v_exp_f32 v72, v72
 v_mfma_f32_16x16x32_bf16 v[46:49], a[244:247], v[54:57], v[46:49]
 v_add_f32 v71, 1.0, v71
 s_waitcnt lgkmcnt(1)
 v_mfma_f32_16x16x32_bf16 v[38:41], a[248:251], v[58:61], v[38:41]
 ds_read_b128 v[54:57], v132 offset:51264
 v_add_f32_e64 v72, 1.0, v72
 v_mfma_f32_16x16x32_bf16 v[42:45], a[252:255], v[58:61], v[42:45]
 v_exp_f32 v73, v73
 v_mfma_f32_16x16x32_bf16 v[46:49], v[144:147], v[58:61], v[46:49]
 v_add_f32 v73, 1.0, v73
 v_mfma_f32_16x16x32_bf16 v[38:41], v[148:151], v[62:65], v[38:41]
 ds_read_b128 v[58:61], v132 offset:51328
 buffer_load_dwordx4 v94, s[68:71], s20 offen offset:3072 lds
 v_mfma_f32_16x16x32_bf16 v[42:45], v[152:155], v[62:65], v[42:45]
 v_rcp_f32_e64 v70, v70
 v_mfma_f32_16x16x32_bf16 v[46:49], v[156:159], v[62:65], v[46:49]
 v_mul_f32 v70, v70, v14
 s_waitcnt lgkmcnt(1)
 v_mfma_f32_16x16x32_bf16 v[38:41], v[160:163], v[50:53], v[38:41]
 ds_read_b128 v[62:65], v132 offset:51392
 v_mfma_f32_16x16x32_bf16 v[42:45], v[164:167], v[50:53], v[42:45]
 v_rcp_f32 v71, v71
 v_mfma_f32_16x16x32_bf16 v[46:49], v[168:171], v[50:53], v[46:49]
 v_rcp_f32 v72, v72
 v_mfma_f32_16x16x32_bf16 v[38:41], v[172:175], v[54:57], v[38:41]
 ds_read_b128 v[50:53], v132 offset:51456
 v_mul_f32_e64 v71, v71, v15
 v_mfma_f32_16x16x32_bf16 v[42:45], v[176:179], v[54:57], v[42:45]
 v_rcp_f32_e64 v73, v73
 v_mfma_f32_16x16x32_bf16 v[46:49], v[180:183], v[54:57], v[46:49]
 v_mul_f32 v72, v72, v16
 s_waitcnt lgkmcnt(1)
 v_mfma_f32_16x16x32_bf16 v[38:41], v[184:187], v[58:61], v[38:41]
 ds_read_b128 v[54:57], v132 offset:51520
 v_mul_f32_e64 v73, v73, v17
 v_mfma_f32_16x16x32_bf16 v[42:45], v[188:191], v[58:61], v[42:45]
 v_cvt_pk_bf16_f32 v70, v70, v71
 v_cvt_pk_bf16_f32 v71, v72, v73
 v_mfma_f32_16x16x32_bf16 v[46:49], v[192:195], v[58:61], v[46:49]
 ds_write_b64 v133, v[70:71] offset:6400
 v_mul_f32_e64 v66, v18, v18
 v_mfma_f32_16x16x32_bf16 v[38:41], v[196:199], v[62:65], v[38:41]
 ds_read_b128 v[58:61], v132 offset:51584
 v_mul_f32_e64 v67, v19, v19
 v_mfma_f32_16x16x32_bf16 v[42:45], v[200:203], v[62:65], v[42:45]
 v_mul_f32_e64 v68, v20, v20
 v_mul_f32 v69, v21, v21
 v_mfma_f32_16x16x32_bf16 v[46:49], v[204:207], v[62:65], v[46:49]
 v_fma_f32 v66, v66, s100, v140
 s_waitcnt lgkmcnt(2)
 v_mfma_f32_16x16x32_bf16 v[38:41], v[208:211], v[50:53], v[38:41]
 ds_read_b128 v[62:65], v132 offset:51648
 v_fma_f32 v67, v67, s100, v140
 v_mfma_f32_16x16x32_bf16 v[42:45], v[212:215], v[50:53], v[42:45]
 v_fma_f32 v68, v68, s100, v140
 v_fma_f32 v69, v69, s100, v140
 v_mfma_f32_16x16x32_bf16 v[46:49], v[216:219], v[50:53], v[46:49]
 v_mul_f32 v66, v66, v18
 v_mul_f32 v67, v67, v19
 v_mfma_f32_16x16x32_bf16 v[38:41], v[220:223], v[54:57], v[38:41]
 v_mul_f32 v68, v68, v20
 v_mul_f32 v69, v69, v21
 v_mfma_f32_16x16x32_bf16 v[42:45], v[224:227], v[54:57], v[42:45]
 v_exp_f32 v66, v66
 v_mfma_f32_16x16x32_bf16 v[46:49], v[228:231], v[54:57], v[46:49]
 v_add_f32 v66, 1.0, v66
 s_waitcnt lgkmcnt(0)
 v_mfma_f32_16x16x32_bf16 v[38:41], v[232:235], v[58:61], v[38:41]
 v_exp_f32 v67, v67
 v_mfma_f32_16x16x32_bf16 v[42:45], v[236:239], v[58:61], v[42:45]
 v_exp_f32_e64 v68, v68
 v_mfma_f32_16x16x32_bf16 v[46:49], v[240:243], v[58:61], v[46:49]
 v_exp_f32 v69, v69
 v_mfma_f32_16x16x32_bf16 v[38:41], v[244:247], v[62:65], v[38:41]
 v_add_f32 v67, 1.0, v67
 v_add_f32_e64 v68, 1.0, v68
 v_mfma_f32_16x16x32_bf16 v[42:45], v[248:251], v[62:65], v[42:45]
 v_add_f32 v69, 1.0, v69
 v_mfma_f32_16x16x32_bf16 v[46:49], v[252:255], v[62:65], v[46:49]
 v_rcp_f32 v66, v66
 v_rcp_f32 v67, v67
 v_rcp_f32 v68, v68
 v_rcp_f32 v69, v69
 v_mul_f32 v66, v66, v18
 v_mul_f32 v67, v67, v19
 v_mul_f32 v68, v68, v20
 v_mul_f32_e64 v69, v69, v21
 v_cvt_pk_bf16_f32 v66, v66, v67
 v_cvt_pk_bf16_f32 v67, v68, v69
 ds_write_b64 v133, v[66:67] offset:6432
 v_pk_mul_f32 v[70:71], v[22:23], v[22:23]
 v_pk_mul_f32 v[72:73], v[24:25], v[24:25]
 v_pk_fma_f32 v[70:71], v[70:71], s[100:101], v[140:141] op_sel_hi:[1,0,0]
 v_pk_fma_f32 v[72:73], v[72:73], s[100:101], v[140:141] op_sel_hi:[1,0,0]
 v_pk_mul_f32 v[70:71], v[70:71], v[22:23]
 v_pk_mul_f32 v[72:73], v[72:73], v[24:25]
 v_exp_f32 v70, v70
 v_exp_f32 v71, v71
 v_exp_f32 v72, v72
 v_exp_f32 v73, v73
 v_pk_add_f32 v[70:71], v[70:71], 1.0 op_sel_hi:[1,0]
 v_pk_add_f32 v[72:73], v[72:73], 1.0 op_sel_hi:[1,0]
 v_rcp_f32 v70, v70
 v_rcp_f32 v71, v71
 v_rcp_f32_e64 v72, v72
 v_rcp_f32_e64 v73, v73
 v_pk_mul_f32 v[70:71], v[70:71], v[22:23]
 v_pk_mul_f32 v[72:73], v[72:73], v[24:25]
 v_cvt_pk_bf16_f32 v70, v70, v71
 v_cvt_pk_bf16_f32 v71, v72, v73
 ds_write_b64 v133, v[70:71] offset:6464
 s_waitcnt lgkmcnt(0)
 s_barrier
 s_mov_b32 s88, s79
 s_add_u32 s89, s79, 0x1000
 v_mov_b32 v82, -1
 v_mov_b32_e64 v83, -1
 v_mov_b32_e64 v84, -1
 v_mov_b32_e64 v85, -1
 s_add_u32 s14, s76, 0x2000
 s_add_u32 s15, s76, 0x3000
 s_add_u32 m0, s1, 0
 s_nop 0
 buffer_load_dwordx4 v91, s[68:71], s21 offen offset:0 lds
 v_pk_mul_f32 v[66:67], v[26:27], v[26:27]
 buffer_load_dwordx4 v92, s[68:71], s21 offen offset:1024 lds
 v_pk_mul_f32 v[70:71], v[30:31], v[30:31]
 buffer_load_dwordx4 v93, s[68:71], s21 offen offset:2048 lds
 v_pk_mul_f32 v[68:69], v[28:29], v[28:29]
 buffer_load_dwordx4 v94, s[68:71], s21 offen offset:3072 lds
 v_pk_mul_f32 v[72:73], v[32:33], v[32:33]
 s_waitcnt vmcnt(12)
 ds_read_b64_tr_b16 a[128:129], v96 offset:0
 ds_read_b64_tr_b16 a[130:131], v96 offset:1024
 ds_read_b64_tr_b16 a[132:133], v97 offset:0
 ds_read_b64_tr_b16 a[134:135], v97 offset:1024
 ds_read_b64_tr_b16 a[136:137], v98 offset:0
 ds_read_b64_tr_b16 a[138:139], v98 offset:1024
 ds_read_b64_tr_b16 a[140:141], v99 offset:0
 ds_read_b64_tr_b16 a[142:143], v99 offset:1024
 s_add_u32 m0, s1, 4096
 s_nop 0
 buffer_load_dwordx4 v91, s[68:71], s24 offen offset:0 lds
 buffer_store_dwordx4 v[82:85], v139, s[60:63], s14 offen
 v_pk_fma_f32 v[66:67], v[66:67], s[100:101], v[140:141] op_sel_hi:[1,0,0]
 buffer_load_dwordx4 v92, s[68:71], s24 offen offset:1024 lds
 v_pk_fma_f32 v[70:71], v[70:71], s[100:101], v[140:141] op_sel_hi:[1,0,0]
 buffer_load_dwordx4 v93, s[68:71], s24 offen offset:2048 lds
 v_pk_fma_f32 v[68:69], v[68:69], s[100:101], v[140:141] op_sel_hi:[1,0,0]
 buffer_load_dwordx4 v94, s[68:71], s24 offen offset:3072 lds
 v_pk_fma_f32 v[72:73], v[72:73], s[100:101], v[140:141] op_sel_hi:[1,0,0]
 s_waitcnt vmcnt(13)
 ds_read_b64_tr_b16 a[144:145], v96 offset:4096
 ds_read_b64_tr_b16 a[146:147], v96 offset:5120
 ds_read_b64_tr_b16 a[148:149], v97 offset:4096
 ds_read_b64_tr_b16 a[150:151], v97 offset:5120
 ds_read_b64_tr_b16 a[152:153], v98 offset:4096
 ds_read_b64_tr_b16 a[154:155], v98 offset:5120
 ds_read_b64_tr_b16 a[156:157], v99 offset:4096
 ds_read_b64_tr_b16 a[158:159], v99 offset:5120
 s_add_u32 m0, s1, 8192
 s_nop 0
 buffer_load_dwordx4 v91, s[68:71], s17 offen offset:0 lds
 v_pk_mul_f32 v[66:67], v[66:67], v[26:27]
 buffer_load_dwordx4 v92, s[68:71], s17 offen offset:1024 lds
 v_pk_mul_f32 v[70:71], v[70:71], v[30:31]
 v_pk_mul_f32 v[68:69], v[68:69], v[28:29]
 buffer_load_dwordx4 v93, s[68:71], s17 offen offset:2048 lds
 v_pk_mul_f32 v[72:73], v[72:73], v[32:33]
 buffer_load_dwordx4 v94, s[68:71], s17 offen offset:3072 lds
 s_add_u32 m0, s1, 12288
 v_exp_f32_e64 v66, v66
 buffer_load_dwordx4 v91, s[68:71], s16 offen offset:0 lds
 v_exp_f32_e64 v70, v70
 buffer_load_dwordx4 v92, s[68:71], s16 offen offset:1024 lds
 v_exp_f32_e64 v67, v67
 buffer_load_dwordx4 v93, s[68:71], s16 offen offset:2048 lds
 v_exp_f32_e64 v71, v71
 v_exp_f32_e64 v68, v68
 buffer_load_dwordx4 v94, s[68:71], s16 offen offset:3072 lds
 v_exp_f32 v72, v72
 s_waitcnt lgkmcnt(0)
 s_add_u32 m0, s84, 0
 s_nop 0
 buffer_load_dwordx4 v91, s[68:71], s22 offen offset:0 lds
 v_exp_f32_e64 v69, v69
 buffer_load_dwordx4 v92, s[68:71], s22 offen offset:1024 lds
 v_exp_f32 v73, v73
 buffer_load_dwordx4 v93, s[68:71], s22 offen offset:2048 lds
 v_pk_add_f32 v[66:67], v[66:67], 1.0 op_sel_hi:[1,0]
 v_pk_add_f32 v[70:71], v[70:71], 1.0 op_sel_hi:[1,0]
 buffer_load_dwordx4 v94, s[68:71], s22 offen offset:3072 lds
 v_pk_add_f32 v[68:69], v[68:69], 1.0 op_sel_hi:[1,0]
 s_waitcnt vmcnt(21)
 ds_read_b64_tr_b16 a[160:161], v96 offset:8192
 ds_read_b64_tr_b16 a[162:163], v96 offset:9216
 ds_read_b64_tr_b16 a[164:165], v97 offset:8192
 ds_read_b64_tr_b16 a[166:167], v97 offset:9216
 ds_read_b64_tr_b16 a[168:169], v98 offset:8192
 ds_read_b64_tr_b16 a[170:171], v98 offset:9216
 ds_read_b64_tr_b16 a[172:173], v99 offset:8192
 ds_read_b64_tr_b16 a[174:175], v99 offset:9216
 s_add_u32 m0, s84, 4096
 s_nop 0
 buffer_load_dwordx4 v91, s[68:71], s23 offen offset:0 lds
 v_pk_add_f32 v[72:73], v[72:73], 1.0 op_sel_hi:[1,0]
 buffer_load_dwordx4 v92, s[68:71], s23 offen offset:1024 lds
 v_rcp_f32 v66, v66
 buffer_load_dwordx4 v93, s[68:71], s23 offen offset:2048 lds
 v_rcp_f32 v70, v70
 buffer_load_dwordx4 v94, s[68:71], s23 offen offset:3072 lds
 s_sub_u32 s94, s1, s84
 v_rcp_f32 v67, v67
 v_rcp_f32 v71, v71
 v_add_u32 v76, s94, v96
 v_add_u32_e64 v77, s94, v97
 v_add_u32_e64 v78, s94, v98
 v_add_u32_e64 v79, s94, v99
 s_waitcnt vmcnt(21)
 ds_read_b64_tr_b16 a[0:1], v76 offset:0
 ds_read_b64_tr_b16 a[2:3], v76 offset:1024
 ds_read_b64_tr_b16 a[32:33], v77 offset:0
 ds_read_b64_tr_b16 a[34:35], v77 offset:1024
 ds_read_b64_tr_b16 a[64:65], v78 offset:0
 ds_read_b64_tr_b16 a[66:67], v78 offset:1024
 ds_read_b64_tr_b16 a[96:97], v79 offset:0
 ds_read_b64_tr_b16 a[98:99], v79 offset:1024
 s_waitcnt lgkmcnt(0)
 s_add_u32 m0, s84, 8192
 s_nop 0
 buffer_load_dwordx4 v91, s[68:71], s25 offen offset:0 lds
 v_rcp_f32_e64 v68, v68
 buffer_load_dwordx4 v92, s[68:71], s25 offen offset:1024 lds
 v_rcp_f32 v72, v72
 buffer_load_dwordx4 v93, s[68:71], s25 offen offset:2048 lds
 v_rcp_f32 v69, v69
 buffer_load_dwordx4 v94, s[68:71], s25 offen offset:3072 lds
 s_sub_u32 s94, s1, s84
 v_rcp_f32 v73, v73
 v_add_u32 v76, s94, v96
 v_add_u32 v77, s94, v97
 v_add_u32 v78, s94, v98
 v_add_u32_e64 v79, s94, v99
 s_waitcnt vmcnt(20)
 ds_read_b64_tr_b16 a[12:13], v76 offset:4096
 ds_read_b64_tr_b16 a[14:15], v76 offset:5120
 ds_read_b64_tr_b16 a[44:45], v77 offset:4096
 ds_read_b64_tr_b16 a[46:47], v77 offset:5120
 ds_read_b64_tr_b16 a[76:77], v78 offset:4096
 ds_read_b64_tr_b16 a[78:79], v78 offset:5120
 ds_read_b64_tr_b16 a[108:109], v79 offset:4096
 ds_read_b64_tr_b16 a[110:111], v79 offset:5120
 s_add_u32 m0, s1, 0
 s_nop 0
 buffer_load_dwordx4 v91, s[68:71], s30 offen offset:0 lds
 v_pk_mul_f32 v[66:67], v[66:67], v[26:27]
 v_pk_mul_f32 v[70:71], v[70:71], v[30:31]
 buffer_load_dwordx4 v92, s[68:71], s30 offen offset:1024 lds
 v_pk_mul_f32 v[68:69], v[68:69], v[28:29]
 buffer_load_dwordx4 v93, s[68:71], s30 offen offset:2048 lds
 v_pk_mul_f32 v[72:73], v[72:73], v[32:33]
 buffer_load_dwordx4 v94, s[68:71], s30 offen offset:3072 lds
 s_sub_u32 s94, s1, s84
 v_cvt_pk_bf16_f32 v66, v66, v67
 v_add_u32 v76, s94, v96
 v_add_u32 v77, s94, v97
 v_add_u32 v78, s94, v98
 v_add_u32 v79, s94, v99
 s_waitcnt vmcnt(20)
 ds_read_b64_tr_b16 a[24:25], v76 offset:8192
 ds_read_b64_tr_b16 a[26:27], v76 offset:9216
 ds_read_b64_tr_b16 a[56:57], v77 offset:8192
 ds_read_b64_tr_b16 a[58:59], v77 offset:9216
 ds_read_b64_tr_b16 a[88:89], v78 offset:8192
 ds_read_b64_tr_b16 a[90:91], v78 offset:9216
 ds_read_b64_tr_b16 a[120:121], v79 offset:8192
 ds_read_b64_tr_b16 a[122:123], v79 offset:9216
 s_sub_u32 s94, s1, s84
 v_add_u32 v76, s94, v96
 v_add_u32 v77, s94, v97
 v_add_u32 v78, s94, v98
 v_add_u32 v79, s94, v99
 s_waitcnt vmcnt(16)
 ds_read_b64_tr_b16 a[20:21], v76 offset:12288
 ds_read_b64_tr_b16 a[22:23], v76 offset:13312
 ds_read_b64_tr_b16 a[52:53], v77 offset:12288
 ds_read_b64_tr_b16 a[54:55], v77 offset:13312
 ds_read_b64_tr_b16 a[84:85], v78 offset:12288
 ds_read_b64_tr_b16 a[86:87], v78 offset:13312
 ds_read_b64_tr_b16 a[116:117], v79 offset:12288
 ds_read_b64_tr_b16 a[118:119], v79 offset:13312
 v_cvt_pk_bf16_f32 v70, v70, v71
 v_cvt_pk_bf16_f32 v67, v68, v69
 v_bfe_u32 v86, v1, 3, 2
 v_lshlrev_b32 v86, 13, v86
 v_and_b32 v87, 7, v1
 v_lshl_add_u32 v86, v87, 7, v86
 v_and_b32 v87, 3, v1
 v_lshlrev_b32 v87, 9, v87
 buffer_load_dword v0, v87, s[60:63], s82 offen sc1
 s_add_u32 s14, s80, 4096
 buffer_load_dword v0, v86, s[60:63], s14 offen sc1
 v_cvt_pk_bf16_f32 v71, v72, v73
 buffer_store_dwordx4 v[82:85], v139, s[60:63], s15 offen
 ds_write_b64 v133, v[66:67] offset:12800
 ds_write_b64 v133, v[70:71] offset:12832
 v_pk_mul_f32 v[66:67], v[34:35], v[34:35]
 v_pk_mul_f32 v[70:71], v[38:39], v[38:39]
 v_pk_mul_f32 v[68:69], v[36:37], v[36:37]
 v_pk_mul_f32 v[72:73], v[40:41], v[40:41]
 v_pk_fma_f32 v[66:67], v[66:67], s[100:101], v[140:141] op_sel_hi:[1,0,0]
 v_pk_fma_f32 v[70:71], v[70:71], s[100:101], v[140:141] op_sel_hi:[1,0,0]
 v_pk_fma_f32 v[68:69], v[68:69], s[100:101], v[140:141] op_sel_hi:[1,0,0]
 v_pk_fma_f32 v[72:73], v[72:73], s[100:101], v[140:141] op_sel_hi:[1,0,0]
 v_pk_mul_f32 v[66:67], v[66:67], v[34:35]
 v_pk_mul_f32 v[70:71], v[70:71], v[38:39]
 v_pk_mul_f32 v[68:69], v[68:69], v[36:37]
 v_pk_mul_f32 v[72:73], v[72:73], v[40:41]
 v_exp_f32 v66, v66
 v_exp_f32 v70, v70
 v_exp_f32 v67, v67
 v_exp_f32 v71, v71
 v_exp_f32 v68, v68
 v_exp_f32 v72, v72
 v_exp_f32 v69, v69
 v_exp_f32 v73, v73
 v_pk_add_f32 v[66:67], v[66:67], 1.0 op_sel_hi:[1,0]
 v_pk_add_f32 v[70:71], v[70:71], 1.0 op_sel_hi:[1,0]
 v_pk_add_f32 v[68:69], v[68:69], 1.0 op_sel_hi:[1,0]
 v_pk_add_f32 v[72:73], v[72:73], 1.0 op_sel_hi:[1,0]
 v_rcp_f32 v66, v66
 v_rcp_f32 v70, v70
 v_rcp_f32 v67, v67
 v_rcp_f32 v71, v71
 v_rcp_f32 v68, v68
 v_rcp_f32 v72, v72
 v_rcp_f32 v69, v69
 v_rcp_f32 v73, v73
 v_pk_mul_f32 v[66:67], v[66:67], v[34:35]
 v_pk_mul_f32 v[70:71], v[70:71], v[38:39]
 v_pk_mul_f32 v[68:69], v[68:69], v[36:37]
 v_pk_mul_f32 v[72:73], v[72:73], v[40:41]
 v_cvt_pk_bf16_f32 v66, v66, v67
 v_cvt_pk_bf16_f32 v70, v70, v71
 v_cvt_pk_bf16_f32 v67, v68, v69
 v_cvt_pk_bf16_f32 v71, v72, v73
 ds_write_b64 v133, v[66:67] offset:12864
 ds_write_b64 v133, v[70:71] offset:19200
 s_waitcnt vmcnt(15)
 ds_read_b64_tr_b16 a[4:5], v96 offset:0
 ds_read_b64_tr_b16 a[6:7], v96 offset:1024
 ds_read_b64_tr_b16 a[36:37], v97 offset:0
 ds_read_b64_tr_b16 a[38:39], v97 offset:1024
 ds_read_b64_tr_b16 a[68:69], v98 offset:0
 ds_read_b64_tr_b16 a[70:71], v98 offset:1024
 ds_read_b64_tr_b16 a[100:101], v99 offset:0
 ds_read_b64_tr_b16 a[102:103], v99 offset:1024
 s_waitcnt vmcnt(11)
 ds_read_b64_tr_b16 a[8:9], v96 offset:4096
 ds_read_b64_tr_b16 a[10:11], v96 offset:5120
 ds_read_b64_tr_b16 a[40:41], v97 offset:4096
 ds_read_b64_tr_b16 a[42:43], v97 offset:5120
 ds_read_b64_tr_b16 a[72:73], v98 offset:4096
 ds_read_b64_tr_b16 a[74:75], v98 offset:5120
 ds_read_b64_tr_b16 a[104:105], v99 offset:4096
 ds_read_b64_tr_b16 a[106:107], v99 offset:5120
 s_waitcnt vmcnt(7)
 ds_read_b64_tr_b16 a[16:17], v96 offset:8192
 ds_read_b64_tr_b16 a[18:19], v96 offset:9216
 ds_read_b64_tr_b16 a[48:49], v97 offset:8192
 ds_read_b64_tr_b16 a[50:51], v97 offset:9216
 ds_read_b64_tr_b16 a[80:81], v98 offset:8192
 ds_read_b64_tr_b16 a[82:83], v98 offset:9216
 ds_read_b64_tr_b16 a[112:113], v99 offset:8192
 ds_read_b64_tr_b16 a[114:115], v99 offset:9216
 s_sub_u32 s94, s1, s84
 v_add_u32 v76, s94, v96
 v_add_u32 v77, s94, v97
 v_add_u32 v78, s94, v98
 v_add_u32_e64 v79, s94, v99
 s_waitcnt vmcnt(3)
 ds_read_b64_tr_b16 a[28:29], v76 offset:0
 ds_read_b64_tr_b16 a[30:31], v76 offset:1024
 ds_read_b64_tr_b16 a[60:61], v77 offset:0
 ds_read_b64_tr_b16 a[62:63], v77 offset:1024
 ds_read_b64_tr_b16 a[92:93], v78 offset:0
 ds_read_b64_tr_b16 a[94:95], v78 offset:1024
 ds_read_b64_tr_b16 a[124:125], v79 offset:0
 ds_read_b64_tr_b16 a[126:127], v79 offset:1024
 s_waitcnt lgkmcnt(0)
 ds_read_b128 v[74:77], v134 offset:0
 ds_read_b128 v[78:81], v134 offset:32
 ds_read_b128 v[82:85], v134 offset:64
 ds_read_b128 v[88:91], v134 offset:96
 ds_read_b128 v[92:95], v134 offset:128
 v_mul_f32 v66, v42, v42
 v_mul_f32 v67, v43, v43
 v_mul_f32 v68, v44, v44
 v_mul_f32_e64 v69, v45, v45
 v_fma_f32 v66, v66, s100, v140
 v_fma_f32 v67, v67, s100, v140
 v_fma_f32 v68, v68, s100, v140
 v_fma_f32 v69, v69, s100, v140
 v_mul_f32 v66, v66, v42
 v_mul_f32 v67, v67, v43
 v_mul_f32 v68, v68, v44
 v_mul_f32 v69, v69, v45
 v_exp_f32 v66, v66
 v_exp_f32 v67, v67
 v_exp_f32 v68, v68
 v_exp_f32 v69, v69
 s_waitcnt lgkmcnt(3)
 v_mfma_f32_32x32x16_bf16 v[2:17], a[128:131], v[74:77], 0
 ds_read_b128 v[96:99], v134 offset:160
 v_add_f32 v66, 1.0, v66
 v_add_f32 v67, 1.0, v67
 v_add_f32 v68, 1.0, v68
 v_add_f32 v69, 1.0, v69
 v_mfma_f32_32x32x16_bf16 v[2:17], a[144:147], v[78:81], v[2:17]
 ds_read_b128 v[74:77], v134 offset:192
 v_rcp_f32 v66, v66
 v_rcp_f32 v67, v67
 s_waitcnt lgkmcnt(3)
 v_mfma_f32_32x32x16_bf16 v[2:17], a[160:163], v[82:85], v[2:17]
 ds_read_b128 v[78:81], v134 offset:224
 v_rcp_f32 v68, v68
 v_rcp_f32 v69, v69
 v_mul_f32_e64 v66, v66, v42
 v_mfma_f32_32x32x16_bf16 v[2:17], a[0:3], v[88:91], v[2:17]
 ds_read_b128 v[82:85], v134 offset:256
 v_mul_f32_e64 v67, v67, v43
 v_mul_f32_e64 v68, v68, v44
 v_mul_f32 v69, v69, v45
 v_cvt_pk_bf16_f32 v66, v66, v67
 s_waitcnt lgkmcnt(3)
 v_mfma_f32_32x32x16_bf16 v[2:17], a[4:7], v[92:95], v[2:17]
 ds_read_b128 v[88:91], v134 offset:288
 s_add_u32 s14, s80, 36864
 buffer_load_dword v0, v86, s[60:63], s14 offen sc1
 v_cvt_pk_bf16_f32 v67, v68, v69
 ds_write_b64 v133, v[66:67] offset:19232
 v_mul_f32 v70, v46, v46
 v_mfma_f32_32x32x16_bf16 v[2:17], a[8:11], v[96:99], v[2:17]
 ds_read_b128 v[92:95], v134 offset:320
 v_mul_f32 v71, v47, v47
 v_mul_f32_e64 v72, v48, v48
 v_mul_f32 v73, v49, v49
 v_fma_f32 v70, v70, s100, v140
 s_waitcnt lgkmcnt(4)
 v_mfma_f32_32x32x16_bf16 v[2:17], a[12:15], v[74:77], v[2:17]
 ds_read_b128 v[96:99], v134 offset:0
 v_fma_f32 v71, v71, s100, v140
 v_fma_f32 v72, v72, s100, v140
 v_fma_f32 v73, v73, s100, v140
 v_mul_f32 v70, v70, v46
 v_mul_f32 v71, v71, v47
 v_mfma_f32_32x32x16_bf16 v[2:17], a[16:19], v[78:81], v[2:17]
 ds_read_b128 v[74:77], v134 offset:32
 v_mul_f32 v72, v72, v48
 v_mul_f32 v73, v73, v49
 v_exp_f32 v70, v70
 s_waitcnt lgkmcnt(4)
 v_mfma_f32_32x32x16_bf16 v[2:17], a[20:23], v[82:85], v[2:17]
 ds_read_b128 v[78:81], v134 offset:64
 v_exp_f32 v71, v71
 v_exp_f32 v72, v72
 v_add_f32_e64 v70, 1.0, v70
 v_mfma_f32_32x32x16_bf16 v[2:17], a[24:27], v[88:91], v[2:17]
 ds_read_b128 v[82:85], v134 offset:96
 v_exp_f32 v73, v73
 v_add_f32 v71, 1.0, v71
 v_add_f32 v72, 1.0, v72
 s_waitcnt lgkmcnt(3)
 v_mfma_f32_32x32x16_bf16 v[2:17], a[28:31], v[92:95], v[2:17]
 ds_read_b128 v[88:91], v134 offset:128
 v_add_f32 v73, 1.0, v73
 v_rcp_f32 v70, v70
 v_rcp_f32_e64 v71, v71
 v_mfma_f32_32x32x16_bf16 v[50:65], a[132:135], v[96:99], 0
 ds_read_b128 v[92:95], v134 offset:160
 v_rcp_f32 v72, v72
 v_rcp_f32_e64 v73, v73
 s_waitcnt lgkmcnt(3)
 v_mfma_f32_32x32x16_bf16 v[50:65], a[148:151], v[74:77], v[50:65]
 ds_read_b128 v[96:99], v134 offset:192
 v_mul_f32 v70, v70, v46
 v_mul_f32 v71, v71, v47
 v_mul_f32_e64 v72, v72, v48
 v_mul_f32 v73, v73, v49
 v_cvt_pk_bf16_f32 v70, v70, v71
 v_mfma_f32_32x32x16_bf16 v[50:65], a[164:167], v[78:81], v[50:65]
 ds_read_b128 v[74:77], v134 offset:224
 v_cvt_pk_bf16_f32 v18, v2, v3
 v_cvt_pk_bf16_f32 v19, v4, v5
 v_cvt_pk_bf16_f32 v20, v6, v7
 v_cvt_pk_bf16_f32 v21, v8, v9
 s_waitcnt lgkmcnt(3)
 v_mfma_f32_32x32x16_bf16 v[50:65], a[32:35], v[82:85], v[50:65]
 ds_read_b128 v[78:81], v134 offset:256
 v_permlane32_swap_b32 v18, v20
 v_permlane32_swap_b32 v19, v21
 v_cvt_pk_bf16_f32 v71, v72, v73
 v_mfma_f32_32x32x16_bf16 v[50:65], a[36:39], v[88:91], v[50:65]
 ds_read_b128 v[82:85], v134 offset:288
 ds_write_b64 v133, v[70:71] offset:19264
 s_waitcnt lgkmcnt(4)
 v_mfma_f32_32x32x16_bf16 v[50:65], a[40:43], v[92:95], v[50:65]
 ds_read_b128 v[88:91], v134 offset:320
 buffer_store_dwordx4 v[18:21], v135, s[60:63], s88 offen offset:0
 v_mfma_f32_32x32x16_bf16 v[50:65], a[44:47], v[96:99], v[50:65]
 ds_read_b128 v[92:95], v134 offset:0
 s_waitcnt lgkmcnt(4)
 v_mfma_f32_32x32x16_bf16 v[50:65], a[48:51], v[74:77], v[50:65]
 ds_read_b128 v[96:99], v134 offset:32
 v_cvt_pk_bf16_f32 v22, v10, v11
 v_cvt_pk_bf16_f32 v23, v12, v13
 v_cvt_pk_bf16_f32 v24, v14, v15
 v_cvt_pk_bf16_f32 v25, v16, v17
 v_mfma_f32_32x32x16_bf16 v[50:65], a[52:55], v[78:81], v[50:65]
 ds_read_b128 v[74:77], v134 offset:64
 v_permlane32_swap_b32 v22, v24
 v_permlane32_swap_b32 v23, v25
 s_waitcnt lgkmcnt(3)
 v_mfma_f32_32x32x16_bf16 v[50:65], a[56:59], v[82:85], v[50:65]
 ds_read_b128 v[78:81], v134 offset:96
 v_mfma_f32_32x32x16_bf16 v[50:65], a[60:63], v[88:91], v[50:65]
 ds_read_b128 v[82:85], v134 offset:128
 buffer_store_dwordx4 v[22:25], v135, s[60:63], s88 offen offset:128
 s_waitcnt lgkmcnt(3)
 v_mfma_f32_32x32x16_bf16 v[2:17], a[136:139], v[92:95], 0
 ds_read_b128 v[88:91], v134 offset:160
 v_mfma_f32_32x32x16_bf16 v[2:17], a[152:155], v[96:99], v[2:17]
 ds_read_b128 v[92:95], v134 offset:192
 s_waitcnt lgkmcnt(3)
 v_mfma_f32_32x32x16_bf16 v[2:17], a[168:171], v[74:77], v[2:17]
 ds_read_b128 v[96:99], v134 offset:224
 s_nop 1
 v_cvt_pk_bf16_f32 v18, v50, v51
 v_cvt_pk_bf16_f32 v19, v52, v53
 v_cvt_pk_bf16_f32 v20, v54, v55
 v_cvt_pk_bf16_f32 v21, v56, v57
 v_mfma_f32_32x32x16_bf16 v[2:17], a[64:67], v[78:81], v[2:17]
 ds_read_b128 v[74:77], v134 offset:256
 v_permlane32_swap_b32 v18, v20
 v_permlane32_swap_b32 v19, v21
 s_waitcnt lgkmcnt(3)
 v_mfma_f32_32x32x16_bf16 v[2:17], a[68:71], v[82:85], v[2:17]
 ds_read_b128 v[78:81], v134 offset:288
 v_mfma_f32_32x32x16_bf16 v[2:17], a[72:75], v[88:91], v[2:17]
 ds_read_b128 v[82:85], v134 offset:320
 buffer_store_dwordx4 v[18:21], v135, s[60:63], s88 offen offset:256
 s_waitcnt lgkmcnt(3)
 v_mfma_f32_32x32x16_bf16 v[2:17], a[76:79], v[92:95], v[2:17]
 ds_read_b128 v[88:91], v134 offset:0
 v_mfma_f32_32x32x16_bf16 v[2:17], a[80:83], v[96:99], v[2:17]
 ds_read_b128 v[92:95], v134 offset:32
 v_cvt_pk_bf16_f32 v22, v58, v59
 v_cvt_pk_bf16_f32 v23, v60, v61
 v_cvt_pk_bf16_f32 v24, v62, v63
 v_cvt_pk_bf16_f32 v25, v64, v65
 s_waitcnt lgkmcnt(3)
 v_mfma_f32_32x32x16_bf16 v[2:17], a[84:87], v[74:77], v[2:17]
 ds_read_b128 v[96:99], v134 offset:64
 v_permlane32_swap_b32 v22, v24
 v_permlane32_swap_b32 v23, v25
 v_mfma_f32_32x32x16_bf16 v[2:17], a[88:91], v[78:81], v[2:17]
 ds_read_b128 v[74:77], v134 offset:96
 s_waitcnt lgkmcnt(3)
 v_mfma_f32_32x32x16_bf16 v[2:17], a[92:95], v[82:85], v[2:17]
 ds_read_b128 v[78:81], v134 offset:128
 buffer_store_dwordx4 v[22:25], v135, s[60:63], s88 offen offset:384
 v_mfma_f32_32x32x16_bf16 v[50:65], a[140:143], v[88:91], 0
 ds_read_b128 v[82:85], v134 offset:160
 s_waitcnt lgkmcnt(3)
 v_mfma_f32_32x32x16_bf16 v[50:65], a[156:159], v[92:95], v[50:65]
 ds_read_b128 v[88:91], v134 offset:192
 v_bfe_u32 v87, v1, 3, 1
 v_lshlrev_b32 v87, 5, v87
 v_and_or_b32 v87, v1, 7, v87
 v_lshlrev_b32_e64 v87, 7, v87
 s_add_u32 s12, s76, 8192
 buffer_load_dword v0, v87, s[60:63], s12 offen sc1
 v_mfma_f32_32x32x16_bf16 v[50:65], a[172:175], v[96:99], v[50:65]
 ds_read_b128 v[92:95], v134 offset:224
 v_cvt_pk_bf16_f32 v18, v2, v3
 v_cvt_pk_bf16_f32 v19, v4, v5
 v_cvt_pk_bf16_f32 v20, v6, v7
 v_cvt_pk_bf16_f32 v21, v8, v9
 s_waitcnt lgkmcnt(3)
 v_mfma_f32_32x32x16_bf16 v[50:65], a[96:99], v[74:77], v[50:65]
 ds_read_b128 v[96:99], v134 offset:256
 v_permlane32_swap_b32 v18, v20
 v_permlane32_swap_b32 v19, v21
 v_mfma_f32_32x32x16_bf16 v[50:65], a[100:103], v[78:81], v[50:65]
 ds_read_b128 v[74:77], v134 offset:288
 s_waitcnt lgkmcnt(3)
 v_mfma_f32_32x32x16_bf16 v[50:65], a[104:107], v[82:85], v[50:65]
 ds_read_b128 v[78:81], v134 offset:320
 buffer_store_dwordx4 v[18:21], v135, s[60:63], s88 offen offset:512
 v_mfma_f32_32x32x16_bf16 v[50:65], a[108:111], v[88:91], v[50:65]
 s_lshl_b32 s12, s5, 2
 s_add_u32 s12, s12, s3
 s_lshl_b32 s12, s12, 9
 v_lshrrev_b32 v87, 4, v1
 v_lshl_add_u32 v87, v87, 7, s12
 v_min_u32 v87, Lslow-Lpc, v87
 global_load_dword v0, v87, s[28:29]
 s_waitcnt lgkmcnt(2)
 v_mfma_f32_32x32x16_bf16 v[50:65], a[112:115], v[92:95], v[50:65]
 v_cvt_pk_bf16_f32 v22, v10, v11
 v_cvt_pk_bf16_f32 v23, v12, v13
 v_cvt_pk_bf16_f32 v24, v14, v15
 v_cvt_pk_bf16_f32 v25, v16, v17
 v_mfma_f32_32x32x16_bf16 v[50:65], a[116:119], v[96:99], v[50:65]
 v_permlane32_swap_b32 v22, v24
 v_permlane32_swap_b32 v23, v25
 s_waitcnt lgkmcnt(0)
 v_mfma_f32_32x32x16_bf16 v[50:65], a[120:123], v[74:77], v[50:65]
 v_mfma_f32_32x32x16_bf16 v[50:65], a[124:127], v[78:81], v[50:65]
 buffer_store_dwordx4 v[22:25], v135, s[60:63], s88 offen offset:640
 s_waitcnt lgkmcnt(0)
 s_barrier
 ds_read_b128 v[74:77], v134 offset:12800
 ds_read_b128 v[78:81], v134 offset:12832
 ds_read_b128 v[82:85], v134 offset:12864
 ds_read_b128 v[26:29], v134 offset:12896
 ds_read_b128 v[30:33], v134 offset:12928
 s_waitcnt lgkmcnt(3)
 v_mfma_f32_32x32x16_bf16 v[2:17], a[128:131], v[74:77], 0
 ds_read_b128 v[34:37], v134 offset:12960
 s_nop 0
 v_cvt_pk_bf16_f32 v18, v50, v51
 v_cvt_pk_bf16_f32 v19, v52, v53
 v_cvt_pk_bf16_f32 v20, v54, v55
 v_cvt_pk_bf16_f32 v21, v56, v57
 v_and_b32 v38, 15, v1
 v_mfma_f32_32x32x16_bf16 v[2:17], a[144:147], v[78:81], v[2:17]
 ds_read_b128 v[74:77], v134 offset:12992
 v_permlane32_swap_b32 v18, v20
 v_permlane32_swap_b32 v19, v21
 s_waitcnt lgkmcnt(3)
 v_mfma_f32_32x32x16_bf16 v[2:17], a[160:163], v[82:85], v[2:17]
 ds_read_b128 v[78:81], v134 offset:13024
 v_and_b32_e64 v39, 1, v1
 v_lshlrev_b32_e64 v39, 4, v39
 v_mov_b32 v40, 0x3f80
 v_lshlrev_b32_e64 v39, v39, v40
 v_lshrrev_b32_e64 v38, 1, v38
 v_mfma_f32_32x32x16_bf16 v[2:17], a[0:3], v[26:29], v[2:17]
 ds_read_b128 v[82:85], v134 offset:13056
 buffer_store_dwordx4 v[18:21], v135, s[60:63], s88 offen offset:768
 v_cmp_eq_u32 vcc, 0, v38
 v_cmp_eq_u32 s[92:93], 1, v38
 v_mov_b32 v41, 0
 s_waitcnt lgkmcnt(3)
 v_mfma_f32_32x32x16_bf16 v[2:17], a[4:7], v[30:33], v[2:17]
 ds_read_b128 v[26:29], v134 offset:13088
 v_cndmask_b32 v88, 0, v39, vcc
 v_cndmask_b32 v89, 0, v39, s[92:93]
 v_cmp_eq_u32 vcc, 2, v38
 v_cmp_eq_u32 s[92:93], 3, v38
 v_mov_b32_e64 v41, 0
 v_mfma_f32_32x32x16_bf16 v[2:17], a[8:11], v[34:37], v[2:17]
 ds_read_b128 v[30:33], v134 offset:13120
 v_cvt_pk_bf16_f32 v22, v58, v59
 v_cvt_pk_bf16_f32 v23, v60, v61
 v_cvt_pk_bf16_f32 v24, v62, v63
 v_cvt_pk_bf16_f32 v25, v64, v65
 s_waitcnt lgkmcnt(3)
 v_mfma_f32_32x32x16_bf16 v[2:17], a[12:15], v[74:77], v[2:17]
 ds_read_b128 v[34:37], v134 offset:12800
 v_permlane32_swap_b32 v22, v24
 v_permlane32_swap_b32 v23, v25
 s_add_u32 s14, s80, 0
 buffer_load_dword v0, v86, s[60:63], s14 offen sc1
 v_mfma_f32_32x32x16_bf16 v[2:17], a[16:19], v[78:81], v[2:17]
 ds_read_b128 v[74:77], v134 offset:12832
 v_cndmask_b32 v90, 0, v39, vcc
 v_cndmask_b32 v91, 0, v39, s[92:93]
 v_cmp_eq_u32 vcc, 4, v38
 v_cmp_eq_u32 s[92:93], 5, v38
 s_waitcnt lgkmcnt(3)
 v_mfma_f32_32x32x16_bf16 v[2:17], a[20:23], v[82:85], v[2:17]
 ds_read_b128 v[78:81], v134 offset:12864
 buffer_store_dwordx4 v[22:25], v135, s[60:63], s88 offen offset:896
 s_add_u32 s14, s80, 32768
 buffer_load_dword v0, v86, s[60:63], s14 offen sc1
 v_mov_b32_e64 v41, 0
 v_cndmask_b32 v92, 0, v39, vcc
 v_mfma_f32_32x32x16_bf16 v[2:17], a[24:27], v[26:29], v[2:17]
 ds_read_b128 v[82:85], v134 offset:12896
 v_cndmask_b32 v93, 0, v39, s[92:93]
 v_cmp_eq_u32 vcc, 6, v38
 v_cmp_eq_u32 s[92:93], 7, v38
 v_mov_b32_e64 v41, 0
 s_waitcnt lgkmcnt(3)
 v_mfma_f32_32x32x16_bf16 v[2:17], a[28:31], v[30:33], v[2:17]
 ds_read_b128 v[26:29], v134 offset:12928
 v_cndmask_b32 v94, 0, v39, vcc
 v_cndmask_b32 v95, 0, v39, s[92:93]
 s_mul_i32 s14, s3, 2080
 s_add_u32 s14, s14, 67584
 v_lshl_add_u32 v96, v1, 5, s14
 v_mfma_f32_32x32x16_bf16 v[50:65], a[132:135], v[34:37], 0
 ds_read_b128 v[30:33], v134 offset:12960
 s_waitcnt lgkmcnt(3)
 v_mfma_f32_32x32x16_bf16 v[50:65], a[148:151], v[74:77], v[50:65]
 ds_read_b128 v[34:37], v134 offset:12992
 v_mfma_f32_32x32x16_bf16 v[50:65], a[164:167], v[78:81], v[50:65]
 ds_read_b128 v[74:77], v134 offset:13024
 v_cvt_pk_bf16_f32 v18, v2, v3
 v_cvt_pk_bf16_f32 v19, v4, v5
 v_cvt_pk_bf16_f32 v20, v6, v7
 v_cvt_pk_bf16_f32 v21, v8, v9
 s_waitcnt lgkmcnt(3)
 v_mfma_f32_32x32x16_bf16 v[50:65], a[32:35], v[82:85], v[50:65]
 ds_read_b128 v[78:81], v134 offset:13056
 v_permlane32_swap_b32 v18, v20
 v_permlane32_swap_b32 v19, v21
 v_mfma_f32_32x32x16_bf16 v[50:65], a[36:39], v[26:29], v[50:65]
 ds_read_b128 v[82:85], v134 offset:13088
 s_waitcnt lgkmcnt(3)
 v_mfma_f32_32x32x16_bf16 v[50:65], a[40:43], v[30:33], v[50:65]
 ds_read_b128 v[26:29], v134 offset:13120
 buffer_store_dwordx4 v[18:21], v135, s[60:63], s89 offen offset:0
 v_mfma_f32_32x32x16_bf16 v[50:65], a[44:47], v[34:37], v[50:65]
 ds_read_b128 v[30:33], v134 offset:12800
 s_waitcnt lgkmcnt(3)
 v_mfma_f32_32x32x16_bf16 v[50:65], a[48:51], v[74:77], v[50:65]
 ds_read_b128 v[34:37], v134 offset:12832
 v_cvt_pk_bf16_f32 v22, v10, v11
 v_cvt_pk_bf16_f32 v23, v12, v13
 v_cvt_pk_bf16_f32 v24, v14, v15
 v_cvt_pk_bf16_f32 v25, v16, v17
 v_mfma_f32_32x32x16_bf16 v[50:65], a[52:55], v[78:81], v[50:65]
 ds_read_b128 v[74:77], v134 offset:12864
 v_permlane32_swap_b32 v22, v24
 v_permlane32_swap_b32 v23, v25
 s_waitcnt lgkmcnt(3)
 v_mfma_f32_32x32x16_bf16 v[50:65], a[56:59], v[82:85], v[50:65]
 ds_read_b128 v[78:81], v134 offset:12896
 v_mfma_f32_32x32x16_bf16 v[50:65], a[60:63], v[26:29], v[50:65]
 ds_read_b128 v[82:85], v134 offset:12928
 buffer_store_dwordx4 v[22:25], v135, s[60:63], s89 offen offset:128
 s_waitcnt lgkmcnt(3)
 v_mfma_f32_32x32x16_bf16 v[2:17], a[136:139], v[30:33], 0
 ds_read_b128 v[26:29], v134 offset:12960
 s_lshl_b32 s14, s9, 2
 s_add_u32 s14, s14, s82
 s_waitcnt vmcnt(3)
 buffer_store_dword v143, off, s[60:63], s14 offset:0
 v_mfma_f32_32x32x16_bf16 v[2:17], a[152:155], v[34:37], v[2:17]
 ds_read_b128 v[30:33], v134 offset:12992
 s_waitcnt lgkmcnt(3)
 v_mfma_f32_32x32x16_bf16 v[2:17], a[168:171], v[74:77], v[2:17]
 ds_read_b128 v[34:37], v134 offset:13024
 v_cvt_pk_bf16_f32 v18, v50, v51
 v_cvt_pk_bf16_f32 v19, v52, v53
 v_cvt_pk_bf16_f32 v20, v54, v55
 v_cvt_pk_bf16_f32 v21, v56, v57
 v_mfma_f32_32x32x16_bf16 v[2:17], a[64:67], v[78:81], v[2:17]
 ds_read_b128 v[74:77], v134 offset:13056
 v_permlane32_swap_b32 v18, v20
 v_permlane32_swap_b32 v19, v21
 s_waitcnt lgkmcnt(3)
 v_mfma_f32_32x32x16_bf16 v[2:17], a[68:71], v[82:85], v[2:17]
 ds_read_b128 v[78:81], v134 offset:13088
 v_mfma_f32_32x32x16_bf16 v[2:17], a[72:75], v[26:29], v[2:17]
 ds_read_b128 v[82:85], v134 offset:13120
 buffer_store_dwordx4 v[18:21], v135, s[60:63], s89 offen offset:256
 s_waitcnt lgkmcnt(3)
 v_mfma_f32_32x32x16_bf16 v[2:17], a[76:79], v[30:33], v[2:17]
 ds_read_b128 v[26:29], v134 offset:12800
 v_mfma_f32_32x32x16_bf16 v[2:17], a[80:83], v[34:37], v[2:17]
 ds_read_b128 v[30:33], v134 offset:12832
 v_cvt_pk_bf16_f32 v22, v58, v59
 v_cvt_pk_bf16_f32 v23, v60, v61
 v_cvt_pk_bf16_f32 v24, v62, v63
 v_cvt_pk_bf16_f32 v25, v64, v65
 s_waitcnt lgkmcnt(3)
 v_mfma_f32_32x32x16_bf16 v[2:17], a[84:87], v[74:77], v[2:17]
 ds_read_b128 v[34:37], v134 offset:12864
 v_permlane32_swap_b32 v22, v24
 v_permlane32_swap_b32 v23, v25
 v_mfma_f32_32x32x16_bf16 v[2:17], a[88:91], v[78:81], v[2:17]
 ds_read_b128 v[74:77], v134 offset:12896
 s_waitcnt lgkmcnt(3)
 v_mfma_f32_32x32x16_bf16 v[2:17], a[92:95], v[82:85], v[2:17]
 ds_read_b128 v[78:81], v134 offset:12928
 buffer_store_dwordx4 v[22:25], v135, s[60:63], s89 offen offset:384
 v_mfma_f32_32x32x16_bf16 v[50:65], a[140:143], v[26:29], 0
 ds_read_b128 v[82:85], v134 offset:12960
 s_waitcnt lgkmcnt(3)
 v_mfma_f32_32x32x16_bf16 v[50:65], a[156:159], v[30:33], v[50:65]
 ds_read_b128 v[26:29], v134 offset:12992
 v_mfma_f32_32x32x16_bf16 v[50:65], a[172:175], v[34:37], v[50:65]
 ds_read_b128 v[30:33], v134 offset:13024
 s_nop 2
 v_cvt_pk_bf16_f32 v18, v2, v3
 v_cvt_pk_bf16_f32 v19, v4, v5
 v_cvt_pk_bf16_f32 v20, v6, v7
 v_cvt_pk_bf16_f32 v21, v8, v9
 s_waitcnt lgkmcnt(3)
 v_mfma_f32_32x32x16_bf16 v[50:65], a[96:99], v[74:77], v[50:65]
 ds_read_b128 v[34:37], v134 offset:13056
 v_permlane32_swap_b32 v18, v20
 v_permlane32_swap_b32 v19, v21
 v_mfma_f32_32x32x16_bf16 v[50:65], a[100:103], v[78:81], v[50:65]
 ds_read_b128 v[74:77], v134 offset:13088
 buffer_load_dword v87, v142, s[60:63], s82 offen offset:0 sc1
 s_waitcnt lgkmcnt(3)
 v_mfma_f32_32x32x16_bf16 v[50:65], a[104:107], v[82:85], v[50:65]
 ds_read_b128 v[78:81], v134 offset:13120
 buffer_store_dwordx4 v[18:21], v135, s[60:63], s89 offen offset:512
 v_mfma_f32_32x32x16_bf16 v[50:65], a[108:111], v[26:29], v[50:65]
 s_waitcnt lgkmcnt(2)
 v_mfma_f32_32x32x16_bf16 v[50:65], a[112:115], v[30:33], v[50:65]
 v_cvt_pk_bf16_f32 v22, v10, v11
 v_cvt_pk_bf16_f32 v23, v12, v13
 v_cvt_pk_bf16_f32 v24, v14, v15
 v_cvt_pk_bf16_f32 v25, v16, v17
 v_mfma_f32_32x32x16_bf16 v[50:65], a[116:119], v[34:37], v[50:65]
 v_permlane32_swap_b32 v22, v24
 v_permlane32_swap_b32 v23, v25
 s_waitcnt lgkmcnt(0)
 v_mfma_f32_32x32x16_bf16 v[50:65], a[120:123], v[74:77], v[50:65]
 v_mfma_f32_32x32x16_bf16 v[50:65], a[124:127], v[78:81], v[50:65]
 buffer_store_dwordx4 v[22:25], v135, s[60:63], s89 offen offset:640
 v_lshlrev_b32 v74, 16, v100
 v_and_b32 v75, s98, v100
 v_lshlrev_b32 v76, 16, v101
 v_and_b32 v77, s98, v101
 v_lshlrev_b32 v78, 16, v102
 v_and_b32 v79, s98, v102
 v_lshlrev_b32 v80, 16, v103
 v_and_b32 v81, s98, v103
 s_nop 2
 v_cvt_pk_bf16_f32 v18, v50, v51
 v_cvt_pk_bf16_f32 v19, v52, v53
 v_cvt_pk_bf16_f32 v20, v54, v55
 v_cvt_pk_bf16_f32 v21, v56, v57
 v_cvt_pk_bf16_f32 v22, v58, v59
 v_cvt_pk_bf16_f32 v23, v60, v61
 v_cvt_pk_bf16_f32 v24, v62, v63
 v_cvt_pk_bf16_f32 v25, v64, v65
 v_permlane32_swap_b32 v18, v20
 v_permlane32_swap_b32 v19, v21
 buffer_store_dwordx4 v[18:21], v135, s[60:63], s89 offen offset:768
 v_permlane32_swap_b32 v22, v24
 v_permlane32_swap_b32 v23, v25
 buffer_store_dwordx4 v[22:25], v135, s[60:63], s89 offen offset:896
 s_add_u32 s14, s80, 0
 s_add_u32 s15, s81, 0
 s_waitcnt vmcnt(4)
 v_cmp_ne_u32 vcc, s7, v87
 s_cbranch_vccnz Lrt_19
Lbk_20:
 buffer_load_dwordx4 v[26:29], v136, s[60:63], s14 offen offset:0 sc1
 buffer_load_dwordx4 v[30:33], v136, s[60:63], s15 offen offset:0 sc1
 buffer_load_dwordx4 v[34:37], v136, s[60:63], s14 offen offset:256 sc1
 buffer_load_dwordx4 v[38:41], v136, s[60:63], s15 offen offset:256 sc1
 buffer_load_dwordx4 v[42:45], v136, s[60:63], s14 offen offset:512 sc1
 buffer_load_dwordx4 v[46:49], v136, s[60:63], s15 offen offset:512 sc1
 buffer_load_dwordx4 v[66:69], v136, s[60:63], s14 offen offset:768 sc1
 buffer_load_dwordx4 v[70:73], v136, s[60:63], s15 offen offset:768 sc1
 v_lshlrev_b32 v10, 16, v116
 v_and_b32 v11, s98, v116
 v_lshlrev_b32 v12, 16, v117
 v_and_b32 v13, s98, v117
 v_lshlrev_b32 v14, 16, v118
 v_and_b32 v15, s98, v118
 v_lshlrev_b32_e64 v16, 16, v119
 v_and_b32_e64 v17, s98, v119
 v_pk_add_f32 v[74:75], v[74:75], v[10:11]
 v_pk_add_f32 v[76:77], v[76:77], v[12:13]
 v_pk_add_f32 v[78:79], v[78:79], v[14:15]
 v_pk_add_f32 v[80:81], v[80:81], v[16:17]
 s_lshl_b32 s14, s9, 2
 s_add_u32 s14, s14, s82
 s_waitcnt vmcnt(8)
 buffer_store_dword v143, off, s[60:63], s14 offset:512
 s_waitcnt vmcnt(8)
 v_mfma_f32_16x16x32_bf16 v[2:5], v[88:91], v[26:29], 0
 s_waitcnt vmcnt(7)
 v_mfma_f32_16x16x32_bf16 v[2:5], v[88:91], v[30:33], v[2:5]
 s_waitcnt vmcnt(6)
 v_mfma_f32_16x16x32_bf16 v[2:5], v[92:95], v[34:37], v[2:5]
 s_waitcnt vmcnt(5)
 v_mfma_f32_16x16x32_bf16 v[2:5], v[92:95], v[38:41], v[2:5]
 s_waitcnt vmcnt(4)
 v_mfma_f32_16x16x32_bf16 v[6:9], v[88:91], v[42:45], 0
 s_waitcnt vmcnt(3)
 v_mfma_f32_16x16x32_bf16 v[6:9], v[88:91], v[46:49], v[6:9]
 s_waitcnt vmcnt(2)
 v_mfma_f32_16x16x32_bf16 v[6:9], v[92:95], v[66:69], v[6:9]
 s_waitcnt vmcnt(1)
 v_mfma_f32_16x16x32_bf16 v[6:9], v[92:95], v[70:73], v[6:9]
 ds_write_b128 v137, v[2:5] offset:0
 s_nop 6
 ds_write_b128 v137, v[6:9] offset:256
 s_waitcnt lgkmcnt(0)
 s_barrier
 ds_read_b128 v[2:5], v96
 ds_read_b128 v[6:9], v96 offset:16
 buffer_load_dword v87, v142, s[60:63], s82 offen offset:512 sc1
 v_lshlrev_b32 v18, 16, v108
 v_and_b32 v19, s98, v108
 v_lshlrev_b32 v20, 16, v109
 v_and_b32 v21, s98, v109
 v_lshlrev_b32 v22, 16, v110
 v_and_b32 v23, s98, v110
 v_lshlrev_b32 v24, 16, v111
 v_and_b32 v25, s98, v111
 s_waitcnt lgkmcnt(1)
 v_pk_add_f32 v[2:3], v[2:3], v[74:75]
 v_pk_add_f32 v[4:5], v[4:5], v[76:77]
 s_waitcnt lgkmcnt(0)
 v_pk_add_f32 v[6:7], v[6:7], v[78:79]
 v_pk_add_f32 v[8:9], v[8:9], v[80:81]
 v_pk_add_f32 v[10:11], v[2:3], v[4:5]
 v_pk_mul_f32 v[12:13], v[2:3], v[2:3]
 v_pk_add_f32 v[14:15], v[6:7], v[8:9]
 v_pk_fma_f32 v[12:13], v[4:5], v[4:5], v[12:13]
 v_pk_add_f32 v[10:11], v[10:11], v[14:15]
 v_pk_fma_f32 v[12:13], v[6:7], v[6:7], v[12:13]
 v_add_f32_e64 v10, v10, v11
 v_pk_fma_f32 v[12:13], v[8:9], v[8:9], v[12:13]
 v_add_f32 v11, v12, v13
 v_add_f32_dpp v10, v10, v10 quad_perm:[1,0,3,2] row_mask:0xf bank_mask:0xf
 v_lshlrev_b32 v74, 16, v104
 v_add_f32_dpp v11, v11, v11 quad_perm:[1,0,3,2] row_mask:0xf bank_mask:0xf
 v_and_b32_e64 v75, s98, v104
 v_add_f32_dpp v10, v10, v10 quad_perm:[2,3,0,1] row_mask:0xf bank_mask:0xf
 v_lshlrev_b32_e64 v76, 16, v105
 v_add_f32_dpp v11, v11, v11 quad_perm:[2,3,0,1] row_mask:0xf bank_mask:0xf
 v_and_b32_e64 v77, s98, v105
 v_add_f32_dpp v10, v10, v10 row_half_mirror row_mask:0xf bank_mask:0xf
 v_lshlrev_b32_e64 v78, 16, v106
 v_add_f32_dpp v11, v11, v11 row_half_mirror row_mask:0xf bank_mask:0xf
 v_and_b32_e64 v79, s98, v106
 v_add_f32_dpp v10, v10, v10 row_mirror row_mask:0xf bank_mask:0xf
 v_lshlrev_b32_e64 v80, 16, v107
 v_add_f32_dpp v11, v11, v11 row_mirror row_mask:0xf bank_mask:0xf
 v_and_b32 v81, s98, v107
 v_add_f32_dpp v10, v10, v10 row_bcast:15 row_mask:0xa bank_mask:0xf
 v_add_f32_dpp v11, v11, v11 row_bcast:15 row_mask:0xa bank_mask:0xf
 s_nop 0
 v_add_f32_dpp v10, v10, v10 row_bcast:31 row_mask:0xc bank_mask:0xf
 v_add_f32_dpp v11, v11, v11 row_bcast:31 row_mask:0xc bank_mask:0xf
 v_readlane_b32 s92, v10, 63
 v_readlane_b32 s93, v11, 63
 v_mov_b32 v13, s96
 v_mul_f32 v10, s92, v13
 v_mul_f32 v11, s93, v13
 v_fma_f32 v11, -v10, v10, v11
 v_max_f32 v11, 0, v11
 v_add_f32 v11, 0x3727c5ac, v11
 v_rsq_f32 v11, v11
 s_nop 0
 v_mul_f32 v10, v10, v11
 s_add_u32 s14, s80, 4096
 s_add_u32 s15, s81, 4096
 s_waitcnt vmcnt(0)
 v_cmp_ne_u32 vcc, s7, v87
 s_cbranch_vccnz Lrt_22
Lbk_23:
 buffer_load_dwordx4 v[34:37], v136, s[60:63], s14 offen offset:0 sc1
 v_pk_fma_f32 v[26:27], v[2:3], v[10:11], v[10:11] op_sel:[0,1,0] op_sel_hi:[1,1,0] neg_lo:[0,0,1] neg_hi:[0,0,1]
 v_pk_fma_f32 v[28:29], v[4:5], v[10:11], v[10:11] op_sel:[0,1,0] op_sel_hi:[1,1,0] neg_lo:[0,0,1] neg_hi:[0,0,1]
 v_pk_fma_f32 v[30:31], v[6:7], v[10:11], v[10:11] op_sel:[0,1,0] op_sel_hi:[1,1,0] neg_lo:[0,0,1] neg_hi:[0,0,1]
 v_pk_fma_f32 v[32:33], v[8:9], v[10:11], v[10:11] op_sel:[0,1,0] op_sel_hi:[1,1,0] neg_lo:[0,0,1] neg_hi:[0,0,1]
 v_pk_fma_f32 v[2:3], v[26:27], v[18:19], v[2:3]
 v_pk_fma_f32 v[4:5], v[28:29], v[20:21], v[4:5]
 v_pk_fma_f32 v[6:7], v[30:31], v[22:23], v[6:7]
 buffer_load_dwordx4 v[38:41], v136, s[60:63], s15 offen offset:0 sc1
 v_pk_fma_f32 v[8:9], v[32:33], v[24:25], v[8:9]
 v_pk_add_f32 v[10:11], v[2:3], v[4:5]
 v_pk_mul_f32 v[12:13], v[2:3], v[2:3]
 v_pk_add_f32 v[14:15], v[6:7], v[8:9]
 v_pk_fma_f32 v[12:13], v[4:5], v[4:5], v[12:13]
 v_pk_add_f32 v[10:11], v[10:11], v[14:15]
 v_pk_fma_f32 v[12:13], v[6:7], v[6:7], v[12:13]
 v_add_f32 v10, v10, v11
 buffer_load_dwordx4 v[42:45], v136, s[60:63], s14 offen offset:256 sc1
 v_pk_fma_f32 v[12:13], v[8:9], v[8:9], v[12:13]
 v_add_f32 v11, v12, v13
 v_add_f32_dpp v10, v10, v10 quad_perm:[1,0,3,2] row_mask:0xf bank_mask:0xf
 v_lshlrev_b32 v66, 16, v116
 v_add_f32_dpp v11, v11, v11 quad_perm:[1,0,3,2] row_mask:0xf bank_mask:0xf
 v_and_b32 v67, s98, v116
 v_add_f32_dpp v10, v10, v10 quad_perm:[2,3,0,1] row_mask:0xf bank_mask:0xf
 v_lshlrev_b32_e64 v68, 16, v117
 buffer_load_dwordx4 v[46:49], v136, s[60:63], s15 offen offset:256 sc1
 v_add_f32_dpp v11, v11, v11 quad_perm:[2,3,0,1] row_mask:0xf bank_mask:0xf
 v_and_b32 v69, s98, v117
 v_add_f32_dpp v10, v10, v10 row_half_mirror row_mask:0xf bank_mask:0xf
 v_lshlrev_b32 v70, 16, v118
 v_add_f32_dpp v11, v11, v11 row_half_mirror row_mask:0xf bank_mask:0xf
 v_and_b32 v71, s98, v118
 v_add_f32_dpp v10, v10, v10 row_mirror row_mask:0xf bank_mask:0xf
 v_lshlrev_b32 v72, 16, v119
 buffer_load_dwordx4 v[50:53], v136, s[60:63], s14 offen offset:512 sc1
 v_add_f32_dpp v11, v11, v11 row_mirror row_mask:0xf bank_mask:0xf
 v_and_b32_e64 v73, s98, v119
 v_add_f32_dpp v10, v10, v10 row_bcast:15 row_mask:0xa bank_mask:0xf
 v_pk_add_f32 v[74:75], v[74:75], v[66:67]
 v_add_f32_dpp v11, v11, v11 row_bcast:15 row_mask:0xa bank_mask:0xf
 v_pk_add_f32 v[76:77], v[76:77], v[68:69]
 v_add_f32_dpp v10, v10, v10 row_bcast:31 row_mask:0xc bank_mask:0xf
 v_pk_add_f32 v[78:79], v[78:79], v[70:71]
 buffer_load_dwordx4 v[54:57], v136, s[60:63], s15 offen offset:512 sc1
 v_add_f32_dpp v11, v11, v11 row_bcast:31 row_mask:0xc bank_mask:0xf
 v_pk_add_f32 v[80:81], v[80:81], v[72:73]
 v_readlane_b32 s92, v10, 63
 v_readlane_b32 s93, v11, 63
 v_mov_b32 v13, s96
 v_mul_f32 v10, s92, v13
 v_mul_f32_e64 v11, s93, v13
 v_fma_f32 v11, -v10, v10, v11
 buffer_load_dwordx4 v[58:61], v136, s[60:63], s14 offen offset:768 sc1
 v_max_f32 v11, 0, v11
 v_add_f32 v11, 0x3727c5ac, v11
 v_rsq_f32 v11, v11
 s_nop 0
 v_mul_f32 v10, v10, v11
 v_pk_fma_f32 v[26:27], v[2:3], v[10:11], v[10:11] op_sel:[0,1,0] op_sel_hi:[1,1,0] neg_lo:[0,0,1] neg_hi:[0,0,1]
 v_pk_fma_f32 v[28:29], v[4:5], v[10:11], v[10:11] op_sel:[0,1,0] op_sel_hi:[1,1,0] neg_lo:[0,0,1] neg_hi:[0,0,1]
 v_pk_fma_f32 v[30:31], v[6:7], v[10:11], v[10:11] op_sel:[0,1,0] op_sel_hi:[1,1,0] neg_lo:[0,0,1] neg_hi:[0,0,1]
 v_pk_fma_f32 v[32:33], v[8:9], v[10:11], v[10:11] op_sel:[0,1,0] op_sel_hi:[1,1,0] neg_lo:[0,0,1] neg_hi:[0,0,1]
 buffer_load_dwordx4 v[62:65], v136, s[60:63], s15 offen offset:768 sc1
 v_cvt_pk_bf16_f32 v18, v26, v27
 v_cvt_pk_bf16_f32 v19, v28, v29
 v_cvt_pk_bf16_f32 v20, v30, v31
 v_cvt_pk_bf16_f32 v21, v32, v33
 v_min_u32 v18, -2, v18
 v_min_u32 v19, -2, v19
 v_min_u32 v20, -2, v20
 v_min_u32 v21, -2, v21
 s_add_u32 s12, s76, 8192
 buffer_store_dwordx4 v[18:21], v139, s[60:63], s12 offen
 v_pk_add_f32 v[26:27], v[2:3], v[66:67]
 v_pk_add_f32 v[28:29], v[4:5], v[68:69]
 v_pk_add_f32 v[30:31], v[6:7], v[70:71]
 v_pk_add_f32 v[32:33], v[8:9], v[72:73]
 ds_write_b128 v96, v[26:29] offset:0
 ds_write_b128 v96, v[30:33] offset:16
 s_add_u32 s77, s77, 8192
 s_add_u32 s78, s78, 8192
 s_add_u32 s82, s82, 1024
 s_waitcnt vmcnt(8)
 v_mfma_f32_16x16x32_bf16 v[10:13], v[88:91], v[34:37], 0
 s_waitcnt vmcnt(7)
 v_mfma_f32_16x16x32_bf16 v[10:13], v[88:91], v[38:41], v[10:13]
 s_waitcnt vmcnt(6)
 v_mfma_f32_16x16x32_bf16 v[10:13], v[92:95], v[42:45], v[10:13]
 s_waitcnt vmcnt(5)
 v_mfma_f32_16x16x32_bf16 v[10:13], v[92:95], v[46:49], v[10:13]
 s_waitcnt vmcnt(4)
 v_mfma_f32_16x16x32_bf16 v[14:17], v[88:91], v[50:53], 0
 s_waitcnt vmcnt(3)
 v_mfma_f32_16x16x32_bf16 v[14:17], v[88:91], v[54:57], v[14:17]
 s_waitcnt vmcnt(2)
 v_mfma_f32_16x16x32_bf16 v[14:17], v[92:95], v[58:61], v[14:17]
 s_waitcnt vmcnt(1)
 v_mfma_f32_16x16x32_bf16 v[14:17], v[92:95], v[62:65], v[14:17]
 ds_write_b128 v137, v[10:13] offset:34816
 s_nop 6
 ds_write_b128 v137, v[14:17] offset:35072
 s_waitcnt lgkmcnt(0)
 s_barrier
 ds_read_b128 v[2:5], v96 offset:34816
 ds_read_b128 v[6:9], v96 offset:34832
 v_lshlrev_b32 v18, 16, v112
 v_and_b32_e64 v19, s98, v112
 v_lshlrev_b32_e64 v20, 16, v113
 v_and_b32_e64 v21, s98, v113
 v_lshlrev_b32_e64 v22, 16, v114
 v_and_b32 v23, s98, v114
 s_add_u32 s86, s77, 0
 s_add_u32 s87, s78, 0
 s_add_u32 m0, s101, 0
 s_nop 0
 buffer_load_dwordx4 v138, s[60:63], s86 offen offset:0 sc1 lds
 s_add_u32 m0, s101, 32
 v_lshlrev_b32 v24, 16, v115
 v_and_b32_e64 v25, s98, v115
 s_waitcnt lgkmcnt(1)
 v_pk_add_f32 v[2:3], v[2:3], v[74:75]
 v_pk_add_f32 v[4:5], v[4:5], v[76:77]
 s_waitcnt lgkmcnt(0)
 v_pk_add_f32 v[6:7], v[6:7], v[78:79]
 v_pk_add_f32 v[8:9], v[8:9], v[80:81]
 buffer_load_dwordx4 v138, s[60:63], s86 offen offset:1024 sc1 lds
 s_add_u32 m0, s101, 64
 v_pk_add_f32 v[10:11], v[2:3], v[4:5]
 v_pk_mul_f32 v[12:13], v[2:3], v[2:3]
 v_pk_add_f32 v[14:15], v[6:7], v[8:9]
 v_pk_fma_f32 v[12:13], v[4:5], v[4:5], v[12:13]
 v_pk_add_f32 v[10:11], v[10:11], v[14:15]
 v_pk_fma_f32 v[12:13], v[6:7], v[6:7], v[12:13]
 buffer_load_dwordx4 v138, s[60:63], s86 offen offset:2048 sc1 lds
 s_add_u32 m0, s101, 96
 v_add_f32_e64 v10, v10, v11
 v_pk_fma_f32 v[12:13], v[8:9], v[8:9], v[12:13]
 v_add_f32_e64 v11, v12, v13
 v_add_f32_dpp v10, v10, v10 quad_perm:[1,0,3,2] row_mask:0xf bank_mask:0xf
 s_nop 0
 v_add_f32_dpp v11, v11, v11 quad_perm:[1,0,3,2] row_mask:0xf bank_mask:0xf
 v_add_f32_dpp v10, v10, v10 quad_perm:[2,3,0,1] row_mask:0xf bank_mask:0xf
 s_nop 0
 v_add_f32_dpp v11, v11, v11 quad_perm:[2,3,0,1] row_mask:0xf bank_mask:0xf
 buffer_load_dwordx4 v138, s[60:63], s86 offen offset:3072 sc1 lds
 s_add_u32 m0, s101, 4224
 v_add_f32_dpp v10, v10, v10 row_half_mirror row_mask:0xf bank_mask:0xf
 v_add_f32_dpp v11, v11, v11 row_half_mirror row_mask:0xf bank_mask:0xf
 s_nop 0
 v_add_f32_dpp v10, v10, v10 row_mirror row_mask:0xf bank_mask:0xf
 v_add_f32_dpp v11, v11, v11 row_mirror row_mask:0xf bank_mask:0xf
 s_nop 0
 v_add_f32_dpp v10, v10, v10 row_bcast:15 row_mask:0xa bank_mask:0xf
 v_add_f32_dpp v11, v11, v11 row_bcast:15 row_mask:0xa bank_mask:0xf
 buffer_load_dwordx4 v138, s[60:63], s87 offen offset:0 sc1 lds
 s_add_u32 m0, s101, 4256
 v_add_f32_dpp v10, v10, v10 row_bcast:31 row_mask:0xc bank_mask:0xf
 v_add_f32_dpp v11, v11, v11 row_bcast:31 row_mask:0xc bank_mask:0xf
 v_readlane_b32 s92, v10, 63
 v_readlane_b32 s93, v11, 63
 v_mov_b32 v13, s96
 v_mul_f32 v10, s92, v13
 buffer_load_dwordx4 v138, s[60:63], s87 offen offset:1024 sc1 lds
 s_add_u32 m0, s101, 4288
 v_mul_f32 v11, s93, v13
 v_fma_f32 v11, -v10, v10, v11
 v_max_f32 v11, 0, v11
 v_add_f32 v11, 0x3727c5ac, v11
 v_rsq_f32 v11, v11
 s_nop 0
 v_mul_f32_e64 v10, v10, v11
 v_pk_fma_f32 v[26:27], v[2:3], v[10:11], v[10:11] op_sel:[0,1,0] op_sel_hi:[1,1,0] neg_lo:[0,0,1] neg_hi:[0,0,1]
 buffer_load_dwordx4 v138, s[60:63], s87 offen offset:2048 sc1 lds
 s_add_u32 m0, s101, 4320
 v_pk_fma_f32 v[28:29], v[4:5], v[10:11], v[10:11] op_sel:[0,1,0] op_sel_hi:[1,1,0] neg_lo:[0,0,1] neg_hi:[0,0,1]
 v_pk_fma_f32 v[30:31], v[6:7], v[10:11], v[10:11] op_sel:[0,1,0] op_sel_hi:[1,1,0] neg_lo:[0,0,1] neg_hi:[0,0,1]
 v_pk_fma_f32 v[32:33], v[8:9], v[10:11], v[10:11] op_sel:[0,1,0] op_sel_hi:[1,1,0] neg_lo:[0,0,1] neg_hi:[0,0,1]
 v_pk_fma_f32 v[2:3], v[26:27], v[18:19], v[2:3]
 v_pk_fma_f32 v[4:5], v[28:29], v[20:21], v[4:5]
 v_pk_fma_f32 v[6:7], v[30:31], v[22:23], v[6:7]
 buffer_load_dwordx4 v138, s[60:63], s87 offen offset:3072 sc1 lds
 v_pk_fma_f32 v[8:9], v[32:33], v[24:25], v[8:9]
 v_pk_add_f32 v[10:11], v[2:3], v[4:5]
 v_pk_mul_f32 v[12:13], v[2:3], v[2:3]
 v_pk_add_f32 v[14:15], v[6:7], v[8:9]
 v_pk_fma_f32 v[12:13], v[4:5], v[4:5], v[12:13]
 v_pk_add_f32 v[10:11], v[10:11], v[14:15]
 v_pk_fma_f32 v[12:13], v[6:7], v[6:7], v[12:13]
 v_add_f32 v10, v10, v11
 v_pk_fma_f32 v[12:13], v[8:9], v[8:9], v[12:13]
 v_add_f32 v11, v12, v13
 v_add_f32_dpp v10, v10, v10 quad_perm:[1,0,3,2] row_mask:0xf bank_mask:0xf
 v_pk_add_f32 v[78:79], v[2:3], v[66:67]
 v_add_f32_dpp v11, v11, v11 quad_perm:[1,0,3,2] row_mask:0xf bank_mask:0xf
 v_pk_add_f32 v[80:81], v[4:5], v[68:69]
 v_add_f32_dpp v10, v10, v10 quad_perm:[2,3,0,1] row_mask:0xf bank_mask:0xf
 v_pk_add_f32 v[82:83], v[6:7], v[70:71]
 v_add_f32_dpp v11, v11, v11 quad_perm:[2,3,0,1] row_mask:0xf bank_mask:0xf
 v_pk_add_f32 v[84:85], v[8:9], v[72:73]
 v_add_f32_dpp v10, v10, v10 row_half_mirror row_mask:0xf bank_mask:0xf
 ds_write_b128 v96, v[78:81] offset:34816
 v_add_f32_dpp v11, v11, v11 row_half_mirror row_mask:0xf bank_mask:0xf
 ds_write_b128 v96, v[82:85] offset:34832
 v_add_f32_dpp v10, v10, v10 row_mirror row_mask:0xf bank_mask:0xf
 v_add_f32_dpp v11, v11, v11 row_mirror row_mask:0xf bank_mask:0xf
 s_nop 0
 v_add_f32_dpp v10, v10, v10 row_bcast:15 row_mask:0xa bank_mask:0xf
 v_add_f32_dpp v11, v11, v11 row_bcast:15 row_mask:0xa bank_mask:0xf
 s_nop 0
 v_add_f32_dpp v10, v10, v10 row_bcast:31 row_mask:0xc bank_mask:0xf
 v_add_f32_dpp v11, v11, v11 row_bcast:31 row_mask:0xc bank_mask:0xf
 v_readlane_b32 s92, v10, 63
 v_readlane_b32 s93, v11, 63
 v_mov_b32 v13, s96
 v_mul_f32 v10, s92, v13
 v_mul_f32 v11, s93, v13
 v_fma_f32 v11, -v10, v10, v11
 v_max_f32 v11, 0, v11
 v_add_f32 v11, 0x3727c5ac, v11
 v_rsq_f32 v11, v11
 s_waitcnt vmcnt(0)
 v_add_u32_e64 v37, s101, v139
 ds_read_b128 v[38:41], v37 offset:0
 ds_read_b128 v[42:45], v37 offset:1056
 ds_read_b128 v[46:49], v37 offset:2112
 ds_read_b128 v[50:53], v37 offset:3168
 ds_read_b128 v[54:57], v37 offset:4224
 ds_read_b128 v[58:61], v37 offset:5280
 ds_read_b128 v[62:65], v37 offset:6336
 ds_read_b128 v[66:69], v37 offset:7392
 v_mul_f32_e64 v10, v10, v11
 v_pk_fma_f32 v[26:27], v[2:3], v[10:11], v[10:11] op_sel:[0,1,0] op_sel_hi:[1,1,0] neg_lo:[0,0,1] neg_hi:[0,0,1]
 v_pk_fma_f32 v[28:29], v[4:5], v[10:11], v[10:11] op_sel:[0,1,0] op_sel_hi:[1,1,0] neg_lo:[0,0,1] neg_hi:[0,0,1]
 v_pk_fma_f32 v[30:31], v[6:7], v[10:11], v[10:11] op_sel:[0,1,0] op_sel_hi:[1,1,0] neg_lo:[0,0,1] neg_hi:[0,0,1]
 v_pk_fma_f32 v[32:33], v[8:9], v[10:11], v[10:11] op_sel:[0,1,0] op_sel_hi:[1,1,0] neg_lo:[0,0,1] neg_hi:[0,0,1]
 v_cvt_pk_bf16_f32 v18, v26, v27
 v_cvt_pk_bf16_f32 v19, v28, v29
 v_cvt_pk_bf16_f32 v20, v30, v31
 v_cvt_pk_bf16_f32 v21, v32, v33
 v_min_u32 v18, -2, v18
 v_min_u32 v19, -2, v19
 v_min_u32 v20, -2, v20
 v_min_u32 v21, -2, v21
 s_add_u32 s12, s76, 12288
 buffer_store_dwordx4 v[18:21], v139, s[60:63], s12 offen
 s_waitcnt lgkmcnt(0)
 v_max_u32 v36, v38, v39
 v_max3_u32 v36, v36, v40, v41
 v_max3_u32 v36, v36, v42, v43
 v_max3_u32 v36, v36, v44, v45
 v_max3_u32 v36, v36, v46, v47
 v_max3_u32 v36, v36, v48, v49
 v_max3_u32 v36, v36, v50, v51
 v_max3_u32 v36, v36, v52, v53
 v_max3_u32 v36, v36, v54, v55
 v_max3_u32 v36, v36, v56, v57
 v_max3_u32 v36, v36, v58, v59
 v_max3_u32 v36, v36, v60, v61
 v_max3_u32 v36, v36, v62, v63
 v_max3_u32 v36, v36, v64, v65
 v_max3_u32 v36, v36, v66, v67
 v_max3_u32 v36, v36, v68, v69
 v_cmp_eq_u32 vcc, -1, v36
 s_cbranch_vccnz Lrt_25
Lbk_26:
 s_waitcnt lgkmcnt(0)
 s_barrier
 ds_read_b128 v[50:53], v132 offset:0
 ds_read_b128 v[54:57], v132 offset:64
 ds_read_b128 v[58:61], v132 offset:128
 s_waitcnt lgkmcnt(1)
 v_mfma_f32_16x16x32_bf16 v[2:5], a[176:179], v[50:53], v[120:123]
 ds_read_b128 v[62:65], v132 offset:192
 v_mfma_f32_16x16x32_bf16 v[6:9], a[180:183], v[50:53], v[124:127]
 v_mfma_f32_16x16x32_bf16 v[10:13], a[184:187], v[50:53], v[128:131]
 v_mfma_f32_16x16x32_bf16 v[2:5], a[188:191], v[54:57], v[2:5]
 ds_read_b128 v[50:53], v132 offset:256
 v_mfma_f32_16x16x32_bf16 v[6:9], a[192:195], v[54:57], v[6:9]
 v_mfma_f32_16x16x32_bf16 v[10:13], a[196:199], v[54:57], v[10:13]
 s_waitcnt lgkmcnt(1)
 v_mfma_f32_16x16x32_bf16 v[2:5], a[200:203], v[58:61], v[2:5]
 ds_read_b128 v[54:57], v132 offset:320
 v_mfma_f32_16x16x32_bf16 v[6:9], a[204:207], v[58:61], v[6:9]
 v_mfma_f32_16x16x32_bf16 v[10:13], a[208:211], v[58:61], v[10:13]
 v_mfma_f32_16x16x32_bf16 v[2:5], a[212:215], v[62:65], v[2:5]
 ds_read_b128 v[58:61], v132 offset:384
 v_mfma_f32_16x16x32_bf16 v[6:9], a[216:219], v[62:65], v[6:9]
 v_mfma_f32_16x16x32_bf16 v[10:13], a[220:223], v[62:65], v[10:13]
 s_waitcnt lgkmcnt(1)
 v_mfma_f32_16x16x32_bf16 v[2:5], a[224:227], v[50:53], v[2:5]
 ds_read_b128 v[62:65], v132 offset:448
 v_mfma_f32_16x16x32_bf16 v[6:9], a[228:231], v[50:53], v[6:9]
 v_mfma_f32_16x16x32_bf16 v[10:13], a[232:235], v[50:53], v[10:13]
 v_mfma_f32_16x16x32_bf16 v[2:5], a[236:239], v[54:57], v[2:5]
 ds_read_b128 v[50:53], v132 offset:512
 v_mfma_f32_16x16x32_bf16 v[6:9], a[240:243], v[54:57], v[6:9]
 v_mfma_f32_16x16x32_bf16 v[10:13], a[244:247], v[54:57], v[10:13]
 s_waitcnt lgkmcnt(1)
 v_mfma_f32_16x16x32_bf16 v[2:5], a[248:251], v[58:61], v[2:5]
 ds_read_b128 v[54:57], v132 offset:576
 v_mfma_f32_16x16x32_bf16 v[6:9], a[252:255], v[58:61], v[6:9]
 s_add_u32 s86, s77, 4096
 s_add_u32 s87, s78, 4096
 s_add_u32 m0, s101, 33792
 v_mfma_f32_16x16x32_bf16 v[10:13], v[144:147], v[58:61], v[10:13]
 buffer_load_dwordx4 v138, s[60:63], s86 offen offset:0 sc1 lds
 s_add_u32 m0, s101, 33824
 v_mfma_f32_16x16x32_bf16 v[2:5], v[148:151], v[62:65], v[2:5]
 ds_read_b128 v[58:61], v132 offset:640
 v_mfma_f32_16x16x32_bf16 v[6:9], v[152:155], v[62:65], v[6:9]
 v_mfma_f32_16x16x32_bf16 v[10:13], v[156:159], v[62:65], v[10:13]
 s_waitcnt lgkmcnt(1)
 v_mfma_f32_16x16x32_bf16 v[2:5], v[160:163], v[50:53], v[2:5]
 ds_read_b128 v[62:65], v132 offset:704
 buffer_load_dwordx4 v138, s[60:63], s86 offen offset:1024 sc1 lds
 s_add_u32 m0, s101, 33856
 v_mfma_f32_16x16x32_bf16 v[6:9], v[164:167], v[50:53], v[6:9]
 v_mfma_f32_16x16x32_bf16 v[10:13], v[168:171], v[50:53], v[10:13]
 v_mfma_f32_16x16x32_bf16 v[2:5], v[172:175], v[54:57], v[2:5]
 ds_read_b128 v[50:53], v132 offset:768
 v_mfma_f32_16x16x32_bf16 v[6:9], v[176:179], v[54:57], v[6:9]
 buffer_load_dwordx4 v138, s[60:63], s86 offen offset:2048 sc1 lds
 s_add_u32 m0, s101, 33888
 v_mfma_f32_16x16x32_bf16 v[10:13], v[180:183], v[54:57], v[10:13]
 s_waitcnt lgkmcnt(1)
 v_mfma_f32_16x16x32_bf16 v[2:5], v[184:187], v[58:61], v[2:5]
 ds_read_b128 v[54:57], v132 offset:832
 v_mfma_f32_16x16x32_bf16 v[6:9], v[188:191], v[58:61], v[6:9]
 v_mfma_f32_16x16x32_bf16 v[10:13], v[192:195], v[58:61], v[10:13]
 buffer_load_dwordx4 v138, s[60:63], s86 offen offset:3072 sc1 lds
 s_add_u32 m0, s101, 38016
 v_mfma_f32_16x16x32_bf16 v[2:5], v[196:199], v[62:65], v[2:5]
 ds_read_b128 v[58:61], v132 offset:896
 v_mfma_f32_16x16x32_bf16 v[6:9], v[200:203], v[62:65], v[6:9]
 v_mfma_f32_16x16x32_bf16 v[10:13], v[204:207], v[62:65], v[10:13]
 s_waitcnt lgkmcnt(1)
 v_mfma_f32_16x16x32_bf16 v[2:5], v[208:211], v[50:53], v[2:5]
 ds_read_b128 v[62:65], v132 offset:960
 buffer_load_dwordx4 v138, s[60:63], s87 offen offset:0 sc1 lds
 s_add_u32 m0, s101, 38048
 v_mfma_f32_16x16x32_bf16 v[6:9], v[212:215], v[50:53], v[6:9]
 v_mfma_f32_16x16x32_bf16 v[10:13], v[216:219], v[50:53], v[10:13]
 v_mfma_f32_16x16x32_bf16 v[2:5], v[220:223], v[54:57], v[2:5]
 ds_read_b128 v[50:53], v132 offset:16896
 v_mfma_f32_16x16x32_bf16 v[6:9], v[224:227], v[54:57], v[6:9]
 buffer_load_dwordx4 v138, s[60:63], s87 offen offset:1024 sc1 lds
 s_add_u32 m0, s101, 38080
 v_mfma_f32_16x16x32_bf16 v[10:13], v[228:231], v[54:57], v[10:13]
 s_waitcnt lgkmcnt(1)
 v_mfma_f32_16x16x32_bf16 v[2:5], v[232:235], v[58:61], v[2:5]
 ds_read_b128 v[54:57], v132 offset:16960
 v_mfma_f32_16x16x32_bf16 v[6:9], v[236:239], v[58:61], v[6:9]
 v_mfma_f32_16x16x32_bf16 v[10:13], v[240:243], v[58:61], v[10:13]
 buffer_load_dwordx4 v138, s[60:63], s87 offen offset:2048 sc1 lds
 s_add_u32 m0, s101, 38112
 v_mfma_f32_16x16x32_bf16 v[2:5], v[244:247], v[62:65], v[2:5]
 ds_read_b128 v[58:61], v132 offset:17024
 v_mfma_f32_16x16x32_bf16 v[6:9], v[248:251], v[62:65], v[6:9]
 v_mfma_f32_16x16x32_bf16 v[10:13], v[252:255], v[62:65], v[10:13]
 s_waitcnt lgkmcnt(1)
 v_mfma_f32_16x16x32_bf16 v[14:17], a[176:179], v[50:53], v[120:123]
 ds_read_b128 v[62:65], v132 offset:17088
 buffer_load_dwordx4 v138, s[60:63], s87 offen offset:3072 sc1 lds
 v_mfma_f32_16x16x32_bf16 v[18:21], a[180:183], v[50:53], v[124:127]
 v_mfma_f32_16x16x32_bf16 v[22:25], a[184:187], v[50:53], v[128:131]
 v_mul_f32 v66, v2, v2
 v_mul_f32_e64 v67, v3, v3
 v_mfma_f32_16x16x32_bf16 v[14:17], a[188:191], v[54:57], v[14:17]
 ds_read_b128 v[50:53], v132 offset:17152
 v_add_u32 v75, s101, v139
 v_mfma_f32_16x16x32_bf16 v[18:21], a[192:195], v[54:57], v[18:21]
 s_waitcnt vmcnt(6)
 ds_read_b128 v[76:79], v75 offset:33792
 ds_read_b128 v[80:83], v75 offset:34848
 v_mfma_f32_16x16x32_bf16 v[22:25], a[196:199], v[54:57], v[22:25]
 v_mul_f32 v68, v4, v4
 s_waitcnt lgkmcnt(3)
 v_mfma_f32_16x16x32_bf16 v[14:17], a[200:203], v[58:61], v[14:17]
 ds_read_b128 v[54:57], v132 offset:17216
 v_mul_f32_e64 v69, v5, v5
 v_mfma_f32_16x16x32_bf16 v[18:21], a[204:207], v[58:61], v[18:21]
 v_fma_f32 v66, v66, s100, v140
 v_fma_f32 v67, v67, s100, v140
 v_mfma_f32_16x16x32_bf16 v[22:25], a[208:211], v[58:61], v[22:25]
 v_fma_f32 v68, v68, s100, v140
 v_fma_f32 v69, v69, s100, v140
 v_mfma_f32_16x16x32_bf16 v[14:17], a[212:215], v[62:65], v[14:17]
 ds_read_b128 v[58:61], v132 offset:17280
 s_waitcnt lgkmcnt(2)
 v_max_u32 v74, v76, v77
 v_mfma_f32_16x16x32_bf16 v[18:21], a[216:219], v[62:65], v[18:21]
 v_max3_u32 v74, v74, v78, v79
 v_max3_u32 v74, v74, v80, v81
 v_mfma_f32_16x16x32_bf16 v[22:25], a[220:223], v[62:65], v[22:25]
 v_max3_u32 v74, v74, v82, v83
 s_waitcnt vmcnt(4)
 ds_read_b128 v[76:79], v75 offset:35904
 ds_read_b128 v[80:83], v75 offset:36960
 s_waitcnt lgkmcnt(3)
 v_mfma_f32_16x16x32_bf16 v[14:17], a[224:227], v[50:53], v[14:17]
 ds_read_b128 v[62:65], v132 offset:17344
 v_mul_f32 v66, v66, v2
 v_mfma_f32_16x16x32_bf16 v[18:21], a[228:231], v[50:53], v[18:21]
 v_mul_f32 v67, v67, v3
 v_mul_f32 v68, v68, v4
 v_mfma_f32_16x16x32_bf16 v[22:25], a[232:235], v[50:53], v[22:25]
 v_mul_f32 v69, v69, v5
 v_mfma_f32_16x16x32_bf16 v[14:17], a[236:239], v[54:57], v[14:17]
 ds_read_b128 v[50:53], v132 offset:17408
 v_mfma_f32_16x16x32_bf16 v[18:21], a[240:243], v[54:57], v[18:21]
 s_waitcnt lgkmcnt(2)
 v_max3_u32 v74, v74, v76, v77
 v_mfma_f32_16x16x32_bf16 v[22:25], a[244:247], v[54:57], v[22:25]
 v_max3_u32 v74, v74, v78, v79
 v_max3_u32 v74, v74, v80, v81
 s_waitcnt lgkmcnt(1)
 v_mfma_f32_16x16x32_bf16 v[14:17], a[248:251], v[58:61], v[14:17]
 ds_read_b128 v[54:57], v132 offset:17472
 v_max3_u32 v74, v74, v82, v83
 s_waitcnt vmcnt(2)
 ds_read_b128 v[76:79], v75 offset:38016
 ds_read_b128 v[80:83], v75 offset:39072
 v_mfma_f32_16x16x32_bf16 v[18:21], a[252:255], v[58:61], v[18:21]
 v_exp_f32 v66, v66
 v_mfma_f32_16x16x32_bf16 v[22:25], v[144:147], v[58:61], v[22:25]
 v_exp_f32 v67, v67
 v_mfma_f32_16x16x32_bf16 v[14:17], v[148:151], v[62:65], v[14:17]
 ds_read_b128 v[58:61], v132 offset:17536
 v_add_f32 v66, 1.0, v66
 v_mfma_f32_16x16x32_bf16 v[18:21], v[152:155], v[62:65], v[18:21]
 v_exp_f32 v68, v68
 v_mfma_f32_16x16x32_bf16 v[22:25], v[156:159], v[62:65], v[22:25]
 s_waitcnt lgkmcnt(1)
 v_max3_u32 v74, v74, v76, v77
 v_mfma_f32_16x16x32_bf16 v[14:17], v[160:163], v[50:53], v[14:17]
 ds_read_b128 v[62:65], v132 offset:17600
 v_max3_u32 v74, v74, v78, v79
 v_max3_u32 v74, v74, v80, v81
 v_mfma_f32_16x16x32_bf16 v[18:21], v[164:167], v[50:53], v[18:21]
 v_max3_u32 v74, v74, v82, v83
 s_waitcnt vmcnt(0)
 ds_read_b128 v[76:79], v75 offset:40128
 ds_read_b128 v[80:83], v75 offset:41184
 v_mfma_f32_16x16x32_bf16 v[22:25], v[168:171], v[50:53], v[22:25]
 v_exp_f32 v69, v69
 v_mfma_f32_16x16x32_bf16 v[14:17], v[172:175], v[54:57], v[14:17]
 ds_read_b128 v[50:53], v132 offset:17664
 v_add_f32_e64 v67, 1.0, v67
 v_mfma_f32_16x16x32_bf16 v[18:21], v[176:179], v[54:57], v[18:21]
 v_add_f32_e64 v68, 1.0, v68
 v_add_f32_e64 v69, 1.0, v69
 v_mfma_f32_16x16x32_bf16 v[22:25], v[180:183], v[54:57], v[22:25]
 s_waitcnt lgkmcnt(3)
 v_mfma_f32_16x16x32_bf16 v[14:17], v[184:187], v[58:61], v[14:17]
 ds_read_b128 v[54:57], v132 offset:17728
 s_waitcnt lgkmcnt(2)
 v_max3_u32 v74, v74, v76, v77
 v_mfma_f32_16x16x32_bf16 v[18:21], v[188:191], v[58:61], v[18:21]
 v_max3_u32 v74, v74, v78, v79
 v_max3_u32 v74, v74, v80, v81
 v_mfma_f32_16x16x32_bf16 v[22:25], v[192:195], v[58:61], v[22:25]
 v_max3_u32 v74, v74, v82, v83
 v_mfma_f32_16x16x32_bf16 v[14:17], v[196:199], v[62:65], v[14:17]
 ds_read_b128 v[58:61], v132 offset:17792
 v_cmp_eq_u32 vcc, -1, v74
 s_cbranch_vccnz Lrt_28
Lbk_29:
 s_barrier
 v_mfma_f32_16x16x32_bf16 v[18:21], v[200:203], v[62:65], v[18:21]
 v_rcp_f32 v66, v66
 v_mfma_f32_16x16x32_bf16 v[22:25], v[204:207], v[62:65], v[22:25]
 v_mul_f32 v66, v66, v2
 s_waitcnt lgkmcnt(1)
 v_mfma_f32_16x16x32_bf16 v[14:17], v[208:211], v[50:53], v[14:17]
 ds_read_b128 v[62:65], v132 offset:17856
 v_mfma_f32_16x16x32_bf16 v[18:21], v[212:215], v[50:53], v[18:21]
 v_rcp_f32_e64 v67, v67
 v_mfma_f32_16x16x32_bf16 v[22:25], v[216:219], v[50:53], v[22:25]
 v_rcp_f32_e64 v68, v68
 v_mfma_f32_16x16x32_bf16 v[14:17], v[220:223], v[54:57], v[14:17]
 ds_read_b128 v[50:53], v132 offset:33792
 v_mul_f32_e64 v67, v67, v3
 v_mfma_f32_16x16x32_bf16 v[18:21], v[224:227], v[54:57], v[18:21]
 v_rcp_f32_e64 v69, v69
 v_mfma_f32_16x16x32_bf16 v[22:25], v[228:231], v[54:57], v[22:25]
 v_mul_f32 v68, v68, v4
 s_waitcnt lgkmcnt(1)
 v_mfma_f32_16x16x32_bf16 v[14:17], v[232:235], v[58:61], v[14:17]
 ds_read_b128 v[54:57], v132 offset:33856
 v_mul_f32_e64 v69, v69, v5
 v_mfma_f32_16x16x32_bf16 v[18:21], v[236:239], v[58:61], v[18:21]
 v_cvt_pk_bf16_f32 v66, v66, v67
 v_cvt_pk_bf16_f32 v67, v68, v69
 v_mfma_f32_16x16x32_bf16 v[22:25], v[240:243], v[58:61], v[22:25]
 ds_write_b64 v133, v[66:67] offset:0
 v_mul_f32_e64 v70, v6, v6
 v_mfma_f32_16x16x32_bf16 v[14:17], v[244:247], v[62:65], v[14:17]
 ds_read_b128 v[58:61], v132 offset:33920
 v_mul_f32_e64 v71, v7, v7
 v_mfma_f32_16x16x32_bf16 v[18:21], v[248:251], v[62:65], v[18:21]
 v_mul_f32_e64 v72, v8, v8
 v_mul_f32 v73, v9, v9
 v_mfma_f32_16x16x32_bf16 v[22:25], v[252:255], v[62:65], v[22:25]
 v_fma_f32 v70, v70, s100, v140
 v_fma_f32 v71, v71, s100, v140
 s_waitcnt lgkmcnt(2)
 v_mfma_f32_16x16x32_bf16 v[26:29], a[176:179], v[50:53], v[120:123]
 ds_read_b128 v[62:65], v132 offset:33984
 v_fma_f32 v72, v72, s100, v140
 v_mfma_f32_16x16x32_bf16 v[30:33], a[180:183], v[50:53], v[124:127]
 v_fma_f32 v73, v73, s100, v140
 v_mul_f32 v70, v70, v6
 v_mfma_f32_16x16x32_bf16 v[34:37], a[184:187], v[50:53], v[128:131]
 v_mul_f32 v71, v71, v7
 v_mul_f32_e64 v72, v72, v8
 v_mfma_f32_16x16x32_bf16 v[26:29], a[188:191], v[54:57], v[26:29]
 ds_read_b128 v[50:53], v132 offset:34048
 v_mul_f32 v73, v73, v9
 v_mfma_f32_16x16x32_bf16 v[30:33], a[192:195], v[54:57], v[30:33]
 v_exp_f32 v70, v70
 v_mfma_f32_16x16x32_bf16 v[34:37], a[196:199], v[54:57], v[34:37]
 v_add_f32 v70, 1.0, v70
 s_waitcnt lgkmcnt(1)
 v_mfma_f32_16x16x32_bf16 v[26:29], a[200:203], v[58:61], v[26:29]
 ds_read_b128 v[54:57], v132 offset:34112
 v_mfma_f32_16x16x32_bf16 v[30:33], a[204:207], v[58:61], v[30:33]
 v_exp_f32 v71, v71
 v_mfma_f32_16x16x32_bf16 v[34:37], a[208:211], v[58:61], v[34:37]
 v_exp_f32 v72, v72
 v_mfma_f32_16x16x32_bf16 v[26:29], a[212:215], v[62:65], v[26:29]
 ds_read_b128 v[58:61], v132 offset:34176
 v_add_f32 v71, 1.0, v71
 v_mfma_f32_16x16x32_bf16 v[30:33], a[216:219], v[62:65], v[30:33]
 v_exp_f32 v73, v73
 v_mfma_f32_16x16x32_bf16 v[34:37], a[220:223], v[62:65], v[34:37]
 v_add_f32 v72, 1.0, v72
 s_waitcnt lgkmcnt(1)
 v_mfma_f32_16x16x32_bf16 v[26:29], a[224:227], v[50:53], v[26:29]
 ds_read_b128 v[62:65], v132 offset:34240
 v_add_f32_e64 v73, 1.0, v73
 v_mfma_f32_16x16x32_bf16 v[30:33], a[228:231], v[50:53], v[30:33]
 v_rcp_f32 v70, v70
 v_mfma_f32_16x16x32_bf16 v[34:37], a[232:235], v[50:53], v[34:37]
 v_rcp_f32 v71, v71
 v_mfma_f32_16x16x32_bf16 v[26:29], a[236:239], v[54:57], v[26:29]
 ds_read_b128 v[50:53], v132 offset:34304
 v_mul_f32 v70, v70, v6
 v_mfma_f32_16x16x32_bf16 v[30:33], a[240:243], v[54:57], v[30:33]
 v_rcp_f32 v72, v72
 v_mfma_f32_16x16x32_bf16 v[34:37], a[244:247], v[54:57], v[34:37]
 v_mul_f32 v71, v71, v7
 s_waitcnt lgkmcnt(1)
 v_mfma_f32_16x16x32_bf16 v[26:29], a[248:251], v[58:61], v[26:29]
 ds_read_b128 v[54:57], v132 offset:34368
 v_mul_f32_e64 v72, v72, v8
 v_mfma_f32_16x16x32_bf16 v[30:33], a[252:255], v[58:61], v[30:33]
 v_rcp_f32 v73, v73
 v_mfma_f32_16x16x32_bf16 v[34:37], v[144:147], v[58:61], v[34:37]
 v_mul_f32 v73, v73, v9
 v_cvt_pk_bf16_f32 v70, v70, v71
 v_mfma_f32_16x16x32_bf16 v[26:29], v[148:151], v[62:65], v[26:29]
 ds_read_b128 v[58:61], v132 offset:34432
 v_cvt_pk_bf16_f32 v71, v72, v73
 v_mfma_f32_16x16x32_bf16 v[30:33], v[152:155], v[62:65], v[30:33]
 ds_write_b64 v133, v[70:71] offset:32
 v_mul_f32 v66, v10, v10
 v_mfma_f32_16x16x32_bf16 v[34:37], v[156:159], v[62:65], v[34:37]
 v_mul_f32_e64 v67, v11, v11
 s_waitcnt lgkmcnt(2)
 v_mfma_f32_16x16x32_bf16 v[26:29], v[160:163], v[50:53], v[26:29]
 ds_read_b128 v[62:65], v132 offset:34496
 v_mul_f32 v68, v12, v12
 v_mfma_f32_16x16x32_bf16 v[30:33], v[164:167], v[50:53], v[30:33]
 v_mul_f32 v69, v13, v13
 v_fma_f32 v66, v66, s100, v140
 v_mfma_f32_16x16x32_bf16 v[34:37], v[168:171], v[50:53], v[34:37]
 v_fma_f32 v67, v67, s100, v140
 v_fma_f32 v68, v68, s100, v140
 v_mfma_f32_16x16x32_bf16 v[26:29], v[172:175], v[54:57], v[26:29]
 ds_read_b128 v[50:53], v132 offset:34560
 v_fma_f32 v69, v69, s100, v140
 v_mfma_f32_16x16x32_bf16 v[30:33], v[176:179], v[54:57], v[30:33]
 v_mul_f32 v66, v66, v10
 v_mul_f32 v67, v67, v11
 v_mfma_f32_16x16x32_bf16 v[34:37], v[180:183], v[54:57], v[34:37]
 v_mul_f32 v68, v68, v12
 s_waitcnt lgkmcnt(1)
 v_mfma_f32_16x16x32_bf16 v[26:29], v[184:187], v[58:61], v[26:29]
 ds_read_b128 v[54:57], v132 offset:34624
 v_mul_f32 v69, v69, v13
 v_mfma_f32_16x16x32_bf16 v[30:33], v[188:191], v[58:61], v[30:33]
 v_exp_f32 v66, v66
 v_mfma_f32_16x16x32_bf16 v[34:37], v[192:195], v[58:61], v[34:37]
 v_exp_f32 v67, v67
 v_mfma_f32_16x16x32_bf16 v[26:29], v[196:199], v[62:65], v[26:29]
 ds_read_b128 v[58:61], v132 offset:34688
 v_add_f32 v66, 1.0, v66
 v_mfma_f32_16x16x32_bf16 v[30:33], v[200:203], v[62:65], v[30:33]
 v_exp_f32 v68, v68
 v_mfma_f32_16x16x32_bf16 v[34:37], v[204:207], v[62:65], v[34:37]
 v_add_f32_e64 v67, 1.0, v67
 s_waitcnt lgkmcnt(1)
 v_mfma_f32_16x16x32_bf16 v[26:29], v[208:211], v[50:53], v[26:29]
 ds_read_b128 v[62:65], v132 offset:34752
 v_add_f32 v68, 1.0, v68
 v_mfma_f32_16x16x32_bf16 v[30:33], v[212:215], v[50:53], v[30:33]
 v_exp_f32 v69, v69
 v_mfma_f32_16x16x32_bf16 v[34:37], v[216:219], v[50:53], v[34:37]
 v_add_f32 v69, 1.0, v69
 v_mfma_f32_16x16x32_bf16 v[26:29], v[220:223], v[54:57], v[26:29]
 ds_read_b128 v[50:53], v132 offset:50688
 v_mfma_f32_16x16x32_bf16 v[30:33], v[224:227], v[54:57], v[30:33]
 v_rcp_f32 v66, v66
 v_mfma_f32_16x16x32_bf16 v[34:37], v[228:231], v[54:57], v[34:37]
 v_mul_f32 v66, v66, v10
 s_waitcnt lgkmcnt(1)
 v_mfma_f32_16x16x32_bf16 v[26:29], v[232:235], v[58:61], v[26:29]
 ds_read_b128 v[54:57], v132 offset:50752
 v_mfma_f32_16x16x32_bf16 v[30:33], v[236:239], v[58:61], v[30:33]
 v_rcp_f32 v67, v67
 v_mfma_f32_16x16x32_bf16 v[34:37], v[240:243], v[58:61], v[34:37]
 v_rcp_f32 v68, v68
 v_mfma_f32_16x16x32_bf16 v[26:29], v[244:247], v[62:65], v[26:29]
 ds_read_b128 v[58:61], v132 offset:50816
 v_mul_f32_e64 v67, v67, v11
 v_mfma_f32_16x16x32_bf16 v[30:33], v[248:251], v[62:65], v[30:33]
 v_rcp_f32_e64 v69, v69
 v_mfma_f32_16x16x32_bf16 v[34:37], v[252:255], v[62:65], v[34:37]
 v_mul_f32 v68, v68, v12
 v_mul_f32_e64 v69, v69, v13
 s_waitcnt lgkmcnt(1)
 v_mfma_f32_16x16x32_bf16 v[38:41], a[176:179], v[50:53], v[120:123]
 ds_read_b128 v[62:65], v132 offset:50880
 v_cvt_pk_bf16_f32 v66, v66, v67
 v_mfma_f32_16x16x32_bf16 v[42:45], a[180:183], v[50:53], v[124:127]
 v_cvt_pk_bf16_f32 v67, v68, v69
 ds_write_b64 v133, v[66:67] offset:64
 v_mfma_f32_16x16x32_bf16 v[46:49], a[184:187], v[50:53], v[128:131]
 v_mul_f32_e64 v70, v14, v14
 v_mul_f32_e64 v71, v15, v15
 v_mfma_f32_16x16x32_bf16 v[38:41], a[188:191], v[54:57], v[38:41]
 ds_read_b128 v[50:53], v132 offset:50944
 v_mul_f32_e64 v72, v16, v16
 v_mfma_f32_16x16x32_bf16 v[42:45], a[192:195], v[54:57], v[42:45]
 v_mul_f32 v73, v17, v17
 v_fma_f32 v70, v70, s100, v140
 v_mfma_f32_16x16x32_bf16 v[46:49], a[196:199], v[54:57], v[46:49]
 v_fma_f32 v71, v71, s100, v140
 s_waitcnt lgkmcnt(2)
 v_mfma_f32_16x16x32_bf16 v[38:41], a[200:203], v[58:61], v[38:41]
 ds_read_b128 v[54:57], v132 offset:51008
 v_fma_f32 v72, v72, s100, v140
 v_mfma_f32_16x16x32_bf16 v[42:45], a[204:207], v[58:61], v[42:45]
 v_fma_f32 v73, v73, s100, v140
 v_mul_f32 v70, v70, v14
 v_mfma_f32_16x16x32_bf16 v[46:49], a[208:211], v[58:61], v[46:49]
 v_mul_f32 v71, v71, v15
 v_mul_f32_e64 v72, v72, v16
 v_mfma_f32_16x16x32_bf16 v[38:41], a[212:215], v[62:65], v[38:41]
 ds_read_b128 v[58:61], v132 offset:51072
 v_mul_f32 v73, v73, v17
 v_mfma_f32_16x16x32_bf16 v[42:45], a[216:219], v[62:65], v[42:45]
 v_exp_f32 v70, v70
 v_mfma_f32_16x16x32_bf16 v[46:49], a[220:223], v[62:65], v[46:49]
 v_add_f32 v70, 1.0, v70
 s_waitcnt lgkmcnt(1)
 v_mfma_f32_16x16x32_bf16 v[38:41], a[224:227], v[50:53], v[38:41]
 ds_read_b128 v[62:65], v132 offset:51136
 v_mfma_f32_16x16x32_bf16 v[42:45], a[228:231], v[50:53], v[42:45]
 v_exp_f32 v71, v71
 v_mfma_f32_16x16x32_bf16 v[46:49], a[232:235], v[50:53], v[46:49]
 v_exp_f32 v72, v72
 v_mfma_f32_16x16x32_bf16 v[38:41], a[236:239], v[54:57], v[38:41]
 ds_read_b128 v[50:53], v132 offset:51200
 v_add_f32 v71, 1.0, v71
 v_mfma_f32_16x16x32_bf16 v[42:45], a[240:243], v[54:57], v[42:45]
 v_exp_f32 v73, v73
 v_mfma_f32_16x16x32_bf16 v[46:49], a[244:247], v[54:57], v[46:49]
 v_add_f32 v72, 1.0, v72
 s_waitcnt lgkmcnt(1)
 v_mfma_f32_16x16x32_bf16 v[38:41], a[248:251], v[58:61], v[38:41]
 ds_read_b128 v[54:57], v132 offset:51264
 v_add_f32_e64 v73, 1.0, v73
 v_mfma_f32_16x16x32_bf16 v[42:45], a[252:255], v[58:61], v[42:45]
 v_rcp_f32 v70, v70
 v_mfma_f32_16x16x32_bf16 v[46:49], v[144:147], v[58:61], v[46:49]
 v_rcp_f32 v71, v71
 v_mfma_f32_16x16x32_bf16 v[38:41], v[148:151], v[62:65], v[38:41]
 ds_read_b128 v[58:61], v132 offset:51328
 v_mul_f32 v70, v70, v14
 v_mfma_f32_16x16x32_bf16 v[42:45], v[152:155], v[62:65], v[42:45]
 v_rcp_f32 v72, v72
 v_mfma_f32_16x16x32_bf16 v[46:49], v[156:159], v[62:65], v[46:49]
 v_mul_f32 v71, v71, v15
 s_waitcnt lgkmcnt(1)
 v_mfma_f32_16x16x32_bf16 v[38:41], v[160:163], v[50:53], v[38:41]
 ds_read_b128 v[62:65], v132 offset:51392
 v_mul_f32_e64 v72, v72, v16
 v_mfma_f32_16x16x32_bf16 v[42:45], v[164:167], v[50:53], v[42:45]
 v_rcp_f32 v73, v73
 v_mfma_f32_16x16x32_bf16 v[46:49], v[168:171], v[50:53], v[46:49]
 v_mul_f32 v73, v73, v17
 v_cvt_pk_bf16_f32 v70, v70, v71
 v_mfma_f32_16x16x32_bf16 v[38:41], v[172:175], v[54:57], v[38:41]
 ds_read_b128 v[50:53], v132 offset:51456
 v_cvt_pk_bf16_f32 v71, v72, v73
 v_mfma_f32_16x16x32_bf16 v[42:45], v[176:179], v[54:57], v[42:45]
 ds_write_b64 v133, v[70:71] offset:6400
 v_mul_f32 v66, v18, v18
 v_mfma_f32_16x16x32_bf16 v[46:49], v[180:183], v[54:57], v[46:49]
 v_mul_f32_e64 v67, v19, v19
 s_waitcnt lgkmcnt(2)
 v_mfma_f32_16x16x32_bf16 v[38:41], v[184:187], v[58:61], v[38:41]
 ds_read_b128 v[54:57], v132 offset:51520
 v_mul_f32 v68, v20, v20
 v_mfma_f32_16x16x32_bf16 v[42:45], v[188:191], v[58:61], v[42:45]
 v_mul_f32 v69, v21, v21
 v_fma_f32 v66, v66, s100, v140
 v_mfma_f32_16x16x32_bf16 v[46:49], v[192:195], v[58:61], v[46:49]
 v_fma_f32 v67, v67, s100, v140
 v_fma_f32 v68, v68, s100, v140
 v_mfma_f32_16x16x32_bf16 v[38:41], v[196:199], v[62:65], v[38:41]
 ds_read_b128 v[58:61], v132 offset:51584
 v_fma_f32 v69, v69, s100, v140
 v_mfma_f32_16x16x32_bf16 v[42:45], v[200:203], v[62:65], v[42:45]
 v_mul_f32 v66, v66, v18
 v_mul_f32 v67, v67, v19
 v_mfma_f32_16x16x32_bf16 v[46:49], v[204:207], v[62:65], v[46:49]
 v_mul_f32 v68, v68, v20
 s_waitcnt lgkmcnt(1)
 v_mfma_f32_16x16x32_bf16 v[38:41], v[208:211], v[50:53], v[38:41]
 ds_read_b128 v[62:65], v132 offset:51648
 v_mul_f32 v69, v69, v21
 v_mfma_f32_16x16x32_bf16 v[42:45], v[212:215], v[50:53], v[42:45]
 v_exp_f32 v66, v66
 v_mfma_f32_16x16x32_bf16 v[46:49], v[216:219], v[50:53], v[46:49]
 v_exp_f32 v67, v67
 v_mfma_f32_16x16x32_bf16 v[38:41], v[220:223], v[54:57], v[38:41]
 v_exp_f32 v68, v68
 v_mfma_f32_16x16x32_bf16 v[42:45], v[224:227], v[54:57], v[42:45]
 v_exp_f32_e64 v69, v69
 v_mfma_f32_16x16x32_bf16 v[46:49], v[228:231], v[54:57], v[46:49]
 v_add_f32 v66, 1.0, v66
 s_waitcnt lgkmcnt(0)
 v_mfma_f32_16x16x32_bf16 v[38:41], v[232:235], v[58:61], v[38:41]
 v_add_f32 v67, 1.0, v67
 v_add_f32 v68, 1.0, v68
 v_mfma_f32_16x16x32_bf16 v[42:45], v[236:239], v[58:61], v[42:45]
 v_add_f32 v69, 1.0, v69
 v_mfma_f32_16x16x32_bf16 v[46:49], v[240:243], v[58:61], v[46:49]
 v_rcp_f32 v66, v66
 v_mfma_f32_16x16x32_bf16 v[38:41], v[244:247], v[62:65], v[38:41]
 v_rcp_f32 v67, v67
 v_mfma_f32_16x16x32_bf16 v[42:45], v[248:251], v[62:65], v[42:45]
 v_rcp_f32 v68, v68
 v_mfma_f32_16x16x32_bf16 v[46:49], v[252:255], v[62:65], v[46:49]
 v_rcp_f32 v69, v69
 v_mul_f32 v66, v66, v18
 v_mul_f32 v67, v67, v19
 v_mul_f32 v68, v68, v20
 v_mul_f32_e64 v69, v69, v21
 v_cvt_pk_bf16_f32 v66, v66, v67
 v_cvt_pk_bf16_f32 v67, v68, v69
 ds_write_b64 v133, v[66:67] offset:6432
 v_pk_mul_f32 v[70:71], v[22:23], v[22:23]
 v_pk_mul_f32 v[72:73], v[24:25], v[24:25]
 v_pk_fma_f32 v[70:71], v[70:71], s[100:101], v[140:141] op_sel_hi:[1,0,0]
 v_pk_fma_f32 v[72:73], v[72:73], s[100:101], v[140:141] op_sel_hi:[1,0,0]
 v_pk_mul_f32 v[70:71], v[70:71], v[22:23]
 v_pk_mul_f32 v[72:73], v[72:73], v[24:25]
 v_exp_f32 v70, v70
 v_exp_f32 v71, v71
 v_exp_f32 v72, v72
 v_exp_f32 v73, v73
 v_pk_add_f32 v[70:71], v[70:71], 1.0 op_sel_hi:[1,0]
 v_pk_add_f32 v[72:73], v[72:73], 1.0 op_sel_hi:[1,0]
 v_rcp_f32 v70, v70
 v_rcp_f32 v71, v71
 v_rcp_f32 v72, v72
 v_rcp_f32_e64 v73, v73
 v_pk_mul_f32 v[70:71], v[70:71], v[22:23]
 v_pk_mul_f32 v[72:73], v[72:73], v[24:25]
 v_cvt_pk_bf16_f32 v70, v70, v71
 v_cvt_pk_bf16_f32 v71, v72, v73
 ds_write_b64 v133, v[70:71] offset:6464
 s_waitcnt lgkmcnt(0)
 s_barrier
 s_mov_b32 s88, s79
 s_add_u32 s89, s79, 0x1000
 ds_read_b128 v[74:77], v134 offset:0
 ds_read_b128 v[78:81], v134 offset:32
 ds_read_b128 v[82:85], v134 offset:64
 ds_read_b128 v[88:91], v134 offset:96
 ds_read_b128 v[92:95], v134 offset:128
 v_pk_mul_f32 v[66:67], v[26:27], v[26:27]
 v_pk_mul_f32 v[68:69], v[28:29], v[28:29]
 v_pk_fma_f32 v[66:67], v[66:67], s[100:101], v[140:141] op_sel_hi:[1,0,0]
 v_pk_fma_f32 v[68:69], v[68:69], s[100:101], v[140:141] op_sel_hi:[1,0,0]
 v_pk_mul_f32 v[66:67], v[66:67], v[26:27]
 v_pk_mul_f32 v[68:69], v[68:69], v[28:29]
 v_exp_f32 v66, v66
 v_exp_f32 v67, v67
 v_exp_f32 v68, v68
 v_exp_f32 v69, v69
 v_pk_add_f32 v[66:67], v[66:67], 1.0 op_sel_hi:[1,0]
 v_pk_add_f32 v[68:69], v[68:69], 1.0 op_sel_hi:[1,0]
 v_rcp_f32 v66, v66
 v_rcp_f32 v67, v67
 v_rcp_f32_e64 v68, v68
 v_rcp_f32_e64 v69, v69
 v_pk_mul_f32 v[66:67], v[66:67], v[26:27]
 v_pk_mul_f32 v[68:69], v[68:69], v[28:29]
 v_cvt_pk_bf16_f32 v66, v66, v67
 v_cvt_pk_bf16_f32 v67, v68, v69
 ds_write_b64 v133, v[66:67] offset:12800
 s_waitcnt lgkmcnt(4)
 v_mfma_f32_32x32x16_bf16 v[2:17], a[128:131], v[74:77], 0
 ds_read_b128 v[96:99], v134 offset:160
 v_mul_f32 v70, v30, v30
 v_mul_f32 v71, v31, v31
 v_mul_f32 v72, v32, v32
 v_mul_f32_e64 v73, v33, v33
 v_fma_f32 v70, v70, s100, v140
 v_mfma_f32_32x32x16_bf16 v[2:17], a[144:147], v[78:81], v[2:17]
 ds_read_b128 v[74:77], v134 offset:192
 v_fma_f32 v71, v71, s100, v140
 v_fma_f32 v72, v72, s100, v140
 v_fma_f32 v73, v73, s100, v140
 v_mul_f32 v70, v70, v30
 s_waitcnt lgkmcnt(4)
 v_mfma_f32_32x32x16_bf16 v[2:17], a[160:163], v[82:85], v[2:17]
 ds_read_b128 v[78:81], v134 offset:224
 v_mul_f32 v71, v71, v31
 v_mul_f32 v72, v72, v32
 v_mul_f32 v73, v73, v33
 v_exp_f32 v70, v70
 v_mfma_f32_32x32x16_bf16 v[2:17], a[0:3], v[88:91], v[2:17]
 ds_read_b128 v[82:85], v134 offset:256
 v_exp_f32 v71, v71
 v_exp_f32_e64 v72, v72
 s_waitcnt lgkmcnt(3)
 v_mfma_f32_32x32x16_bf16 v[2:17], a[4:7], v[92:95], v[2:17]
 ds_read_b128 v[88:91], v134 offset:288
 v_exp_f32 v73, v73
 v_add_f32 v70, 1.0, v70
 v_add_f32 v71, 1.0, v71
 v_add_f32 v72, 1.0, v72
 v_mfma_f32_32x32x16_bf16 v[2:17], a[8:11], v[96:99], v[2:17]
 ds_read_b128 v[92:95], v134 offset:320
 v_add_f32 v73, 1.0, v73
 v_rcp_f32_e64 v70, v70
 s_waitcnt lgkmcnt(3)
 v_mfma_f32_32x32x16_bf16 v[2:17], a[12:15], v[74:77], v[2:17]
 ds_read_b128 v[96:99], v134 offset:0
 v_rcp_f32 v71, v71
 v_rcp_f32 v72, v72
 v_mul_f32_e64 v70, v70, v30
 v_mfma_f32_32x32x16_bf16 v[2:17], a[16:19], v[78:81], v[2:17]
 ds_read_b128 v[74:77], v134 offset:32
 v_rcp_f32 v73, v73
 v_mul_f32 v71, v71, v31
 v_mul_f32 v72, v72, v32
 s_waitcnt lgkmcnt(3)
 v_mfma_f32_32x32x16_bf16 v[2:17], a[20:23], v[82:85], v[2:17]
 ds_read_b128 v[78:81], v134 offset:64
 v_mul_f32_e64 v73, v73, v33
 v_cvt_pk_bf16_f32 v70, v70, v71
 v_cvt_pk_bf16_f32 v71, v72, v73
 ds_write_b64 v133, v[70:71] offset:12832
 v_mul_f32_e64 v66, v34, v34
 v_mfma_f32_32x32x16_bf16 v[2:17], a[24:27], v[88:91], v[2:17]
 ds_read_b128 v[82:85], v134 offset:96
 v_mul_f32 v67, v35, v35
 v_mul_f32 v68, v36, v36
 v_mul_f32 v69, v37, v37
 v_fma_f32 v66, v66, s100, v140
 s_waitcnt lgkmcnt(4)
 v_mfma_f32_32x32x16_bf16 v[2:17], a[28:31], v[92:95], v[2:17]
 ds_read_b128 v[88:91], v134 offset:128
 v_fma_f32 v67, v67, s100, v140
 v_fma_f32 v68, v68, s100, v140
 v_fma_f32 v69, v69, s100, v140
 v_mul_f32 v66, v66, v34
 v_mul_f32 v67, v67, v35
 v_mfma_f32_32x32x16_bf16 v[50:65], a[132:135], v[96:99], 0
 ds_read_b128 v[92:95], v134 offset:160
 v_mul_f32 v68, v68, v36
 v_mul_f32 v69, v69, v37
 v_exp_f32 v66, v66
 s_waitcnt lgkmcnt(4)
 v_mfma_f32_32x32x16_bf16 v[50:65], a[148:151], v[74:77], v[50:65]
 ds_read_b128 v[96:99], v134 offset:192
 v_exp_f32 v67, v67
 v_exp_f32 v68, v68
 v_add_f32_e64 v66, 1.0, v66
 v_mfma_f32_32x32x16_bf16 v[50:65], a[164:167], v[78:81], v[50:65]
 ds_read_b128 v[74:77], v134 offset:224
 v_cvt_pk_bf16_f32 v18, v2, v3
 v_cvt_pk_bf16_f32 v19, v4, v5
 v_cvt_pk_bf16_f32 v20, v6, v7
 v_cvt_pk_bf16_f32 v21, v8, v9
 s_waitcnt lgkmcnt(3)
 v_mfma_f32_32x32x16_bf16 v[50:65], a[32:35], v[82:85], v[50:65]
 ds_read_b128 v[78:81], v134 offset:256
 v_permlane32_swap_b32 v18, v20
 v_permlane32_swap_b32 v19, v21
 v_add_f32 v67, 1.0, v67
 v_mfma_f32_32x32x16_bf16 v[50:65], a[36:39], v[88:91], v[50:65]
 ds_read_b128 v[82:85], v134 offset:288
 v_exp_f32_e64 v69, v69
 v_add_f32_e64 v68, 1.0, v68
 v_add_f32 v69, 1.0, v69
 s_waitcnt lgkmcnt(3)
 v_mfma_f32_32x32x16_bf16 v[50:65], a[40:43], v[92:95], v[50:65]
 ds_read_b128 v[88:91], v134 offset:320
 buffer_store_dwordx4 v[18:21], v135, s[60:63], s88 offen offset:0 nt
 v_rcp_f32_e64 v66, v66
 v_rcp_f32_e64 v67, v67
 v_mfma_f32_32x32x16_bf16 v[50:65], a[44:47], v[96:99], v[50:65]
 ds_read_b128 v[92:95], v134 offset:0
 v_rcp_f32 v68, v68
 v_rcp_f32_e64 v69, v69
 s_waitcnt lgkmcnt(3)
 v_mfma_f32_32x32x16_bf16 v[50:65], a[48:51], v[74:77], v[50:65]
 ds_read_b128 v[96:99], v134 offset:32
 v_cvt_pk_bf16_f32 v22, v10, v11
 v_cvt_pk_bf16_f32 v23, v12, v13
 v_cvt_pk_bf16_f32 v24, v14, v15
 v_cvt_pk_bf16_f32 v25, v16, v17
 v_mul_f32 v66, v66, v34
 v_mfma_f32_32x32x16_bf16 v[50:65], a[52:55], v[78:81], v[50:65]
 ds_read_b128 v[74:77], v134 offset:64
 v_permlane32_swap_b32 v22, v24
 v_permlane32_swap_b32 v23, v25
 s_waitcnt lgkmcnt(3)
 v_mfma_f32_32x32x16_bf16 v[50:65], a[56:59], v[82:85], v[50:65]
 ds_read_b128 v[78:81], v134 offset:96
 v_mul_f32 v67, v67, v35
 v_mul_f32 v68, v68, v36
 v_mul_f32_e64 v69, v69, v37
 v_cvt_pk_bf16_f32 v66, v66, v67
 v_cvt_pk_bf16_f32 v67, v68, v69
 v_mfma_f32_32x32x16_bf16 v[50:65], a[60:63], v[88:91], v[50:65]
 ds_read_b128 v[82:85], v134 offset:128
 buffer_store_dwordx4 v[22:25], v135, s[60:63], s88 offen offset:128 nt
 ds_write_b64 v133, v[66:67] offset:12864
 v_mul_f32 v70, v38, v38
 v_mul_f32 v71, v39, v39
 v_mul_f32 v72, v40, v40
 s_waitcnt lgkmcnt(4)
 v_mfma_f32_32x32x16_bf16 v[2:17], a[136:139], v[92:95], 0
 ds_read_b128 v[88:91], v134 offset:160
 v_mul_f32_e64 v73, v41, v41
 v_fma_f32 v70, v70, s100, v140
 v_fma_f32 v71, v71, s100, v140
 v_fma_f32 v72, v72, s100, v140
 v_fma_f32 v73, v73, s100, v140
 v_mfma_f32_32x32x16_bf16 v[2:17], a[152:155], v[96:99], v[2:17]
 ds_read_b128 v[92:95], v134 offset:192
 v_mul_f32 v70, v70, v38
 v_mul_f32 v71, v71, v39
 v_mul_f32 v72, v72, v40
 v_mul_f32_e64 v73, v73, v41
 s_waitcnt lgkmcnt(4)
 v_mfma_f32_32x32x16_bf16 v[2:17], a[168:171], v[74:77], v[2:17]
 ds_read_b128 v[96:99], v134 offset:224
 v_cvt_pk_bf16_f32 v18, v50, v51
 v_cvt_pk_bf16_f32 v19, v52, v53
 v_cvt_pk_bf16_f32 v20, v54, v55
 v_cvt_pk_bf16_f32 v21, v56, v57
 v_mfma_f32_32x32x16_bf16 v[2:17], a[64:67], v[78:81], v[2:17]
 ds_read_b128 v[74:77], v134 offset:256
 v_permlane32_swap_b32 v18, v20
 v_permlane32_swap_b32 v19, v21
 s_waitcnt lgkmcnt(3)
 v_mfma_f32_32x32x16_bf16 v[2:17], a[68:71], v[82:85], v[2:17]
 ds_read_b128 v[78:81], v134 offset:288
 v_exp_f32 v70, v70
 v_exp_f32 v71, v71
 v_add_f32 v70, 1.0, v70
 v_mfma_f32_32x32x16_bf16 v[2:17], a[72:75], v[88:91], v[2:17]
 ds_read_b128 v[82:85], v134 offset:320
 buffer_store_dwordx4 v[18:21], v135, s[60:63], s88 offen offset:256 nt
 v_exp_f32 v72, v72
 v_add_f32_e64 v71, 1.0, v71
 s_waitcnt lgkmcnt(3)
 v_mfma_f32_32x32x16_bf16 v[2:17], a[76:79], v[92:95], v[2:17]
 ds_read_b128 v[88:91], v134 offset:0
 v_exp_f32_e64 v73, v73
 v_add_f32_e64 v72, 1.0, v72
 v_add_f32_e64 v73, 1.0, v73
 v_mfma_f32_32x32x16_bf16 v[2:17], a[80:83], v[96:99], v[2:17]
 ds_read_b128 v[92:95], v134 offset:32
 v_cvt_pk_bf16_f32 v22, v58, v59
 v_cvt_pk_bf16_f32 v23, v60, v61
 v_cvt_pk_bf16_f32 v24, v62, v63
 v_cvt_pk_bf16_f32 v25, v64, v65
 s_waitcnt lgkmcnt(3)
 v_mfma_f32_32x32x16_bf16 v[2:17], a[84:87], v[74:77], v[2:17]
 ds_read_b128 v[96:99], v134 offset:64
 v_permlane32_swap_b32 v22, v24
 v_permlane32_swap_b32 v23, v25
 v_mfma_f32_32x32x16_bf16 v[2:17], a[88:91], v[78:81], v[2:17]
 ds_read_b128 v[74:77], v134 offset:96
 v_rcp_f32 v70, v70
 v_rcp_f32 v71, v71
 s_waitcnt lgkmcnt(3)
 v_mfma_f32_32x32x16_bf16 v[2:17], a[92:95], v[82:85], v[2:17]
 ds_read_b128 v[78:81], v134 offset:128
 buffer_store_dwordx4 v[22:25], v135, s[60:63], s88 offen offset:384 nt
 v_rcp_f32 v72, v72
 v_rcp_f32 v73, v73
 v_mfma_f32_32x32x16_bf16 v[50:65], a[140:143], v[88:91], 0
 ds_read_b128 v[82:85], v134 offset:160
 v_mul_f32 v70, v70, v38
 v_mul_f32 v71, v71, v39
 v_mul_f32_e64 v72, v72, v40
 v_mul_f32 v73, v73, v41
 s_waitcnt lgkmcnt(3)
 v_mfma_f32_32x32x16_bf16 v[50:65], a[156:159], v[92:95], v[50:65]
 ds_read_b128 v[88:91], v134 offset:192
 v_cvt_pk_bf16_f32 v70, v70, v71
 v_cvt_pk_bf16_f32 v71, v72, v73
 ds_write_b64 v133, v[70:71] offset:19200
 v_mul_f32 v66, v42, v42
 v_mul_f32 v67, v43, v43
 v_mfma_f32_32x32x16_bf16 v[50:65], a[172:175], v[96:99], v[50:65]
 ds_read_b128 v[92:95], v134 offset:224
 v_cvt_pk_bf16_f32 v18, v2, v3
 v_cvt_pk_bf16_f32 v19, v4, v5
 v_cvt_pk_bf16_f32 v20, v6, v7
 v_cvt_pk_bf16_f32 v21, v8, v9
 s_waitcnt lgkmcnt(4)
 v_mfma_f32_32x32x16_bf16 v[50:65], a[96:99], v[74:77], v[50:65]
 ds_read_b128 v[96:99], v134 offset:256
 v_permlane32_swap_b32 v18, v20
 v_permlane32_swap_b32 v19, v21
 v_mul_f32 v68, v44, v44
 v_mfma_f32_32x32x16_bf16 v[50:65], a[100:103], v[78:81], v[50:65]
 ds_read_b128 v[74:77], v134 offset:288
 v_mul_f32 v69, v45, v45
 v_fma_f32 v66, v66, s100, v140
 v_fma_f32 v67, v67, s100, v140
 v_fma_f32 v68, v68, s100, v140
 s_waitcnt lgkmcnt(4)
 v_mfma_f32_32x32x16_bf16 v[50:65], a[104:107], v[82:85], v[50:65]
 ds_read_b128 v[78:81], v134 offset:320
 buffer_store_dwordx4 v[18:21], v135, s[60:63], s88 offen offset:512 nt
 v_fma_f32 v69, v69, s100, v140
 v_mul_f32 v66, v66, v42
 v_mul_f32 v67, v67, v43
 v_mul_f32 v68, v68, v44
 v_mfma_f32_32x32x16_bf16 v[50:65], a[108:111], v[88:91], v[50:65]
 v_mul_f32 v69, v69, v45
 v_exp_f32 v66, v66
 v_exp_f32_e64 v67, v67
 s_waitcnt lgkmcnt(2)
 v_mfma_f32_32x32x16_bf16 v[50:65], a[112:115], v[92:95], v[50:65]
 v_cvt_pk_bf16_f32 v22, v10, v11
 v_cvt_pk_bf16_f32 v23, v12, v13
 v_cvt_pk_bf16_f32 v24, v14, v15
 v_cvt_pk_bf16_f32 v25, v16, v17
 v_exp_f32 v68, v68
 v_mfma_f32_32x32x16_bf16 v[50:65], a[116:119], v[96:99], v[50:65]
 v_permlane32_swap_b32 v22, v24
 v_permlane32_swap_b32 v23, v25
 v_add_f32 v66, 1.0, v66
 s_waitcnt lgkmcnt(0)
 v_mfma_f32_32x32x16_bf16 v[50:65], a[120:123], v[74:77], v[50:65]
 v_exp_f32 v69, v69
 v_add_f32 v67, 1.0, v67
 v_add_f32 v68, 1.0, v68
 v_add_f32_e64 v69, 1.0, v69
 v_mfma_f32_32x32x16_bf16 v[50:65], a[124:127], v[78:81], v[50:65]
 buffer_store_dwordx4 v[22:25], v135, s[60:63], s88 offen offset:640 nt
 v_rcp_f32 v66, v66
 v_rcp_f32 v67, v67
 v_mul_f32 v66, v66, v42
 v_rcp_f32 v68, v68
 v_rcp_f32 v69, v69
 v_mul_f32 v67, v67, v43
 v_mul_f32 v68, v68, v44
 v_mul_f32 v69, v69, v45
 v_cvt_pk_bf16_f32 v66, v66, v67
 v_cvt_pk_bf16_f32 v67, v68, v69
 ds_write_b64 v133, v[66:67] offset:19232
 v_pk_mul_f32 v[70:71], v[46:47], v[46:47]
 v_pk_mul_f32 v[72:73], v[48:49], v[48:49]
 v_pk_fma_f32 v[70:71], v[70:71], s[100:101], v[140:141] op_sel_hi:[1,0,0]
 v_pk_fma_f32 v[72:73], v[72:73], s[100:101], v[140:141] op_sel_hi:[1,0,0]
 v_pk_mul_f32 v[70:71], v[70:71], v[46:47]
 v_pk_mul_f32 v[72:73], v[72:73], v[48:49]
 v_exp_f32 v70, v70
 v_exp_f32 v71, v71
 v_exp_f32 v72, v72
 v_exp_f32 v73, v73
 v_pk_add_f32 v[70:71], v[70:71], 1.0 op_sel_hi:[1,0]
 v_pk_add_f32 v[72:73], v[72:73], 1.0 op_sel_hi:[1,0]
 v_rcp_f32 v70, v70
 v_rcp_f32 v71, v71
 v_rcp_f32 v72, v72
 v_rcp_f32 v73, v73
 v_pk_mul_f32 v[70:71], v[70:71], v[46:47]
 v_pk_mul_f32 v[72:73], v[72:73], v[48:49]
 v_cvt_pk_bf16_f32 v70, v70, v71
 v_cvt_pk_bf16_f32 v71, v72, v73
 ds_write_b64 v133, v[70:71] offset:19264
 s_waitcnt lgkmcnt(0)
 s_barrier
 ds_read_b128 v[74:77], v134 offset:12800
 ds_read_b128 v[78:81], v134 offset:12832
 ds_read_b128 v[82:85], v134 offset:12864
 ds_read_b128 v[26:29], v134 offset:12896
 ds_read_b128 v[30:33], v134 offset:12928
 s_waitcnt lgkmcnt(3)
 v_mfma_f32_32x32x16_bf16 v[2:17], a[128:131], v[74:77], 0
 ds_read_b128 v[34:37], v134 offset:12960
 v_cvt_pk_bf16_f32 v18, v50, v51
 v_cvt_pk_bf16_f32 v19, v52, v53
 v_cvt_pk_bf16_f32 v20, v54, v55
 v_cvt_pk_bf16_f32 v21, v56, v57
 v_and_b32_e64 v38, 15, v1
 v_mfma_f32_32x32x16_bf16 v[2:17], a[144:147], v[78:81], v[2:17]
 ds_read_b128 v[74:77], v134 offset:12992
 v_permlane32_swap_b32 v18, v20
 v_permlane32_swap_b32 v19, v21
 s_waitcnt lgkmcnt(3)
 v_mfma_f32_32x32x16_bf16 v[2:17], a[160:163], v[82:85], v[2:17]
 ds_read_b128 v[78:81], v134 offset:13024
 v_and_b32_e64 v39, 1, v1
 v_lshlrev_b32_e64 v39, 4, v39
 v_mov_b32 v40, 0x3f80
 v_lshlrev_b32_e64 v39, v39, v40
 v_lshrrev_b32_e64 v38, 1, v38
 v_mfma_f32_32x32x16_bf16 v[2:17], a[0:3], v[26:29], v[2:17]
 ds_read_b128 v[82:85], v134 offset:13056
 buffer_store_dwordx4 v[18:21], v135, s[60:63], s88 offen offset:768 nt
 v_cmp_eq_u32 vcc, 0, v38
 v_cmp_eq_u32 s[92:93], 1, v38
 v_mov_b32_e64 v41, 0
 s_waitcnt lgkmcnt(3)
 v_mfma_f32_32x32x16_bf16 v[2:17], a[4:7], v[30:33], v[2:17]
 ds_read_b128 v[26:29], v134 offset:13088
 v_cndmask_b32 v88, 0, v39, vcc
 v_cndmask_b32 v89, 0, v39, s[92:93]
 v_cmp_eq_u32 vcc, 2, v38
 v_cmp_eq_u32 s[92:93], 3, v38
 v_mov_b32_e64 v41, 0
 v_mfma_f32_32x32x16_bf16 v[2:17], a[8:11], v[34:37], v[2:17]
 ds_read_b128 v[30:33], v134 offset:13120
 v_cvt_pk_bf16_f32 v22, v58, v59
 v_cvt_pk_bf16_f32 v23, v60, v61
 v_cvt_pk_bf16_f32 v24, v62, v63
 v_cvt_pk_bf16_f32 v25, v64, v65
 s_waitcnt lgkmcnt(3)
 v_mfma_f32_32x32x16_bf16 v[2:17], a[12:15], v[74:77], v[2:17]
 ds_read_b128 v[34:37], v134 offset:12800
 v_permlane32_swap_b32 v22, v24
 v_permlane32_swap_b32 v23, v25
 v_cndmask_b32 v90, 0, v39, vcc
 v_mfma_f32_32x32x16_bf16 v[2:17], a[16:19], v[78:81], v[2:17]
 ds_read_b128 v[74:77], v134 offset:12832
 v_cndmask_b32 v91, 0, v39, s[92:93]
 v_cmp_eq_u32 vcc, 4, v38
 v_cmp_eq_u32 s[92:93], 5, v38
 v_mov_b32_e64 v41, 0
 s_waitcnt lgkmcnt(3)
 v_mfma_f32_32x32x16_bf16 v[2:17], a[20:23], v[82:85], v[2:17]
 ds_read_b128 v[78:81], v134 offset:12864
 buffer_store_dwordx4 v[22:25], v135, s[60:63], s88 offen offset:896 nt
 v_cndmask_b32 v92, 0, v39, vcc
 v_cndmask_b32 v93, 0, v39, s[92:93]
 v_cmp_eq_u32 vcc, 6, v38
 v_cmp_eq_u32 s[92:93], 7, v38
 v_mfma_f32_32x32x16_bf16 v[2:17], a[24:27], v[26:29], v[2:17]
 ds_read_b128 v[82:85], v134 offset:12896
 v_mov_b32 v41, 0
 v_cndmask_b32 v94, 0, v39, vcc
 v_cndmask_b32 v95, 0, v39, s[92:93]
 s_mul_i32 s14, s3, 2080
 s_waitcnt lgkmcnt(3)
 v_mfma_f32_32x32x16_bf16 v[2:17], a[28:31], v[30:33], v[2:17]
 ds_read_b128 v[26:29], v134 offset:12928
 s_add_u32 s14, s14, 67584
 v_lshl_add_u32 v96, v1, 5, s14
 v_mfma_f32_32x32x16_bf16 v[50:65], a[132:135], v[34:37], 0
 ds_read_b128 v[30:33], v134 offset:12960
 s_waitcnt lgkmcnt(3)
 v_mfma_f32_32x32x16_bf16 v[50:65], a[148:151], v[74:77], v[50:65]
 ds_read_b128 v[34:37], v134 offset:12992
 v_mfma_f32_32x32x16_bf16 v[50:65], a[164:167], v[78:81], v[50:65]
 ds_read_b128 v[74:77], v134 offset:13024
 s_nop 1
 v_cvt_pk_bf16_f32 v18, v2, v3
 v_cvt_pk_bf16_f32 v19, v4, v5
 v_cvt_pk_bf16_f32 v20, v6, v7
 v_cvt_pk_bf16_f32 v21, v8, v9
 s_waitcnt lgkmcnt(3)
 v_mfma_f32_32x32x16_bf16 v[50:65], a[32:35], v[82:85], v[50:65]
 ds_read_b128 v[78:81], v134 offset:13056
 v_permlane32_swap_b32 v18, v20
 v_permlane32_swap_b32 v19, v21
 v_mfma_f32_32x32x16_bf16 v[50:65], a[36:39], v[26:29], v[50:65]
 ds_read_b128 v[82:85], v134 offset:13088
 s_waitcnt lgkmcnt(3)
 v_mfma_f32_32x32x16_bf16 v[50:65], a[40:43], v[30:33], v[50:65]
 ds_read_b128 v[26:29], v134 offset:13120
 buffer_store_dwordx4 v[18:21], v135, s[60:63], s89 offen offset:0 nt
 v_mfma_f32_32x32x16_bf16 v[50:65], a[44:47], v[34:37], v[50:65]
 ds_read_b128 v[30:33], v134 offset:12800
 s_waitcnt lgkmcnt(3)
 v_mfma_f32_32x32x16_bf16 v[50:65], a[48:51], v[74:77], v[50:65]
 ds_read_b128 v[34:37], v134 offset:12832
 v_cvt_pk_bf16_f32 v22, v10, v11
 v_cvt_pk_bf16_f32 v23, v12, v13
 v_cvt_pk_bf16_f32 v24, v14, v15
 v_cvt_pk_bf16_f32 v25, v16, v17
 v_mfma_f32_32x32x16_bf16 v[50:65], a[52:55], v[78:81], v[50:65]
 ds_read_b128 v[74:77], v134 offset:12864
 v_permlane32_swap_b32 v22, v24
 v_permlane32_swap_b32 v23, v25
 s_waitcnt lgkmcnt(3)
 v_mfma_f32_32x32x16_bf16 v[50:65], a[56:59], v[82:85], v[50:65]
 ds_read_b128 v[78:81], v134 offset:12896
 v_mfma_f32_32x32x16_bf16 v[50:65], a[60:63], v[26:29], v[50:65]
 ds_read_b128 v[82:85], v134 offset:12928
 buffer_store_dwordx4 v[22:25], v135, s[60:63], s89 offen offset:128 nt
 s_waitcnt lgkmcnt(3)
 v_mfma_f32_32x32x16_bf16 v[2:17], a[136:139], v[30:33], 0
 ds_read_b128 v[26:29], v134 offset:12960
 s_lshl_b32 s14, s9, 2
 s_add_u32 s14, s14, s82
 s_waitcnt vmcnt(2)
 buffer_store_dword v143, off, s[60:63], s14 offset:0
 v_mfma_f32_32x32x16_bf16 v[2:17], a[152:155], v[34:37], v[2:17]
 ds_read_b128 v[30:33], v134 offset:12992
 s_waitcnt lgkmcnt(3)
 v_mfma_f32_32x32x16_bf16 v[2:17], a[168:171], v[74:77], v[2:17]
 ds_read_b128 v[34:37], v134 offset:13024
 v_cvt_pk_bf16_f32 v18, v50, v51
 v_cvt_pk_bf16_f32 v19, v52, v53
 v_cvt_pk_bf16_f32 v20, v54, v55
 v_cvt_pk_bf16_f32 v21, v56, v57
 v_mfma_f32_32x32x16_bf16 v[2:17], a[64:67], v[78:81], v[2:17]
 ds_read_b128 v[74:77], v134 offset:13056
 v_permlane32_swap_b32 v18, v20
 v_permlane32_swap_b32 v19, v21
 s_waitcnt lgkmcnt(3)
 v_mfma_f32_32x32x16_bf16 v[2:17], a[68:71], v[82:85], v[2:17]
 ds_read_b128 v[78:81], v134 offset:13088
 v_mfma_f32_32x32x16_bf16 v[2:17], a[72:75], v[26:29], v[2:17]
 ds_read_b128 v[82:85], v134 offset:13120
 buffer_store_dwordx4 v[18:21], v135, s[60:63], s89 offen offset:256 nt
 s_waitcnt lgkmcnt(3)
 v_mfma_f32_32x32x16_bf16 v[2:17], a[76:79], v[30:33], v[2:17]
 ds_read_b128 v[26:29], v134 offset:12800
 v_mfma_f32_32x32x16_bf16 v[2:17], a[80:83], v[34:37], v[2:17]
 ds_read_b128 v[30:33], v134 offset:12832
 v_cvt_pk_bf16_f32 v22, v58, v59
 v_cvt_pk_bf16_f32 v23, v60, v61
 v_cvt_pk_bf16_f32 v24, v62, v63
 v_cvt_pk_bf16_f32 v25, v64, v65
 s_waitcnt lgkmcnt(3)
 v_mfma_f32_32x32x16_bf16 v[2:17], a[84:87], v[74:77], v[2:17]
 ds_read_b128 v[34:37], v134 offset:12864
 v_permlane32_swap_b32 v22, v24
 v_permlane32_swap_b32 v23, v25
 v_mfma_f32_32x32x16_bf16 v[2:17], a[88:91], v[78:81], v[2:17]
 ds_read_b128 v[74:77], v134 offset:12896
 s_waitcnt lgkmcnt(3)
 v_mfma_f32_32x32x16_bf16 v[2:17], a[92:95], v[82:85], v[2:17]
 ds_read_b128 v[78:81], v134 offset:12928
 buffer_store_dwordx4 v[22:25], v135, s[60:63], s89 offen offset:384 nt
 v_mfma_f32_32x32x16_bf16 v[50:65], a[140:143], v[26:29], 0
 ds_read_b128 v[82:85], v134 offset:12960
 s_waitcnt lgkmcnt(3)
 v_mfma_f32_32x32x16_bf16 v[50:65], a[156:159], v[30:33], v[50:65]
 ds_read_b128 v[26:29], v134 offset:12992
 v_mfma_f32_32x32x16_bf16 v[50:65], a[172:175], v[34:37], v[50:65]
 ds_read_b128 v[30:33], v134 offset:13024
 s_nop 2
 v_cvt_pk_bf16_f32 v18, v2, v3
 v_cvt_pk_bf16_f32 v19, v4, v5
 v_cvt_pk_bf16_f32 v20, v6, v7
 v_cvt_pk_bf16_f32 v21, v8, v9
 s_waitcnt lgkmcnt(3)
 v_mfma_f32_32x32x16_bf16 v[50:65], a[96:99], v[74:77], v[50:65]
 ds_read_b128 v[34:37], v134 offset:13056
 v_permlane32_swap_b32 v18, v20
 v_permlane32_swap_b32 v19, v21
 v_mfma_f32_32x32x16_bf16 v[50:65], a[100:103], v[78:81], v[50:65]
 ds_read_b128 v[74:77], v134 offset:13088
 buffer_load_dword v87, v142, s[60:63], s82 offen offset:0 sc1
 s_waitcnt lgkmcnt(3)
 v_mfma_f32_32x32x16_bf16 v[50:65], a[104:107], v[82:85], v[50:65]
 ds_read_b128 v[78:81], v134 offset:13120
 buffer_store_dwordx4 v[18:21], v135, s[60:63], s89 offen offset:512 nt
 v_mfma_f32_32x32x16_bf16 v[50:65], a[108:111], v[26:29], v[50:65]
 s_waitcnt lgkmcnt(2)
 v_mfma_f32_32x32x16_bf16 v[50:65], a[112:115], v[30:33], v[50:65]
 v_cvt_pk_bf16_f32 v22, v10, v11
 v_cvt_pk_bf16_f32 v23, v12, v13
 v_cvt_pk_bf16_f32 v24, v14, v15
 v_cvt_pk_bf16_f32 v25, v16, v17
 v_mfma_f32_32x32x16_bf16 v[50:65], a[116:119], v[34:37], v[50:65]
 v_permlane32_swap_b32 v22, v24
 v_permlane32_swap_b32 v23, v25
 s_waitcnt lgkmcnt(0)
 v_mfma_f32_32x32x16_bf16 v[50:65], a[120:123], v[74:77], v[50:65]
 v_mfma_f32_32x32x16_bf16 v[50:65], a[124:127], v[78:81], v[50:65]
 buffer_store_dwordx4 v[22:25], v135, s[60:63], s89 offen offset:640 nt
 ds_read_b128 v[2:5], v137
 ds_read_b128 v[6:9], v137 offset:256
 ds_read_b128 v[10:13], v137 offset:34816
 ds_read_b128 v[14:17], v137 offset:35072
 s_nop 6
 v_cvt_pk_bf16_f32 v18, v50, v51
 v_cvt_pk_bf16_f32 v19, v52, v53
 v_cvt_pk_bf16_f32 v20, v54, v55
 v_cvt_pk_bf16_f32 v21, v56, v57
 v_cvt_pk_bf16_f32 v22, v58, v59
 v_cvt_pk_bf16_f32 v23, v60, v61
 v_cvt_pk_bf16_f32 v24, v62, v63
 v_cvt_pk_bf16_f32 v25, v64, v65
 v_permlane32_swap_b32 v18, v20
 v_permlane32_swap_b32 v19, v21
 buffer_store_dwordx4 v[18:21], v135, s[60:63], s89 offen offset:768 nt
 v_permlane32_swap_b32 v22, v24
 v_permlane32_swap_b32 v23, v25
 buffer_store_dwordx4 v[22:25], v135, s[60:63], s89 offen offset:896 nt
 s_add_u32 s14, s80, 0
 s_add_u32 s15, s81, 0
 s_waitcnt vmcnt(4)
 v_cmp_ne_u32 vcc, s7, v87
 s_cbranch_vccnz Lrt_31
Lbk_32:
 buffer_load_dwordx4 v[26:29], v136, s[60:63], s14 offen offset:0 sc1
 buffer_load_dwordx4 v[30:33], v136, s[60:63], s15 offen offset:0 sc1
 buffer_load_dwordx4 v[34:37], v136, s[60:63], s14 offen offset:256 sc1
 buffer_load_dwordx4 v[38:41], v136, s[60:63], s15 offen offset:256 sc1
 buffer_load_dwordx4 v[42:45], v136, s[60:63], s14 offen offset:512 sc1
 buffer_load_dwordx4 v[46:49], v136, s[60:63], s15 offen offset:512 sc1
 buffer_load_dwordx4 v[66:69], v136, s[60:63], s14 offen offset:768 sc1
 buffer_load_dwordx4 v[70:73], v136, s[60:63], s15 offen offset:768 sc1
 v_bfe_u32 v18, v1, 1, 2
 v_lshlrev_b32_e64 v18, 10, v18
 v_subrev_u32 v19, 67584, v137
 v_bfe_u32 v20, v1, 1, 2
 v_mul_u32_u24 v20, 2080, v20
 v_sub_u32 v19, v19, v20
 v_lshrrev_b32 v19, 1, v19
 v_add_u32 v18, v18, v19
 s_lshl_b32 s86, s6, 13
 s_add_u32 s87, s86, 4096
 s_lshl_b32 s14, s9, 2
 s_add_u32 s14, s14, s82
 s_waitcnt vmcnt(8)
 buffer_store_dword v143, off, s[60:63], s14 offset:512
 s_waitcnt vmcnt(8) lgkmcnt(3)
 v_mfma_f32_16x16x32_bf16 v[2:5], v[88:91], v[26:29], v[2:5]
 s_waitcnt vmcnt(7)
 v_mfma_f32_16x16x32_bf16 v[2:5], v[88:91], v[30:33], v[2:5]
 s_waitcnt vmcnt(6)
 v_mfma_f32_16x16x32_bf16 v[2:5], v[92:95], v[34:37], v[2:5]
 s_waitcnt vmcnt(5)
 v_mfma_f32_16x16x32_bf16 v[2:5], v[92:95], v[38:41], v[2:5]
 s_waitcnt vmcnt(4) lgkmcnt(2)
 v_mfma_f32_16x16x32_bf16 v[6:9], v[88:91], v[42:45], v[6:9]
 s_waitcnt vmcnt(3)
 v_mfma_f32_16x16x32_bf16 v[6:9], v[88:91], v[46:49], v[6:9]
 s_waitcnt vmcnt(2)
 v_mfma_f32_16x16x32_bf16 v[6:9], v[92:95], v[66:69], v[6:9]
 s_waitcnt vmcnt(1)
 v_mfma_f32_16x16x32_bf16 v[6:9], v[92:95], v[70:73], v[6:9]
 buffer_load_dword v87, v142, s[60:63], s82 offen offset:512 sc1
 s_add_u32 s14, s80, 4096
 s_add_u32 s15, s81, 4096
 s_waitcnt vmcnt(0)
 v_cmp_ne_u32 vcc, s7, v87
 s_cbranch_vccnz Lrt_34
Lbk_35:
 buffer_load_dwordx4 v[34:37], v136, s[60:63], s14 offen offset:0 sc1
 buffer_load_dwordx4 v[38:41], v136, s[60:63], s15 offen offset:0 sc1
 buffer_load_dwordx4 v[42:45], v136, s[60:63], s14 offen offset:256 sc1
 buffer_load_dwordx4 v[46:49], v136, s[60:63], s15 offen offset:256 sc1
 buffer_load_dwordx4 v[50:53], v136, s[60:63], s14 offen offset:512 sc1
 buffer_load_dwordx4 v[54:57], v136, s[60:63], s15 offen offset:512 sc1
 buffer_load_dwordx4 v[58:61], v136, s[60:63], s14 offen offset:768 sc1
 buffer_load_dwordx4 v[62:65], v136, s[60:63], s15 offen offset:768 sc1
 v_cvt_pk_bf16_f32 v20, v2, v3
 v_cvt_pk_bf16_f32 v21, v4, v5
 buffer_store_dwordx2 v[20:21], v18, s[72:75], s86 offen offset:0 nt
 v_cvt_pk_bf16_f32 v22, v6, v7
 v_cvt_pk_bf16_f32 v23, v8, v9
 buffer_store_dwordx2 v[22:23], v18, s[72:75], s86 offen offset:128 nt
 s_waitcnt vmcnt(9) lgkmcnt(1)
 v_mfma_f32_16x16x32_bf16 v[10:13], v[88:91], v[34:37], v[10:13]
 s_waitcnt vmcnt(8)
 v_mfma_f32_16x16x32_bf16 v[10:13], v[88:91], v[38:41], v[10:13]
 s_waitcnt vmcnt(7)
 v_mfma_f32_16x16x32_bf16 v[10:13], v[92:95], v[42:45], v[10:13]
 s_waitcnt vmcnt(6)
 v_mfma_f32_16x16x32_bf16 v[10:13], v[92:95], v[46:49], v[10:13]
 s_waitcnt vmcnt(5) lgkmcnt(0)
 v_mfma_f32_16x16x32_bf16 v[14:17], v[88:91], v[50:53], v[14:17]
 s_waitcnt vmcnt(4)
 v_mfma_f32_16x16x32_bf16 v[14:17], v[88:91], v[54:57], v[14:17]
 s_waitcnt vmcnt(3)
 v_mfma_f32_16x16x32_bf16 v[14:17], v[92:95], v[58:61], v[14:17]
 s_waitcnt vmcnt(2)
 v_mfma_f32_16x16x32_bf16 v[14:17], v[92:95], v[62:65], v[14:17]
 v_cvt_pk_bf16_f32 v20, v10, v11
 v_cvt_pk_bf16_f32 v21, v12, v13
 buffer_store_dwordx2 v[20:21], v18, s[72:75], s87 offen offset:0 nt
 s_nop 4
 v_cvt_pk_bf16_f32 v22, v14, v15
 v_cvt_pk_bf16_f32 v23, v16, v17
 buffer_store_dwordx2 v[22:23], v18, s[72:75], s87 offen offset:128 nt
 s_endpgm
 s_nop 0
Lrt_6:
 s_nop 7
 s_nop 7
 s_mov_b32 s85, 0
 s_mov_b32 s83, m0
Llp_8:
 buffer_load_dword v82, v84, s[60:63], s89 offen sc1
 buffer_load_dword v83, v84, s[60:63], s89 offen offset:2048 sc1
 s_waitcnt vmcnt(0)
 v_xor_b32_e64 v82, s7, v82
 v_xor_b32_e64 v83, s7, v83
 v_or_b32_e64 v82, v82, v83
 v_cmp_ne_u32 vcc, 0, v82
 s_mov_b32 m0, s83
 s_nop 2
 s_cbranch_vccz Lbk_7
 s_add_u32 s85, s85, 1
 s_cmp_lt_u32 s85, 262144
 s_cbranch_scc1 Llp_8
 s_branch Lbk_7
Lrt_9:
 s_nop 7
 s_nop 7
 s_mov_b32 s85, 0
 s_mov_b32 s83, m0
Llp_11:
 s_mov_b64 exec, vcc
 buffer_load_dwordx4 v[76:79], v74, s[60:63], s88 offen sc1
 buffer_load_dwordx4 v[80:83], v74, s[60:63], s87 offen sc1
 s_mov_b64 exec, -1
 s_waitcnt vmcnt(0)
 v_max3_u32 v75, v76, v77, v78
 v_max3_u32 v85, v79, v80, v81
 v_max3_u32 v75, v75, v82, v83
 v_max_u32_e64 v75, v75, v85
 v_cmp_eq_u32 vcc, -1, v75
 s_mov_b32 m0, s83
 s_nop 2
 s_cbranch_vccz Lbk_10
 s_add_u32 s85, s85, 1
 s_cmp_lt_u32 s85, 262144
 s_cbranch_scc1 Llp_11
 s_branch Lbk_10
Lrt_12:
 s_nop 7
 s_nop 7
 s_mov_b32 s85, 0
 s_mov_b32 s83, m0
Llp_14:
 s_add_u32 s86, s77, 0
 s_add_u32 s87, s78, 0
 s_add_u32 m0, s101, 0
 s_nop 0
 buffer_load_dwordx4 v138, s[60:63], s86 offen offset:0 sc1 lds
 s_add_u32 m0, s101, 32
 s_nop 0
 buffer_load_dwordx4 v138, s[60:63], s86 offen offset:1024 sc1 lds
 s_add_u32 m0, s101, 64
 s_nop 0
 buffer_load_dwordx4 v138, s[60:63], s86 offen offset:2048 sc1 lds
 s_add_u32 m0, s101, 96
 s_nop 0
 buffer_load_dwordx4 v138, s[60:63], s86 offen offset:3072 sc1 lds
 s_add_u32 m0, s101, 4224
 s_nop 0
 buffer_load_dwordx4 v138, s[60:63], s87 offen offset:0 sc1 lds
 s_add_u32 m0, s101, 4256
 s_nop 0
 buffer_load_dwordx4 v138, s[60:63], s87 offen offset:1024 sc1 lds
 s_add_u32 m0, s101, 4288
 s_nop 0
 buffer_load_dwordx4 v138, s[60:63], s87 offen offset:2048 sc1 lds
 s_add_u32 m0, s101, 4320
 s_nop 0
 buffer_load_dwordx4 v138, s[60:63], s87 offen offset:3072 sc1 lds
 s_waitcnt vmcnt(0)
 v_add_u32 v71, s101, v139
 ds_read_b128 v[2:5], v71 offset:0
 ds_read_b128 v[6:9], v71 offset:1056
 ds_read_b128 v[10:13], v71 offset:2112
 ds_read_b128 v[14:17], v71 offset:3168
 ds_read_b128 v[18:21], v71 offset:4224
 ds_read_b128 v[22:25], v71 offset:5280
 ds_read_b128 v[26:29], v71 offset:6336
 ds_read_b128 v[30:33], v71 offset:7392
 s_waitcnt lgkmcnt(0)
 v_max_u32 v70, v2, v3
 v_max3_u32 v70, v70, v4, v5
 v_max3_u32 v70, v70, v6, v7
 v_max3_u32 v70, v70, v8, v9
 v_max3_u32 v70, v70, v10, v11
 v_max3_u32 v70, v70, v12, v13
 v_max3_u32 v70, v70, v14, v15
 v_max3_u32 v70, v70, v16, v17
 v_max3_u32 v70, v70, v18, v19
 v_max3_u32 v70, v70, v20, v21
 v_max3_u32 v70, v70, v22, v23
 v_max3_u32 v70, v70, v24, v25
 v_max3_u32 v70, v70, v26, v27
 v_max3_u32 v70, v70, v28, v29
 v_max3_u32 v70, v70, v30, v31
 v_max3_u32 v70, v70, v32, v33
 v_cmp_eq_u32 vcc, -1, v70
 s_mov_b32 m0, s83
 s_nop 2
 s_cbranch_vccz Lbk_13
 s_add_u32 s85, s85, 1
 s_cmp_lt_u32 s85, 262144
 s_cbranch_scc1 Llp_14
 s_branch Lbk_13
Lrt_16:
 s_nop 7
 s_nop 7
 s_mov_b32 s85, 0
 s_mov_b32 s83, m0
Llp_18:
 s_add_u32 s86, s77, 4096
 s_add_u32 s87, s78, 4096
 s_add_u32 m0, s101, 33792
 s_nop 0
 buffer_load_dwordx4 v138, s[60:63], s86 offen offset:0 sc1 lds
 s_add_u32 m0, s101, 33824
 s_nop 0
 buffer_load_dwordx4 v138, s[60:63], s86 offen offset:1024 sc1 lds
 s_add_u32 m0, s101, 33856
 s_nop 0
 buffer_load_dwordx4 v138, s[60:63], s86 offen offset:2048 sc1 lds
 s_add_u32 m0, s101, 33888
 s_nop 0
 buffer_load_dwordx4 v138, s[60:63], s86 offen offset:3072 sc1 lds
 s_add_u32 m0, s101, 38016
 s_nop 0
 buffer_load_dwordx4 v138, s[60:63], s87 offen offset:0 sc1 lds
 s_add_u32 m0, s101, 38048
 s_nop 0
 buffer_load_dwordx4 v138, s[60:63], s87 offen offset:1024 sc1 lds
 s_add_u32 m0, s101, 38080
 s_nop 0
 buffer_load_dwordx4 v138, s[60:63], s87 offen offset:2048 sc1 lds
 s_add_u32 m0, s101, 38112
 s_nop 0
 buffer_load_dwordx4 v138, s[60:63], s87 offen offset:3072 sc1 lds
 s_waitcnt vmcnt(0)
 v_add_u32 v75, s101, v139
 ds_read_b128 v[76:79], v75 offset:33792
 ds_read_b128 v[80:83], v75 offset:34848
 s_waitcnt lgkmcnt(0)
 v_max_u32_e64 v74, v76, v77
 v_max3_u32 v74, v74, v78, v79
 v_max3_u32 v74, v74, v80, v81
 v_max3_u32 v74, v74, v82, v83
 ds_read_b128 v[76:79], v75 offset:35904
 ds_read_b128 v[80:83], v75 offset:36960
 s_waitcnt lgkmcnt(0)
 v_max3_u32 v74, v74, v76, v77
 v_max3_u32 v74, v74, v78, v79
 v_max3_u32 v74, v74, v80, v81
 v_max3_u32 v74, v74, v82, v83
 ds_read_b128 v[76:79], v75 offset:38016
 ds_read_b128 v[80:83], v75 offset:39072
 s_waitcnt lgkmcnt(0)
 v_max3_u32 v74, v74, v76, v77
 v_max3_u32 v74, v74, v78, v79
 v_max3_u32 v74, v74, v80, v81
 v_max3_u32 v74, v74, v82, v83
 ds_read_b128 v[76:79], v75 offset:40128
 ds_read_b128 v[80:83], v75 offset:41184
 s_waitcnt lgkmcnt(0)
 v_max3_u32 v74, v74, v76, v77
 v_max3_u32 v74, v74, v78, v79
 v_max3_u32 v74, v74, v80, v81
 v_max3_u32 v74, v74, v82, v83
 v_cmp_eq_u32 vcc, -1, v74
 s_mov_b32 m0, s83
 s_nop 2
 s_cbranch_vccz Lbk_17
 s_add_u32 s85, s85, 1
 s_cmp_lt_u32 s85, 262144
 s_cbranch_scc1 Llp_18
 s_branch Lbk_17
Lrt_19:
 s_nop 7
 s_nop 7
 s_mov_b32 s85, 0
 s_mov_b32 s83, m0
Llp_21:
 buffer_load_dword v87, v142, s[60:63], s82 offen offset:0 sc1
 s_waitcnt vmcnt(0)
 v_cmp_ne_u32 vcc, s7, v87
 s_mov_b32 m0, s83
 s_nop 2
 s_cbranch_vccz Lbk_20
 s_add_u32 s85, s85, 1
 s_cmp_lt_u32 s85, 262144
 s_cbranch_scc1 Llp_21
 s_branch Lbk_20
Lrt_22:
 s_nop 7
 s_nop 7
 s_mov_b32 s85, 0
 s_mov_b32 s83, m0
Llp_24:
 buffer_load_dword v87, v142, s[60:63], s82 offen offset:512 sc1
 s_waitcnt vmcnt(0)
 v_cmp_ne_u32 vcc, s7, v87
 s_mov_b32 m0, s83
 s_nop 2
 s_cbranch_vccz Lbk_23
 s_add_u32 s85, s85, 1
 s_cmp_lt_u32 s85, 262144
 s_cbranch_scc1 Llp_24
 s_branch Lbk_23
Lrt_25:
 s_nop 7
 s_nop 7
 s_mov_b32 s85, 0
 s_mov_b32 s83, m0
Llp_27:
 s_add_u32 s86, s77, 0
 s_add_u32 s87, s78, 0
 s_add_u32 m0, s101, 0
 s_nop 0
 buffer_load_dwordx4 v138, s[60:63], s86 offen offset:0 sc1 lds
 s_add_u32 m0, s101, 32
 s_nop 0
 buffer_load_dwordx4 v138, s[60:63], s86 offen offset:1024 sc1 lds
 s_add_u32 m0, s101, 64
 s_nop 0
 buffer_load_dwordx4 v138, s[60:63], s86 offen offset:2048 sc1 lds
 s_add_u32 m0, s101, 96
 s_nop 0
 buffer_load_dwordx4 v138, s[60:63], s86 offen offset:3072 sc1 lds
 s_add_u32 m0, s101, 4224
 s_nop 0
 buffer_load_dwordx4 v138, s[60:63], s87 offen offset:0 sc1 lds
 s_add_u32 m0, s101, 4256
 s_nop 0
 buffer_load_dwordx4 v138, s[60:63], s87 offen offset:1024 sc1 lds
 s_add_u32 m0, s101, 4288
 s_nop 0
 buffer_load_dwordx4 v138, s[60:63], s87 offen offset:2048 sc1 lds
 s_add_u32 m0, s101, 4320
 s_nop 0
 buffer_load_dwordx4 v138, s[60:63], s87 offen offset:3072 sc1 lds
 s_waitcnt vmcnt(0)
 v_add_u32_e64 v37, s101, v139
 ds_read_b128 v[38:41], v37 offset:0
 ds_read_b128 v[42:45], v37 offset:1056
 ds_read_b128 v[46:49], v37 offset:2112
 ds_read_b128 v[50:53], v37 offset:3168
 ds_read_b128 v[54:57], v37 offset:4224
 ds_read_b128 v[58:61], v37 offset:5280
 ds_read_b128 v[62:65], v37 offset:6336
 ds_read_b128 v[66:69], v37 offset:7392
 s_waitcnt lgkmcnt(0)
 v_max_u32 v36, v38, v39
 v_max3_u32 v36, v36, v40, v41
 v_max3_u32 v36, v36, v42, v43
 v_max3_u32 v36, v36, v44, v45
 v_max3_u32 v36, v36, v46, v47
 v_max3_u32 v36, v36, v48, v49
 v_max3_u32 v36, v36, v50, v51
 v_max3_u32 v36, v36, v52, v53
 v_max3_u32 v36, v36, v54, v55
 v_max3_u32 v36, v36, v56, v57
 v_max3_u32 v36, v36, v58, v59
 v_max3_u32 v36, v36, v60, v61
 v_max3_u32 v36, v36, v62, v63
 v_max3_u32 v36, v36, v64, v65
 v_max3_u32 v36, v36, v66, v67
 v_max3_u32 v36, v36, v68, v69
 v_cmp_eq_u32 vcc, -1, v36
 s_mov_b32 m0, s83
 s_nop 2
 s_cbranch_vccz Lbk_26
 s_add_u32 s85, s85, 1
 s_cmp_lt_u32 s85, 262144
 s_cbranch_scc1 Llp_27
 s_branch Lbk_26
Lrt_28:
 s_nop 7
 s_nop 7
 s_mov_b32 s85, 0
 s_mov_b32 s83, m0
Llp_30:
 s_add_u32 s86, s77, 4096
 s_add_u32 s87, s78, 4096
 s_add_u32 m0, s101, 33792
 s_nop 0
 buffer_load_dwordx4 v138, s[60:63], s86 offen offset:0 sc1 lds
 s_add_u32 m0, s101, 33824
 s_nop 0
 buffer_load_dwordx4 v138, s[60:63], s86 offen offset:1024 sc1 lds
 s_add_u32 m0, s101, 33856
 s_nop 0
 buffer_load_dwordx4 v138, s[60:63], s86 offen offset:2048 sc1 lds
 s_add_u32 m0, s101, 33888
 s_nop 0
 buffer_load_dwordx4 v138, s[60:63], s86 offen offset:3072 sc1 lds
 s_add_u32 m0, s101, 38016
 s_nop 0
 buffer_load_dwordx4 v138, s[60:63], s87 offen offset:0 sc1 lds
 s_add_u32 m0, s101, 38048
 s_nop 0
 buffer_load_dwordx4 v138, s[60:63], s87 offen offset:1024 sc1 lds
 s_add_u32 m0, s101, 38080
 s_nop 0
 buffer_load_dwordx4 v138, s[60:63], s87 offen offset:2048 sc1 lds
 s_add_u32 m0, s101, 38112
 s_nop 0
 buffer_load_dwordx4 v138, s[60:63], s87 offen offset:3072 sc1 lds
 s_waitcnt vmcnt(0)
 v_add_u32_e64 v75, s101, v139
 ds_read_b128 v[76:79], v75 offset:33792
 ds_read_b128 v[80:83], v75 offset:34848
 s_waitcnt lgkmcnt(0)
 v_max_u32 v74, v76, v77
 v_max3_u32 v74, v74, v78, v79
 v_max3_u32 v74, v74, v80, v81
 v_max3_u32 v74, v74, v82, v83
 ds_read_b128 v[76:79], v75 offset:35904
 ds_read_b128 v[80:83], v75 offset:36960
 s_waitcnt lgkmcnt(0)
 v_max3_u32 v74, v74, v76, v77
 v_max3_u32 v74, v74, v78, v79
 v_max3_u32 v74, v74, v80, v81
 v_max3_u32 v74, v74, v82, v83
 ds_read_b128 v[76:79], v75 offset:38016
 ds_read_b128 v[80:83], v75 offset:39072
 s_waitcnt lgkmcnt(0)
 v_max3_u32 v74, v74, v76, v77
 v_max3_u32 v74, v74, v78, v79
 v_max3_u32 v74, v74, v80, v81
 v_max3_u32 v74, v74, v82, v83
 ds_read_b128 v[76:79], v75 offset:40128
 ds_read_b128 v[80:83], v75 offset:41184
 s_waitcnt lgkmcnt(0)
 v_max3_u32 v74, v74, v76, v77
 v_max3_u32 v74, v74, v78, v79
 v_max3_u32 v74, v74, v80, v81
 v_max3_u32 v74, v74, v82, v83
 v_cmp_eq_u32 vcc, -1, v74
 s_mov_b32 m0, s83
 s_nop 2
 s_cbranch_vccz Lbk_29
 s_add_u32 s85, s85, 1
 s_cmp_lt_u32 s85, 262144
 s_cbranch_scc1 Llp_30
 s_branch Lbk_29
Lrt_31:
 s_nop 7
 s_nop 7
 s_mov_b32 s85, 0
 s_mov_b32 s83, m0
Llp_33:
 buffer_load_dword v87, v142, s[60:63], s82 offen offset:0 sc1
 s_waitcnt vmcnt(0)
 v_cmp_ne_u32 vcc, s7, v87
 s_mov_b32 m0, s83
 s_nop 2
 s_cbranch_vccz Lbk_32
 s_add_u32 s85, s85, 1
 s_cmp_lt_u32 s85, 262144
 s_cbranch_scc1 Llp_33
 s_branch Lbk_32
Lrt_34:
 s_nop 7
 s_nop 7
 s_mov_b32 s85, 0
 s_mov_b32 s83, m0
Llp_36:
 buffer_load_dword v87, v142, s[60:63], s82 offen offset:512 sc1
 s_waitcnt vmcnt(0)
 v_cmp_ne_u32 vcc, s7, v87
 s_mov_b32 m0, s83
 s_nop 2
 s_cbranch_vccz Lbk_35
 s_add_u32 s85, s85, 1
 s_cmp_lt_u32 s85, 262144
 s_cbranch_scc1 Llp_36
 s_branch Lbk_35
Lslow:
 s_waitcnt vmcnt(0) lgkmcnt(0)
 s_barrier
 buffer_wbl2 sc0 sc1
 s_waitcnt vmcnt(0)
 s_mov_b32 s85, 0
Lsp_37:
 buffer_load_dwordx4 v[72:75], v139, s[60:63], s86 offen offset:0 sc0 sc1
 buffer_load_dwordx4 v[76:79], v139, s[60:63], s86 offen offset:1024 sc0 sc1
 buffer_load_dwordx4 v[80:83], v139, s[60:63], s86 offen offset:2048 sc0 sc1
 buffer_load_dwordx4 v[84:87], v139, s[60:63], s86 offen offset:3072 sc0 sc1
 s_waitcnt vmcnt(0)
 v_mov_b32 v2, 0
 v_xor_b32 v3, s7, v73
 v_xor_b32 v4, s7, v75
 v_or3_b32 v2, v2, v3, v4
 v_xor_b32 v3, s7, v77
 v_xor_b32 v4, s7, v79
 v_or3_b32 v2, v2, v3, v4
 v_xor_b32_e64 v3, s7, v81
 v_xor_b32_e64 v4, s7, v83
 v_or3_b32 v2, v2, v3, v4
 v_xor_b32 v3, s7, v85
 v_xor_b32_e64 v4, s7, v87
 v_or3_b32 v2, v2, v3, v4
 v_cmp_lt_u32 vcc, 7, v2
 s_nop 3
 s_cbranch_vccz Lsok_38
 s_add_u32 s85, s85, 1
 s_cmp_lt_u32 s85, 262144
 s_cbranch_scc1 Lsp_37
Lsok_38:
 v_mov_b32_e64 v73, v74
 ds_write_b64 v114, v[72:73] offset:0
 v_mov_b32_e64 v77, v78
 ds_write_b64 v114, v[76:77] offset:512
 v_mov_b32_e64 v81, v82
 ds_write_b64 v114, v[80:81] offset:1024
 v_mov_b32_e64 v85, v86
 ds_write_b64 v114, v[84:85] offset:1536
 s_waitcnt lgkmcnt(0)
 s_barrier
 ds_read_b128 a[0:3], v108 offset:0
 ds_read_b128 a[32:35], v109 offset:3584
 ds_read_b128 a[4:7], v108 offset:512
 ds_read_b128 a[36:39], v109 offset:3072
 ds_read_b128 a[8:11], v108 offset:1024
 ds_read_b128 a[40:43], v109 offset:2560
 ds_read_b128 a[12:15], v108 offset:1536
 ds_read_b128 a[44:47], v109 offset:2048
 ds_read_b128 a[16:19], v108 offset:2048
 ds_read_b128 a[48:51], v109 offset:1536
 ds_read_b128 a[20:23], v108 offset:2560
 ds_read_b128 a[52:55], v109 offset:1024
 ds_read_b128 a[24:27], v108 offset:3072
 ds_read_b128 a[56:59], v109 offset:512
 ds_read_b128 a[28:31], v108 offset:3584
 ds_read_b128 a[60:63], v109 offset:0
 s_waitcnt lgkmcnt(14)
 v_mfma_f32_16x16x32_bf16 v[2:5], a[0:3], a[32:35], 0
 s_lshl_b32 s14, s6, 14
 s_lshl_b32 s15, s3, 10
 s_waitcnt lgkmcnt(12)
 v_mfma_f32_16x16x32_bf16 v[6:9], a[0:3], a[36:39], 0
 s_add_u32 s76, s14, s15
 s_add_u32 s76, s76, 8388608
 v_mfma_f32_16x16x32_bf16 v[6:9], a[4:7], a[32:35], v[6:9]
 s_add_u32 m0, s0, 102400
 s_add_u32 s94, s31, 0
 v_mfma_f32_16x16x32_bf16 v[10:13], a[4:7], a[36:39], 0
 buffer_load_dwordx4 v88, s[64:67], s94 offen offset:0 lds
 v_mov_b32 v40, -1
 s_waitcnt lgkmcnt(10)
 v_mfma_f32_16x16x32_bf16 v[10:13], a[0:3], a[40:43], v[10:13]
 buffer_store_dwordx4 v[40:43], v139, s[60:63], s76 offen sc0 sc1
 s_nop 1
 v_mov_b32 v41, -1
 v_mfma_f32_16x16x32_bf16 v[10:13], a[8:11], a[32:35], v[10:13]
 v_mov_b32_e64 v42, -1
 v_mov_b32_e64 v43, -1
 v_mfma_f32_16x16x32_bf16 v[14:17], a[4:7], a[40:43], 0
 ds_read_b128 a[64:67], v108 offset:64
 ds_read_b128 a[96:99], v109 offset:3648
 v_mfma_f32_16x16x32_bf16 v[14:17], a[8:11], a[36:39], v[14:17]
 ds_read_b128 a[68:71], v108 offset:576
 ds_read_b128 a[100:103], v109 offset:3136
 v_mfma_f32_16x16x32_bf16 v[18:21], a[8:11], a[40:43], 0
 s_add_u32 s15, s76, 4096
 buffer_load_dwordx4 v89, s[64:67], s94 offen offset:1024 lds
 s_waitcnt lgkmcnt(12)
 v_mfma_f32_16x16x32_bf16 v[14:17], a[0:3], a[44:47], v[14:17]
 ds_read_b128 a[72:75], v108 offset:1088
 ds_read_b128 a[104:107], v109 offset:2624
 v_mfma_f32_16x16x32_bf16 v[14:17], a[12:15], a[32:35], v[14:17]
 ds_read_b128 a[76:79], v108 offset:1600
 ds_read_b128 a[108:111], v109 offset:2112
 v_mfma_f32_16x16x32_bf16 v[18:21], a[4:7], a[44:47], v[18:21]
 ds_read_b128 a[80:83], v108 offset:2112
 ds_read_b128 a[112:115], v109 offset:1600
 v_mfma_f32_16x16x32_bf16 v[18:21], a[12:15], a[36:39], v[18:21]
 ds_read_b128 a[84:87], v108 offset:2624
 ds_read_b128 a[116:119], v109 offset:1088
 v_mfma_f32_16x16x32_bf16 v[22:25], a[8:11], a[44:47], 0
 buffer_load_dwordx4 v90, s[64:67], s94 offen offset:2048 lds
 ds_read_b128 a[88:91], v108 offset:3136
 v_mfma_f32_16x16x32_bf16 v[22:25], a[12:15], a[40:43], v[22:25]
 s_add_u32 m0, s0, 114688
 s_add_u32 s94, s31, 88064
 v_mfma_f32_16x16x32_bf16 v[26:29], a[12:15], a[44:47], 0
 ds_read_b128 a[120:123], v109 offset:576
 ds_read_b128 a[92:95], v108 offset:3648
 s_waitcnt lgkmcnt(15)
 v_mfma_f32_16x16x32_bf16 v[18:21], a[0:3], a[48:51], v[18:21]
 buffer_store_dwordx4 v[40:43], v139, s[60:63], s15 offen sc0 sc1
 ds_read_b128 a[124:127], v109 offset:64
 v_mfma_f32_16x16x32_bf16 v[18:21], a[16:19], a[32:35], v[18:21]
 s_lshl_b32 s14, s6, 4
 s_lshl_b32 s12, s3, 2
 v_mfma_f32_16x16x32_bf16 v[22:25], a[4:7], a[48:51], v[22:25]
 s_add_u32 s14, s14, s12
 s_add_u32 s14, s14, 4096
 v_mfma_f32_16x16x32_bf16 v[22:25], a[16:19], a[36:39], v[22:25]
 buffer_load_dwordx4 v88, s[64:67], s94 offen offset:0 lds
 v_mfma_f32_16x16x32_bf16 v[26:29], a[8:11], a[48:51], v[26:29]
 buffer_store_dword v143, off, s[60:63], s14 sc0 sc1
 s_and_b32 s12, s10, 3
 v_mfma_f32_16x16x32_bf16 v[26:29], a[16:19], a[40:43], v[26:29]
 s_add_u32 s88, s12, s3
 s_mul_i32 s88, s88, 3
 v_mfma_f32_16x16x32_bf16 v[30:33], a[12:15], a[48:51], 0
 s_mul_i32 s14, s9, 352
 v_lshl_add_u32 v120, v145, 3, s14
 v_mfma_f32_16x16x32_bf16 v[30:33], a[16:19], a[44:47], v[30:33]
 s_add_u32 s14, s88, 0
 s_sub_u32 s12, s14, 11
 v_mfma_f32_16x16x32_bf16 v[22:25], a[0:3], a[52:55], v[22:25]
 buffer_load_dwordx4 v89, s[64:67], s94 offen offset:1024 lds
 s_min_u32 s14, s14, s12
 v_mfma_f32_16x16x32_bf16 v[22:25], a[20:23], a[32:35], v[22:25]
 s_lshl_b32 s86, s14, 5
 s_add_u32 s14, s88, 1
 v_mfma_f32_16x16x32_bf16 v[26:29], a[4:7], a[52:55], v[26:29]
 s_sub_u32 s12, s14, 11
 s_min_u32 s14, s14, s12
 v_mfma_f32_16x16x32_bf16 v[26:29], a[20:23], a[36:39], v[26:29]
 s_lshl_b32 s87, s14, 5
 s_add_u32 s14, s88, 2
 v_mfma_f32_16x16x32_bf16 v[30:33], a[8:11], a[52:55], v[30:33]
 s_sub_u32 s12, s14, 11
 s_min_u32 s14, s14, s12
 v_mfma_f32_16x16x32_bf16 v[30:33], a[20:23], a[40:43], v[30:33]
 buffer_load_dwordx4 v90, s[64:67], s94 offen offset:2048 lds
 s_lshl_b32 s88, s14, 5
 v_mfma_f32_16x16x32_bf16 v[26:29], a[0:3], a[56:59], v[26:29]
 s_add_u32 m0, s0, 126976
 s_add_u32 s94, s31, 176128
 v_mfma_f32_16x16x32_bf16 v[26:29], a[24:27], a[32:35], v[26:29]
 s_cmp_eq_u32 s3, 3
 s_cselect_b32 s88, 0x10000, s88
 v_mfma_f32_16x16x32_bf16 v[30:33], a[4:7], a[56:59], v[30:33]
 s_mov_b32 s52, s36
 s_mov_b32 s53, s37
 v_mfma_f32_16x16x32_bf16 v[30:33], a[24:27], a[36:39], v[30:33]
 s_mov_b32 s54, 0x400
 s_mov_b32 s55, 0x20000
 v_mfma_f32_16x16x32_bf16 v[30:33], a[0:3], a[60:63], v[30:33]
 s_mov_b32 s44, s32
 s_mov_b32 s45, s33
 v_mfma_f32_16x16x32_bf16 v[30:33], a[28:31], a[32:35], v[30:33]
 s_mov_b32 s46, 0xac0
 s_mov_b32 s47, 0x20000
 s_waitcnt lgkmcnt(0)
 v_mfma_f32_16x16x32_bf16 v[2:5], a[64:67], a[96:99], v[2:5]
 ds_read_b128 a[0:3], v108 offset:128
 ds_read_b128 a[32:35], v109 offset:3712
 v_mfma_f32_16x16x32_bf16 v[6:9], a[64:67], a[100:103], v[6:9]
 ds_read_b128 a[4:7], v108 offset:640
 ds_read_b128 a[36:39], v109 offset:3200
 v_mfma_f32_16x16x32_bf16 v[6:9], a[68:71], a[96:99], v[6:9]
 ds_read_b128 a[8:11], v108 offset:1152
 ds_read_b128 a[40:43], v109 offset:2688
 v_mfma_f32_16x16x32_bf16 v[10:13], a[68:71], a[100:103], v[10:13]
 ds_read_b128 a[12:15], v108 offset:1664
 ds_read_b128 a[44:47], v109 offset:2176
 v_mfma_f32_16x16x32_bf16 v[10:13], a[64:67], a[104:107], v[10:13]
 ds_read_b128 a[16:19], v108 offset:2176
 ds_read_b128 a[48:51], v109 offset:1664
 v_mfma_f32_16x16x32_bf16 v[10:13], a[72:75], a[96:99], v[10:13]
 ds_read_b128 a[20:23], v108 offset:2688
 ds_read_b128 a[52:55], v109 offset:1152
 v_mfma_f32_16x16x32_bf16 v[14:17], a[68:71], a[104:107], v[14:17]
 ds_read_b128 a[24:27], v108 offset:3200
 ds_read_b128 a[56:59], v109 offset:640
 v_mfma_f32_16x16x32_bf16 v[14:17], a[72:75], a[100:103], v[14:17]
 ds_read_b128 a[28:31], v108 offset:3712
 ds_read_b128 a[60:63], v109 offset:128
 v_mfma_f32_16x16x32_bf16 v[18:21], a[72:75], a[104:107], v[18:21]
 buffer_load_dwordx4 v88, s[64:67], s94 offen offset:0 lds
 buffer_load_dwordx4 v[116:119], v139, s[52:55], 0 offen
 v_mfma_f32_16x16x32_bf16 v[14:17], a[64:67], a[108:111], v[14:17]
 buffer_load_dwordx2 v[130:131], v120, s[44:47], s88 offen
 buffer_load_dwordx2 v[126:127], v120, s[44:47], s87 offen
 v_mfma_f32_16x16x32_bf16 v[14:17], a[76:79], a[96:99], v[14:17]
 buffer_load_dwordx2 v[122:123], v120, s[44:47], s86 offen
 v_bfe_u32 v149, v1, 2, 2
 v_mfma_f32_16x16x32_bf16 v[18:21], a[68:71], a[108:111], v[18:21]
 v_mul_u32_u24 v95, 3072, v145
 v_mul_u32_u24 v148, 384, v149
 v_mfma_f32_16x16x32_bf16 v[18:21], a[76:79], a[100:103], v[18:21]
 v_and_b32_e64 v150, 3, v1
 v_lshl_add_u32 v148, v150, 3, v148
 v_mfma_f32_16x16x32_bf16 v[22:25], a[72:75], a[108:111], v[22:25]
 s_mov_b32 s12, 102400
 v_add3_u32 v148, v95, v148, s12
 v_mfma_f32_16x16x32_bf16 v[22:25], a[76:79], a[104:107], v[22:25]
 v_bfe_u32 v150, v1, 3, 2
 s_mul_i32 s12, s3, 3
 v_mfma_f32_16x16x32_bf16 v[26:29], a[76:79], a[108:111], v[26:29]
 v_xor_b32 v95, s12, v150
 v_lshl_add_u32 v95, v95, 5, v148
 v_mfma_f32_16x16x32_bf16 v[18:21], a[64:67], a[112:115], v[18:21]
 s_add_u32 s12, s12, 1
 v_xor_b32_e64 v87, s12, v150
 v_mfma_f32_16x16x32_bf16 v[18:21], a[80:83], a[96:99], v[18:21]
 v_lshl_add_u32 v87, v87, 5, v148
 s_add_u32 s12, s12, 1
 v_mfma_f32_16x16x32_bf16 v[22:25], a[68:71], a[112:115], v[22:25]
 v_xor_b32_e64 v69, s12, v150
 v_lshl_add_u32 v69, v69, 5, v148
 v_mfma_f32_16x16x32_bf16 v[22:25], a[80:83], a[100:103], v[22:25]
 v_bfe_u32 v148, v1, 4, 1
 v_bfe_u32 v150, v1, 1, 1
 v_mfma_f32_16x16x32_bf16 v[26:29], a[72:75], a[112:115], v[26:29]
 v_lshl_add_u32 v148, v148, 1, v150
 v_lshl_add_u32 v148, v149, 2, v148
 v_mfma_f32_16x16x32_bf16 v[26:29], a[80:83], a[104:107], v[26:29]
 v_lshlrev_b32 v148, 4, v148
 v_and_b32 v150, 1, v1
 v_mfma_f32_16x16x32_bf16 v[30:33], a[76:79], a[112:115], v[30:33]
 v_lshl_add_u32 v148, v150, 3, v148
 v_lshl_add_u32 v150, v147, 3, v149
 v_mfma_f32_16x16x32_bf16 v[30:33], a[80:83], a[108:111], v[30:33]
 buffer_load_dwordx4 v89, s[64:67], s94 offen offset:1024 lds
 v_lshl_add_u32 v148, v150, 8, v148
 v_mfma_f32_16x16x32_bf16 v[22:25], a[64:67], a[116:119], v[22:25]
 v_add_u32 v96, s84, v148
 v_xor_b32 v97, 64, v96
 v_mfma_f32_16x16x32_bf16 v[22:25], a[84:87], a[96:99], v[22:25]
 v_xor_b32 v98, 0x80, v96
 v_xor_b32 v99, 0xc0, v96
 v_mfma_f32_16x16x32_bf16 v[26:29], a[68:71], a[116:119], v[26:29]
 v_lshlrev_b32 v110, 2, v145
 v_xor_b32 v110, v110, v1
 v_mfma_f32_16x16x32_bf16 v[26:29], a[84:87], a[100:103], v[26:29]
 s_lshl_b32 s12, s3, 13
 v_lshl_add_u32 v110, v110, 4, s12
 v_mfma_f32_16x16x32_bf16 v[30:33], a[72:75], a[116:119], v[30:33]
 v_and_b32 v148, 3, v1
 v_lshlrev_b32 v115, 2, v148
 v_mfma_f32_16x16x32_bf16 v[30:33], a[84:87], a[104:107], v[30:33]
 v_lshrrev_b32 v149, 2, v1
 v_xor_b32_e64 v115, v115, v149
 v_mfma_f32_16x16x32_bf16 v[26:29], a[64:67], a[120:123], v[26:29]
 v_lshl_add_u32 v115, v148, 4, v115
 s_lshl_b32 s12, s3, 10
 v_mfma_f32_16x16x32_bf16 v[26:29], a[88:91], a[96:99], v[26:29]
 v_lshl_add_u32 v115, v115, 4, s12
 v_lshlrev_b32 v112, 3, v0
 v_mfma_f32_16x16x32_bf16 v[30:33], a[68:71], a[120:123], v[30:33]
 v_sub_u32 v112, 69624, v112
 s_mul_i32 s101, s3, 8448
 v_mfma_f32_16x16x32_bf16 v[30:33], a[88:91], a[100:103], v[30:33]
 s_add_u32 s95, s101, 33792
 s_and_b32 s12, s3, 1
 v_mfma_f32_16x16x32_bf16 v[30:33], a[64:67], a[124:127], v[30:33]
 s_lshl_b32 s27, s12, 12
 s_lshr_b32 s12, s3, 1
 v_mfma_f32_16x16x32_bf16 v[30:33], a[92:95], a[96:99], v[30:33]
 s_mul_i32 s12, s12, 33792
 s_add_u32 s27, s27, s12
 s_waitcnt lgkmcnt(0)
 v_mfma_f32_16x16x32_bf16 v[2:5], a[0:3], a[32:35], v[2:5]
 s_add_u32 s27, s27, 24576
 s_mul_i32 s1, s3, 16896
 v_mfma_f32_16x16x32_bf16 v[6:9], a[0:3], a[36:39], v[6:9]
 s_mul_i32 s11, s3, 6400
 s_add_u32 s11, s11, 76800
 v_mfma_f32_16x16x32_bf16 v[6:9], a[4:7], a[32:35], v[6:9]
 buffer_load_dwordx4 v90, s[64:67], s94 offen offset:2048 lds
 s_lshl_b32 s12, s10, 17
 v_mfma_f32_16x16x32_bf16 v[10:13], a[4:7], a[36:39], v[10:13]
 s_add_u32 m0, s0, 139264
 s_add_u32 s94, s31, 264192
 v_mfma_f32_16x16x32_bf16 v[10:13], a[0:3], a[40:43], v[10:13]
 s_lshl_b32 s77, s3, 15
 s_add_u32 s77, s77, s12
 v_mfma_f32_16x16x32_bf16 v[10:13], a[8:11], a[32:35], v[10:13]
 s_add_u32 s77, s77, 8388608
 s_add_u32 s78, s77, 0x4000
 v_mfma_f32_16x16x32_bf16 v[14:17], a[4:7], a[40:43], v[14:17]
 ds_read_b128 a[64:67], v108 offset:192
 ds_read_b128 a[96:99], v109 offset:3776
 v_mfma_f32_16x16x32_bf16 v[14:17], a[8:11], a[36:39], v[14:17]
 ds_read_b128 a[68:71], v108 offset:704
 ds_read_b128 a[100:103], v109 offset:3264
 v_mfma_f32_16x16x32_bf16 v[18:21], a[8:11], a[40:43], v[18:21]
 ds_read_b128 a[72:75], v108 offset:1216
 ds_read_b128 a[104:107], v109 offset:2752
 v_mfma_f32_16x16x32_bf16 v[14:17], a[0:3], a[44:47], v[14:17]
 ds_read_b128 a[76:79], v108 offset:1728
 ds_read_b128 a[108:111], v109 offset:2240
 v_mfma_f32_16x16x32_bf16 v[14:17], a[12:15], a[32:35], v[14:17]
 ds_read_b128 a[80:83], v108 offset:2240
 ds_read_b128 a[112:115], v109 offset:1728
 v_mfma_f32_16x16x32_bf16 v[18:21], a[4:7], a[44:47], v[18:21]
 ds_read_b128 a[84:87], v108 offset:2752
 ds_read_b128 a[116:119], v109 offset:1216
 v_mfma_f32_16x16x32_bf16 v[18:21], a[12:15], a[36:39], v[18:21]
 ds_read_b128 a[88:91], v108 offset:3264
 ds_read_b128 a[120:123], v109 offset:704
 v_mfma_f32_16x16x32_bf16 v[22:25], a[8:11], a[44:47], v[22:25]
 ds_read_b128 a[92:95], v108 offset:3776
 ds_read_b128 a[124:127], v109 offset:192
 v_mfma_f32_16x16x32_bf16 v[22:25], a[12:15], a[40:43], v[22:25]
 s_and_b32 s12, s10, 3
 s_mul_i32 s15, s3, 22016
 v_mfma_f32_16x16x32_bf16 v[26:29], a[12:15], a[44:47], v[26:29]
 s_add_u32 s14, s12, 1
 s_and_b32 s14, s14, 3
 v_mfma_f32_16x16x32_bf16 v[18:21], a[0:3], a[48:51], v[18:21]
 s_mul_i32 s14, s14, 352256
 s_add_u32 s34, s14, s15
 v_mfma_f32_16x16x32_bf16 v[18:21], a[16:19], a[32:35], v[18:21]
 buffer_load_dwordx4 v88, s[64:67], s94 offen offset:0 lds
 s_add_u32 s14, s12, 2
 v_mfma_f32_16x16x32_bf16 v[22:25], a[4:7], a[48:51], v[22:25]
 s_and_b32 s14, s14, 3
 s_mul_i32 s14, s14, 352256
 v_mfma_f32_16x16x32_bf16 v[22:25], a[16:19], a[36:39], v[22:25]
 s_add_u32 s35, s14, s15
 s_add_u32 s14, s12, 3
 v_mfma_f32_16x16x32_bf16 v[26:29], a[8:11], a[48:51], v[26:29]
 s_and_b32 s14, s14, 3
 s_mul_i32 s14, s14, 352256
 v_mfma_f32_16x16x32_bf16 v[26:29], a[16:19], a[40:43], v[26:29]
 s_add_u32 s13, s14, s15
 s_and_b32 s12, s10, 3
 v_mfma_f32_16x16x32_bf16 v[30:33], a[12:15], a[48:51], v[30:33]
 s_mul_i32 s15, s12, 49152
 s_add_u32 s14, s15, 0
 v_mfma_f32_16x16x32_bf16 v[30:33], a[16:19], a[44:47], v[30:33]
 s_sub_u32 s18, s14, 180224
 s_min_u32 s18, s18, s14
 v_mfma_f32_16x16x32_bf16 v[22:25], a[0:3], a[52:55], v[22:25]
 s_add_u32 s14, s15, 16384
 s_sub_u32 s19, s14, 180224
 v_mfma_f32_16x16x32_bf16 v[22:25], a[20:23], a[32:35], v[22:25]
 s_min_u32 s19, s19, s14
 s_add_u32 s14, s15, 32768
 v_mfma_f32_16x16x32_bf16 v[26:29], a[4:7], a[52:55], v[26:29]
 s_sub_u32 s20, s14, 180224
 s_min_u32 s20, s20, s14
 v_mfma_f32_16x16x32_bf16 v[26:29], a[20:23], a[36:39], v[26:29]
 s_add_u32 s14, s15, 49152
 s_sub_u32 s21, s14, 180224
 v_mfma_f32_16x16x32_bf16 v[30:33], a[8:11], a[52:55], v[30:33]
 s_min_u32 s21, s21, s14
 s_add_u32 s14, s15, 65536
 v_mfma_f32_16x16x32_bf16 v[30:33], a[20:23], a[40:43], v[30:33]
 s_sub_u32 s22, s14, 180224
 s_min_u32 s22, s22, s14
 v_mfma_f32_16x16x32_bf16 v[26:29], a[0:3], a[56:59], v[26:29]
 s_add_u32 s14, s15, 81920
 s_sub_u32 s23, s14, 180224
 v_mfma_f32_16x16x32_bf16 v[26:29], a[24:27], a[32:35], v[26:29]
 s_min_u32 s23, s23, s14
 s_add_u32 s14, s15, 98304
 v_mfma_f32_16x16x32_bf16 v[30:33], a[4:7], a[56:59], v[30:33]
 buffer_load_dwordx4 v89, s[64:67], s94 offen offset:1024 lds
 s_sub_u32 s24, s14, 180224
 v_mfma_f32_16x16x32_bf16 v[30:33], a[24:27], a[36:39], v[30:33]
 s_min_u32 s24, s24, s14
 s_add_u32 s14, s15, 114688
 v_mfma_f32_16x16x32_bf16 v[30:33], a[0:3], a[60:63], v[30:33]
 s_sub_u32 s25, s14, 180224
 s_min_u32 s25, s25, s14
 v_mfma_f32_16x16x32_bf16 v[30:33], a[28:31], a[32:35], v[30:33]
 s_add_u32 s14, s15, 131072
 s_sub_u32 s16, s14, 180224
 s_waitcnt lgkmcnt(0)
 v_mfma_f32_16x16x32_bf16 v[2:5], a[64:67], a[96:99], v[2:5]
 s_min_u32 s16, s16, s14
 s_add_u32 s14, s15, 147456
 v_mfma_f32_16x16x32_bf16 v[6:9], a[64:67], a[100:103], v[6:9]
 s_sub_u32 s17, s14, 180224
 s_min_u32 s17, s17, s14
 v_mfma_f32_16x16x32_bf16 v[6:9], a[68:71], a[96:99], v[6:9]
 s_add_u32 s14, s15, 163840
 s_sub_u32 s30, s14, 180224
 v_mfma_f32_16x16x32_bf16 v[10:13], a[68:71], a[100:103], v[10:13]
 s_min_u32 s30, s30, s14
 v_lshlrev_b32_e64 v149, 2, v145
 v_mfma_f32_16x16x32_bf16 v[10:13], a[64:67], a[104:107], v[10:13]
 v_xor_b32_e64 v149, v144, v149
 v_lshlrev_b32_e64 v91, 10, v145
 v_mfma_f32_16x16x32_bf16 v[10:13], a[72:75], a[96:99], v[10:13]
 v_lshl_add_u32 v91, v149, 4, v91
 s_mul_i32 s14, s9, 180224
 v_mfma_f32_16x16x32_bf16 v[14:17], a[68:71], a[104:107], v[14:17]
 s_lshl_b32 s15, s3, 8
 s_add_u32 s14, s14, s15
 v_mfma_f32_16x16x32_bf16 v[14:17], a[72:75], a[100:103], v[14:17]
 v_add_u32_e64 v91, s14, v91
 v_add_u32 v92, 3072, v91
 v_mfma_f32_16x16x32_bf16 v[18:21], a[72:75], a[104:107], v[18:21]
 v_add_u32 v93, 6144, v91
 v_add_u32 v94, 9216, v91
 v_mfma_f32_16x16x32_bf16 v[14:17], a[64:67], a[108:111], v[14:17]
 v_lshrrev_b32_e64 v84, 1, v0
 v_lshlrev_b32_e64 v84, 4, v84
 v_mfma_f32_16x16x32_bf16 v[14:17], a[76:79], a[96:99], v[14:17]
 s_and_b32 s12, s10, 12
 s_add_u32 s89, s12, 4096
 v_mfma_f32_16x16x32_bf16 v[18:21], a[68:71], a[108:111], v[18:21]
 buffer_load_dwordx4 v90, s[64:67], s94 offen offset:2048 lds
 s_lshl_b32 s12, s5, 2
 v_mfma_f32_16x16x32_bf16 v[18:21], a[76:79], a[100:103], v[18:21]
 s_add_u32 s12, s12, s3
 s_lshl_b32 s12, s12, 9
 v_mfma_f32_16x16x32_bf16 v[22:25], a[72:75], a[108:111], v[22:25]
 v_lshrrev_b32_e64 v85, 4, v1
 v_lshl_add_u32 v85, v85, 7, s12
 v_mfma_f32_16x16x32_bf16 v[22:25], a[76:79], a[104:107], v[22:25]
 v_min_u32 v85, Lslow-Lpc, v85
 global_load_dword a172, v85, s[28:29]
 v_mfma_f32_16x16x32_bf16 v[26:29], a[76:79], a[108:111], v[26:29]
 ds_read_b64 v[38:39], v112 offset:2048
 ds_read_b64 v[40:41], v112 offset:6656
 v_mfma_f32_16x16x32_bf16 v[18:21], a[64:67], a[112:115], v[18:21]
 ds_read_b64 v[42:43], v112 offset:0
 ds_read_b64 v[44:45], v112 offset:4608
 v_mfma_f32_16x16x32_bf16 v[18:21], a[80:83], a[96:99], v[18:21]
 v_readfirstlane_b32 s99, v36
 s_lshl_b32 s14, s6, 8
 v_mfma_f32_16x16x32_bf16 v[22:25], a[68:71], a[112:115], v[22:25]
 s_add_u32 s14, s14, 6291456
 s_add_u32 s15, s14, 0x100000
 v_mfma_f32_16x16x32_bf16 v[22:25], a[80:83], a[100:103], v[22:25]
 s_lshl_b32 s100, s99, 16
 s_and_b32 s99, s99, 0xffff0000
 v_mfma_f32_16x16x32_bf16 v[26:29], a[72:75], a[112:115], v[26:29]
 s_waitcnt lgkmcnt(0)
 v_and_b32_e64 v46, s98, v39
 v_mfma_f32_16x16x32_bf16 v[26:29], a[80:83], a[104:107], v[26:29]
 v_lshlrev_b32 v47, 16, v39
 v_and_b32 v48, s98, v38
 v_mfma_f32_16x16x32_bf16 v[30:33], a[76:79], a[112:115], v[30:33]
 v_lshlrev_b32 v49, 16, v38
 v_mul_f32 v46, s100, v46
 v_mfma_f32_16x16x32_bf16 v[30:33], a[80:83], a[108:111], v[30:33]
 v_mul_f32 v47, s100, v47
 v_mul_f32 v48, s100, v48
 v_mfma_f32_16x16x32_bf16 v[22:25], a[64:67], a[116:119], v[22:25]
 v_mul_f32 v49, s100, v49
 v_and_b32 v50, s98, v41
 v_mfma_f32_16x16x32_bf16 v[22:25], a[84:87], a[96:99], v[22:25]
 v_lshlrev_b32 v51, 16, v41
 v_and_b32 v52, s98, v40
 v_mfma_f32_16x16x32_bf16 v[26:29], a[68:71], a[116:119], v[26:29]
 v_lshlrev_b32 v53, 16, v40
 v_mul_f32 v50, s99, v50
 v_mfma_f32_16x16x32_bf16 v[26:29], a[84:87], a[100:103], v[26:29]
 v_mul_f32 v51, s99, v51
 v_mul_f32 v52, s99, v52
 v_mfma_f32_16x16x32_bf16 v[30:33], a[72:75], a[116:119], v[30:33]
 v_mul_f32 v53, s99, v53
 v_and_b32 v54, s98, v43
 v_mfma_f32_16x16x32_bf16 v[30:33], a[84:87], a[104:107], v[30:33]
 v_lshlrev_b32 v55, 16, v43
 v_and_b32 v56, s98, v42
 v_mfma_f32_16x16x32_bf16 v[26:29], a[64:67], a[120:123], v[26:29]
 v_lshlrev_b32 v57, 16, v42
 v_mul_f32 v54, s100, v54
 v_mfma_f32_16x16x32_bf16 v[26:29], a[88:91], a[96:99], v[26:29]
 v_mul_f32 v55, s100, v55
 v_mul_f32 v56, s100, v56
 v_mfma_f32_16x16x32_bf16 v[30:33], a[68:71], a[120:123], v[30:33]
 v_mul_f32 v57, s100, v57
 v_and_b32 v58, s98, v45
 v_mfma_f32_16x16x32_bf16 v[30:33], a[88:91], a[100:103], v[30:33]
 v_lshlrev_b32 v59, 16, v45
 v_and_b32 v60, s98, v44
 v_mfma_f32_16x16x32_bf16 v[30:33], a[64:67], a[124:127], v[30:33]
 v_lshlrev_b32 v61, 16, v44
 v_mul_f32 v58, s99, v58
 v_mfma_f32_16x16x32_bf16 v[30:33], a[92:95], a[96:99], v[30:33]
 v_mul_f32 v59, s99, v59
 v_mul_f32 v60, s99, v60
 v_mul_f32_e64 v61, s99, v61
 s_waitcnt lgkmcnt(0)
 s_barrier
 ds_write_b128 v110, v[2:5] offset:0
 ds_write_b128 v110, v[6:9] offset:1024
 ds_write_b128 v110, v[10:13] offset:2048
 ds_write_b128 v110, v[14:17] offset:3072
 ds_write_b128 v110, v[18:21] offset:4096
 ds_write_b128 v110, v[22:25] offset:5120
 ds_write_b128 v110, v[26:29] offset:6144
 ds_write_b128 v110, v[30:33] offset:7168
 s_waitcnt lgkmcnt(0)
 s_barrier
 ds_read_b128 v[2:5], v115 offset:0
 ds_read_b128 v[6:9], v115 offset:8192
 ds_read_b128 v[10:13], v115 offset:16384
 ds_read_b128 v[14:17], v115 offset:24576
 ds_read_b128 v[18:21], v115 offset:4096
 ds_read_b128 v[22:25], v115 offset:12288
 ds_read_b128 v[26:29], v115 offset:20480
 ds_read_b128 v[30:33], v115 offset:28672
 s_waitcnt vmcnt(15)
 s_waitcnt lgkmcnt(6)
 v_pk_add_f32 v[46:47], v[46:47], v[2:3]
 v_pk_add_f32 v[48:49], v[48:49], v[4:5]
 v_pk_add_f32 v[46:47], v[46:47], v[6:7]
 v_pk_add_f32 v[48:49], v[48:49], v[8:9]
 s_waitcnt lgkmcnt(4)
 v_pk_add_f32 v[50:51], v[50:51], v[10:11]
 v_pk_add_f32 v[52:53], v[52:53], v[12:13]
 v_pk_add_f32 v[50:51], v[50:51], v[14:15]
 v_pk_add_f32 v[52:53], v[52:53], v[16:17]
 v_cvt_pk_bf16_f32 v72, v46, v50
 v_cvt_pk_bf16_f32 v73, v47, v51
 v_cvt_pk_bf16_f32 v74, v48, v52
 v_cvt_pk_bf16_f32 v75, v49, v53
 v_min_u32 v72, -2, v72
 v_min_u32_e64 v73, -2, v73
 v_min_u32_e64 v74, -2, v74
 v_min_u32_e64 v75, -2, v75
 buffer_store_dwordx4 v[72:75], v111, s[60:63], s14 offen sc0 sc1
 s_waitcnt lgkmcnt(2)
 v_pk_add_f32 v[54:55], v[54:55], v[18:19]
 v_pk_add_f32 v[56:57], v[56:57], v[20:21]
 v_pk_add_f32 v[54:55], v[54:55], v[22:23]
 v_pk_add_f32 v[56:57], v[56:57], v[24:25]
 s_waitcnt lgkmcnt(0)
 v_pk_add_f32 v[58:59], v[58:59], v[26:27]
 v_pk_add_f32 v[60:61], v[60:61], v[28:29]
 v_pk_add_f32 v[58:59], v[58:59], v[30:31]
 v_pk_add_f32 v[60:61], v[60:61], v[32:33]
 v_cvt_pk_bf16_f32 v76, v54, v58
 v_cvt_pk_bf16_f32 v77, v55, v59
 v_cvt_pk_bf16_f32 v78, v56, v60
 v_cvt_pk_bf16_f32 v79, v57, v61
 v_min_u32_e64 v76, -2, v76
 v_min_u32_e64 v77, -2, v77
 v_min_u32_e64 v78, -2, v78
 v_min_u32_e64 v79, -2, v79
 buffer_store_dwordx4 v[76:79], v111, s[60:63], s15 offen sc0 sc1
 buffer_load_dword v82, v84, s[60:63], s89 offen sc1
 buffer_load_dword v83, v84, s[60:63], s89 offen offset:2048 sc1
 s_add_u32 m0, s0, 33792
 s_add_u32 s94, s34, 0
 buffer_load_dwordx4 v88, s[64:67], s94 offen offset:0 lds
 buffer_load_dwordx4 v89, s[64:67], s94 offen offset:1024 lds
 buffer_load_dwordx4 v90, s[64:67], s94 offen offset:2048 lds
 v_lshrrev_b32 v75, 1, v0
 v_lshlrev_b32 v74, 8, v75
 v_and_b32_e64 v72, 1, v0
 v_lshl_add_u32 v74, v72, 4, v74
 s_lshl_b32 s88, s10, 16
 s_lshl_b32 s87, s9, 5
 s_add_u32 s88, s88, s87
 s_add_u32 s88, s88, 6291456
 s_add_u32 s87, s88, 0x8000
 s_mov_b32 s96, 0x3b000000
 s_waitcnt vmcnt(8)
 s_barrier
 s_add_u32 m0, s0, 46080
 s_add_u32 s94, s34, 88064
 buffer_load_dwordx4 v88, s[64:67], s94 offen offset:0 lds
 ds_read_b64_tr_b16 a[176:177], v95 offset:0
 ds_read_b64_tr_b16 a[178:179], v95 offset:1536
 ds_read_b64_tr_b16 a[180:181], v87 offset:0
 ds_read_b64_tr_b16 a[182:183], v87 offset:1536
 ds_read_b64_tr_b16 a[184:185], v69 offset:0
 ds_read_b64_tr_b16 a[186:187], v69 offset:1536
 ds_read_b64_tr_b16 a[188:189], v95 offset:12288
 ds_read_b64_tr_b16 a[190:191], v95 offset:13824
 ds_read_b64_tr_b16 a[192:193], v87 offset:12288
 ds_read_b64_tr_b16 a[194:195], v87 offset:13824
 ds_read_b64_tr_b16 a[196:197], v69 offset:12288
 buffer_load_dwordx4 v89, s[64:67], s94 offen offset:1024 lds
 ds_read_b64_tr_b16 a[198:199], v69 offset:13824
 ds_read_b64_tr_b16 a[200:201], v95 offset:24576
 ds_read_b64_tr_b16 a[202:203], v95 offset:26112
 ds_read_b64_tr_b16 a[204:205], v87 offset:24576
 ds_read_b64_tr_b16 a[206:207], v87 offset:26112
 ds_read_b64_tr_b16 a[208:209], v69 offset:24576
 ds_read_b64_tr_b16 a[210:211], v69 offset:26112
 ds_read_b64_tr_b16 a[212:213], v95 offset:36864
 ds_read_b64_tr_b16 a[214:215], v95 offset:38400
 ds_read_b64_tr_b16 a[216:217], v87 offset:36864
 ds_read_b64_tr_b16 a[218:219], v87 offset:38400
 ds_read_b64_tr_b16 a[220:221], v69 offset:36864
 buffer_load_dwordx4 v90, s[64:67], s94 offen offset:2048 lds
 s_add_u32 m0, s0, 76800
 s_add_u32 s94, s34, 176128
 ds_read_b64_tr_b16 a[222:223], v69 offset:38400
 v_lshlrev_b32 v2, 16, v100
 v_lshlrev_b32 v34, 16, v104
 v_and_b32 v3, s98, v100
 v_and_b32 v35, s98, v104
 v_lshlrev_b32 v4, 16, v101
 v_lshlrev_b32 v36, 16, v105
 v_and_b32 v5, s98, v101
 v_and_b32 v37, s98, v105
 v_lshlrev_b32 v6, 16, v102
 v_lshlrev_b32 v38, 16, v106
 v_and_b32 v7, s98, v102
 buffer_load_dwordx4 v88, s[64:67], s94 offen offset:0 lds
 v_and_b32 v39, s98, v106
 v_lshlrev_b32 v8, 16, v103
 v_lshlrev_b32 v40, 16, v107
 v_and_b32 v9, s98, v103
 v_and_b32 v41, s98, v107
 v_pk_add_f32 v[10:11], v[2:3], v[4:5]
 v_pk_add_f32 v[42:43], v[34:35], v[36:37]
 v_pk_mul_f32 v[12:13], v[2:3], v[2:3]
 v_pk_mul_f32 v[44:45], v[34:35], v[34:35]
 v_pk_add_f32 v[14:15], v[6:7], v[8:9]
 v_pk_add_f32 v[46:47], v[38:39], v[40:41]
 v_pk_fma_f32 v[12:13], v[4:5], v[4:5], v[12:13]
 buffer_load_dwordx4 v89, s[64:67], s94 offen offset:1024 lds
 v_pk_fma_f32 v[44:45], v[36:37], v[36:37], v[44:45]
 v_pk_add_f32 v[10:11], v[10:11], v[14:15]
 v_pk_add_f32 v[42:43], v[42:43], v[46:47]
 v_pk_fma_f32 v[12:13], v[6:7], v[6:7], v[12:13]
 v_pk_fma_f32 v[44:45], v[38:39], v[38:39], v[44:45]
 v_add_f32 v10, v10, v11
 v_add_f32 v42, v42, v43
 v_pk_fma_f32 v[12:13], v[8:9], v[8:9], v[12:13]
 v_pk_fma_f32 v[44:45], v[40:41], v[40:41], v[44:45]
 v_add_f32 v11, v12, v13
 v_add_f32 v43, v44, v45
 v_add_f32_dpp v10, v10, v10 quad_perm:[1,0,3,2] row_mask:0xf bank_mask:0xf
 buffer_load_dwordx4 v90, s[64:67], s94 offen offset:2048 lds
 s_add_u32 m0, s0, 89088
 s_add_u32 s94, s34, 264192
 v_add_f32_dpp v42, v42, v42 quad_perm:[1,0,3,2] row_mask:0xf bank_mask:0xf
 v_add_f32_dpp v11, v11, v11 quad_perm:[1,0,3,2] row_mask:0xf bank_mask:0xf
 v_add_f32_dpp v43, v43, v43 quad_perm:[1,0,3,2] row_mask:0xf bank_mask:0xf
 v_add_f32_dpp v10, v10, v10 quad_perm:[2,3,0,1] row_mask:0xf bank_mask:0xf
 v_add_f32_dpp v42, v42, v42 quad_perm:[2,3,0,1] row_mask:0xf bank_mask:0xf
 v_add_f32_dpp v11, v11, v11 quad_perm:[2,3,0,1] row_mask:0xf bank_mask:0xf
 v_add_f32_dpp v43, v43, v43 quad_perm:[2,3,0,1] row_mask:0xf bank_mask:0xf
 v_add_f32_dpp v10, v10, v10 row_half_mirror row_mask:0xf bank_mask:0xf
 v_add_f32_dpp v42, v42, v42 row_half_mirror row_mask:0xf bank_mask:0xf
 v_add_f32_dpp v11, v11, v11 row_half_mirror row_mask:0xf bank_mask:0xf
 v_add_f32_dpp v43, v43, v43 row_half_mirror row_mask:0xf bank_mask:0xf
 v_add_f32_dpp v10, v10, v10 row_mirror row_mask:0xf bank_mask:0xf
 buffer_load_dwordx4 v88, s[64:67], s94 offen offset:0 lds
 v_add_f32_dpp v42, v42, v42 row_mirror row_mask:0xf bank_mask:0xf
 v_add_f32_dpp v11, v11, v11 row_mirror row_mask:0xf bank_mask:0xf
 v_add_f32_dpp v43, v43, v43 row_mirror row_mask:0xf bank_mask:0xf
 v_add_f32_dpp v10, v10, v10 row_bcast:15 row_mask:0xa bank_mask:0xf
 v_add_f32_dpp v42, v42, v42 row_bcast:15 row_mask:0xa bank_mask:0xf
 v_add_f32_dpp v11, v11, v11 row_bcast:15 row_mask:0xa bank_mask:0xf
 v_add_f32_dpp v43, v43, v43 row_bcast:15 row_mask:0xa bank_mask:0xf
 v_add_f32_dpp v10, v10, v10 row_bcast:31 row_mask:0xc bank_mask:0xf
 v_add_f32_dpp v42, v42, v42 row_bcast:31 row_mask:0xc bank_mask:0xf
 v_add_f32_dpp v11, v11, v11 row_bcast:31 row_mask:0xc bank_mask:0xf
 v_add_f32_dpp v43, v43, v43 row_bcast:31 row_mask:0xc bank_mask:0xf
 v_readlane_b32 s92, v10, 63
 buffer_load_dwordx4 v89, s[64:67], s94 offen offset:1024 lds
 v_readlane_b32 s90, v42, 63
 v_readlane_b32 s93, v11, 63
 v_readlane_b32 s91, v43, 63
 v_mov_b32 v13, s96
 v_mov_b32 v45, s96
 v_mul_f32 v10, s92, v13
 v_mul_f32 v42, s90, v45
 v_mul_f32 v11, s93, v13
 v_mul_f32 v43, s91, v45
 v_fma_f32 v11, -v10, v10, v11
 v_fma_f32 v43, -v42, v42, v43
 v_max_f32_e64 v11, 0, v11
 buffer_load_dwordx4 v90, s[64:67], s94 offen offset:2048 lds
 s_add_u32 m0, s0, 0
 s_add_u32 s94, s35, 0
 v_max_f32_e64 v43, 0, v43
 v_add_f32 v11, 0x3727c5ac, v11
 v_add_f32 v43, 0x3727c5ac, v43
 v_rsq_f32 v11, v11
 v_rsq_f32 v43, v43
 v_mul_f32_e64 v10, v10, v11
 v_mul_f32_e64 v42, v42, v43
 v_pk_fma_f32 v[26:27], v[2:3], v[10:11], v[10:11] op_sel:[0,1,0] op_sel_hi:[1,1,0] neg_lo:[0,0,1] neg_hi:[0,0,1]
 v_pk_fma_f32 v[28:29], v[4:5], v[10:11], v[10:11] op_sel:[0,1,0] op_sel_hi:[1,1,0] neg_lo:[0,0,1] neg_hi:[0,0,1]
 v_pk_fma_f32 v[30:31], v[6:7], v[10:11], v[10:11] op_sel:[0,1,0] op_sel_hi:[1,1,0] neg_lo:[0,0,1] neg_hi:[0,0,1]
 v_pk_fma_f32 v[32:33], v[8:9], v[10:11], v[10:11] op_sel:[0,1,0] op_sel_hi:[1,1,0] neg_lo:[0,0,1] neg_hi:[0,0,1]
 v_pk_fma_f32 v[58:59], v[34:35], v[42:43], v[42:43] op_sel:[0,1,0] op_sel_hi:[1,1,0] neg_lo:[0,0,1] neg_hi:[0,0,1]
 buffer_load_dwordx4 v88, s[64:67], s94 offen offset:0 lds
 v_pk_fma_f32 v[60:61], v[36:37], v[42:43], v[42:43] op_sel:[0,1,0] op_sel_hi:[1,1,0] neg_lo:[0,0,1] neg_hi:[0,0,1]
 v_pk_fma_f32 v[62:63], v[38:39], v[42:43], v[42:43] op_sel:[0,1,0] op_sel_hi:[1,1,0] neg_lo:[0,0,1] neg_hi:[0,0,1]
 v_pk_fma_f32 v[64:65], v[40:41], v[42:43], v[42:43] op_sel:[0,1,0] op_sel_hi:[1,1,0] neg_lo:[0,0,1] neg_hi:[0,0,1]
 v_and_b32_e64 v18, 15, v1
 v_lshrrev_b32_e64 v19, 4, v1
 v_and_b32_e64 v20, 31, v1
 v_lshrrev_b32_e64 v21, 5, v1
 s_and_b32 s12, s10, 3
 s_lshl_b32 s14, s12, 8
 v_add_u32_e64 v138, s14, v139
 v_and_b32 v138, 0x3ff, v138
 s_lshl_b32 s14, s10, 19
 buffer_load_dwordx4 v89, s[64:67], s94 offen offset:1024 lds
 s_lshl_b32 s15, s3, 10
 s_add_u32 s14, s14, s15
 s_add_u32 s14, s14, 12582912
 s_lshl_b32 s15, s9, 13
 s_add_u32 s79, s14, s15
 s_lshl_b32 s15, s9, 16
 s_add_u32 s80, s14, s15
 s_add_u32 s81, s80, 0x8000
 s_lshl_b32 s14, s10, 4
 s_add_u32 s14, s14, s3
 s_lshl_b32 s14, s14, 7
 s_add_u32 s82, s14, 65536
 buffer_load_dwordx4 v90, s[64:67], s94 offen offset:2048 lds
 s_add_u32 m0, s0, 12288
 s_add_u32 s94, s35, 88064
 v_mul_u32_u24 v132, 1056, v18
 v_lshl_add_u32 v132, v19, 4, v132
 v_mul_u32_u24 v133, 400, v18
 v_lshl_add_u32 v133, v19, 3, v133
 s_mul_i32 s14, s3, 96
 s_add_u32 s14, s14, 76800
 v_add_u32_e64 v133, s14, v133
 v_mul_u32_u24 v134, 400, v20
 v_lshl_add_u32 v134, v21, 4, v134
 v_add_u32 v134, 76800, v134
 v_lshrrev_b32 v22, 2, v20
 v_lshlrev_b32 v135, 16, v22
 buffer_load_dwordx4 v88, s[64:67], s94 offen offset:0 lds
 v_and_b32 v22, 3, v20
 v_lshl_add_u32 v135, v22, 5, v135
 v_lshl_add_u32 v135, v21, 4, v135
 v_lshlrev_b32 v136, 13, v19
 v_lshl_add_u32 v136, v18, 4, v136
 v_bfe_u32 v22, v1, 1, 2
 v_mul_u32_u24 v137, 2080, v22
 v_lshl_add_u32 v137, v21, 7, v137
 v_bfe_u32 v22, v1, 3, 1
 v_lshl_add_u32 v137, v22, 6, v137
 v_and_b32_e64 v22, 1, v1
 v_lshl_add_u32 v137, v22, 5, v137
 buffer_load_dwordx4 v89, s[64:67], s94 offen offset:1024 lds
 v_bfe_u32 v22, v1, 4, 1
 v_lshl_add_u32 v137, v22, 4, v137
 s_lshl_b32 s14, s3, 9
 s_add_u32 s14, s14, 67584
 v_add_u32 v137, s14, v137
 v_and_b32 v22, 7, v1
 v_lshlrev_b32 v142, 2, v22
 v_mov_b32 v140, 0xc0135761
 s_mov_b32 s72, s38
 s_mov_b32 s73, s39
 s_mov_b32 s74, 0x200000
 s_mov_b32 s75, 0x20000
 s_waitcnt vmcnt(18)
 v_xor_b32 v82, s7, v82
 s_waitcnt vmcnt(17)
 v_xor_b32 v83, s7, v83
 v_or_b32_e64 v82, v82, v83
 v_cmp_ne_u32 vcc, 0, v82
 s_cbranch_vccnz Lrt_41
Lbk_42:
 buffer_load_dwordx4 v[76:79], v74, s[60:63], s88 offen sc1
 buffer_load_dwordx4 v[80:83], v74, s[60:63], s87 offen sc1
 v_mul_u32_u24 v84, 4096, v72
 v_lshl_add_u32 v84, v75, 2, v84
 v_add_u32 v84, 67584, v84
 s_mov_b32 s100, 0xbdd2d3e8
 buffer_load_dwordx4 v90, s[64:67], s94 offen offset:2048 lds
 v_lshlrev_b32 v120, 16, v122
 v_and_b32 v121, s98, v122
 v_lshlrev_b32 v122, 16, v123
 v_and_b32 v123, s98, v123
 v_lshlrev_b32 v124, 16, v126
 v_and_b32 v125, s98, v126
 v_lshlrev_b32 v126, 16, v127
 v_and_b32 v127, s98, v127
 v_lshlrev_b32 v128, 16, v130
 v_and_b32 v129, s98, v130
 v_lshlrev_b32 v130, 16, v131
 v_and_b32 v131, s98, v131
 s_mul_i32 s12, s3, 1024
 s_add_u32 s12, s12, 67584
 v_add_u32_e64 v86, s12, v139
 s_waitcnt vmcnt(2)
 v_max3_u32 v75, v76, v77, v78
 s_waitcnt vmcnt(1)
 v_max3_u32 v85, v79, v80, v81
 v_max3_u32 v75, v75, v82, v83
 v_max_u32_e64 v75, v75, v85
 v_cmp_eq_u32 vcc, -1, v75
 s_cbranch_vccnz Lrt_44
Lbk_45:
 ds_write_b32 v84, v76 offset:0
 ds_write_b32 v84, v77 offset:1024
 ds_write_b32 v84, v78 offset:2048
 ds_write_b32 v84, v79 offset:3072
 ds_write_b32 v84, v80 offset:512
 ds_write_b32 v84, v81 offset:1536
 ds_write_b32 v84, v82 offset:2560
 ds_write_b32 v84, v83 offset:3584
 s_waitcnt vmcnt(0)
 s_waitcnt lgkmcnt(0)
 s_barrier
 ds_read_b128 v[108:111], v86
 ds_read_b128 v[112:115], v86 offset:4096
 s_add_u32 m0, s0, 102400
 s_add_u32 s94, s35, 176128
 buffer_load_dwordx4 v88, s[64:67], s94 offen offset:0 lds
 s_waitcnt lgkmcnt(1)
 v_lshlrev_b32 v18, 16, v108
 v_and_b32 v19, s98, v108
 v_lshlrev_b32 v20, 16, v109
 v_and_b32 v21, s98, v109
 v_lshlrev_b32 v22, 16, v110
 v_and_b32 v23, s98, v110
 buffer_load_dwordx4 v89, s[64:67], s94 offen offset:1024 lds
 v_lshlrev_b32 v24, 16, v111
 v_and_b32 v25, s98, v111
 v_pk_fma_f32 v[2:3], v[26:27], v[18:19], v[2:3]
 v_pk_fma_f32 v[4:5], v[28:29], v[20:21], v[4:5]
 v_pk_fma_f32 v[6:7], v[30:31], v[22:23], v[6:7]
 v_pk_fma_f32 v[8:9], v[32:33], v[24:25], v[8:9]
 v_pk_add_f32 v[10:11], v[2:3], v[4:5]
 buffer_load_dwordx4 v90, s[64:67], s94 offen offset:2048 lds
 s_add_u32 m0, s0, 114688
 s_add_u32 s94, s35, 264192
 v_pk_mul_f32 v[12:13], v[2:3], v[2:3]
 v_pk_add_f32 v[14:15], v[6:7], v[8:9]
 v_pk_fma_f32 v[12:13], v[4:5], v[4:5], v[12:13]
 v_pk_add_f32 v[10:11], v[10:11], v[14:15]
 v_pk_fma_f32 v[12:13], v[6:7], v[6:7], v[12:13]
 v_add_f32 v10, v10, v11
 v_pk_fma_f32 v[12:13], v[8:9], v[8:9], v[12:13]
 buffer_load_dwordx4 v88, s[64:67], s94 offen offset:0 lds
 v_add_f32 v11, v12, v13
 v_add_f32_dpp v10, v10, v10 quad_perm:[1,0,3,2] row_mask:0xf bank_mask:0xf
 s_waitcnt lgkmcnt(0)
 v_lshlrev_b32 v50, 16, v112
 v_add_f32_dpp v11, v11, v11 quad_perm:[1,0,3,2] row_mask:0xf bank_mask:0xf
 v_and_b32_e64 v51, s98, v112
 v_add_f32_dpp v10, v10, v10 quad_perm:[2,3,0,1] row_mask:0xf bank_mask:0xf
 buffer_load_dwordx4 v89, s[64:67], s94 offen offset:1024 lds
 v_lshlrev_b32 v52, 16, v113
 v_add_f32_dpp v11, v11, v11 quad_perm:[2,3,0,1] row_mask:0xf bank_mask:0xf
 v_and_b32 v53, s98, v113
 v_add_f32_dpp v10, v10, v10 row_half_mirror row_mask:0xf bank_mask:0xf
 v_lshlrev_b32 v54, 16, v114
 v_add_f32_dpp v11, v11, v11 row_half_mirror row_mask:0xf bank_mask:0xf
 v_and_b32 v55, s98, v114
 buffer_load_dwordx4 v90, s[64:67], s94 offen offset:2048 lds
 s_add_u32 m0, s0, 126976
 s_add_u32 s94, s13, 0
 v_add_f32_dpp v10, v10, v10 row_mirror row_mask:0xf bank_mask:0xf
 v_lshlrev_b32 v56, 16, v115
 v_add_f32_dpp v11, v11, v11 row_mirror row_mask:0xf bank_mask:0xf
 v_and_b32_e64 v57, s98, v115
 v_add_f32_dpp v10, v10, v10 row_bcast:15 row_mask:0xa bank_mask:0xf
 v_pk_fma_f32 v[34:35], v[58:59], v[50:51], v[34:35]
 v_add_f32_dpp v11, v11, v11 row_bcast:15 row_mask:0xa bank_mask:0xf
 buffer_load_dwordx4 v88, s[64:67], s94 offen offset:0 lds
 v_pk_fma_f32 v[36:37], v[60:61], v[52:53], v[36:37]
 v_add_f32_dpp v10, v10, v10 row_bcast:31 row_mask:0xc bank_mask:0xf
 v_pk_fma_f32 v[38:39], v[62:63], v[54:55], v[38:39]
 v_add_f32_dpp v11, v11, v11 row_bcast:31 row_mask:0xc bank_mask:0xf
 v_pk_fma_f32 v[40:41], v[64:65], v[56:57], v[40:41]
 v_readlane_b32 s92, v10, 63
 buffer_load_dwordx4 v89, s[64:67], s94 offen offset:1024 lds
 v_readlane_b32 s93, v11, 63
 v_mov_b32 v13, s96
 v_mul_f32 v10, s92, v13
 v_mul_f32 v11, s93, v13
 v_fma_f32 v11, -v10, v10, v11
 v_max_f32 v11, 0, v11
 v_add_f32 v11, 0x3727c5ac, v11
 buffer_load_dwordx4 v90, s[64:67], s94 offen offset:2048 lds
 v_rsq_f32 v11, v11
 s_nop 0
 v_mul_f32_e64 v10, v10, v11
 v_pk_fma_f32 v[26:27], v[2:3], v[10:11], v[10:11] op_sel:[0,1,0] op_sel_hi:[1,1,0] neg_lo:[0,0,1] neg_hi:[0,0,1]
 v_pk_fma_f32 v[28:29], v[4:5], v[10:11], v[10:11] op_sel:[0,1,0] op_sel_hi:[1,1,0] neg_lo:[0,0,1] neg_hi:[0,0,1]
 v_pk_fma_f32 v[30:31], v[6:7], v[10:11], v[10:11] op_sel:[0,1,0] op_sel_hi:[1,1,0] neg_lo:[0,0,1] neg_hi:[0,0,1]
 v_pk_fma_f32 v[32:33], v[8:9], v[10:11], v[10:11] op_sel:[0,1,0] op_sel_hi:[1,1,0] neg_lo:[0,0,1] neg_hi:[0,0,1]
 v_cvt_pk_bf16_f32 v18, v26, v27
 v_cvt_pk_bf16_f32 v19, v28, v29
 v_cvt_pk_bf16_f32 v20, v30, v31
 v_cvt_pk_bf16_f32 v21, v32, v33
 v_min_u32 v18, -2, v18
 v_min_u32 v19, -2, v19
 v_min_u32 v20, -2, v20
 v_min_u32_e64 v21, -2, v21
 s_add_u32 s14, s76, 0
 buffer_store_dwordx4 v[18:21], v139, s[60:63], s14 offen sc0 sc1
 v_add_u32 v66, 4294864896, v95
 v_add_u32 v67, 4294864896, v87
 v_add_u32 v68, 4294864896, v69
 ds_read_b64_tr_b16 v[160:161], v66 offset:0
 ds_read_b64_tr_b16 v[162:163], v66 offset:1536
 ds_read_b64_tr_b16 v[164:165], v67 offset:0
 ds_read_b64_tr_b16 v[166:167], v67 offset:1536
 ds_read_b64_tr_b16 v[168:169], v68 offset:0
 ds_read_b64_tr_b16 v[170:171], v68 offset:1536
 ds_read_b64_tr_b16 v[172:173], v66 offset:12288
 ds_read_b64_tr_b16 v[174:175], v66 offset:13824
 ds_read_b64_tr_b16 v[176:177], v67 offset:12288
 ds_read_b64_tr_b16 v[178:179], v67 offset:13824
 ds_read_b64_tr_b16 v[180:181], v68 offset:12288
 ds_read_b64_tr_b16 v[182:183], v68 offset:13824
 ds_read_b64_tr_b16 a[224:225], v66 offset:33792
 ds_read_b64_tr_b16 a[226:227], v66 offset:35328
 ds_read_b64_tr_b16 a[228:229], v67 offset:33792
 ds_read_b64_tr_b16 a[230:231], v67 offset:35328
 ds_read_b64_tr_b16 a[232:233], v68 offset:33792
 ds_read_b64_tr_b16 a[234:235], v68 offset:35328
 ds_read_b64_tr_b16 a[236:237], v66 offset:46080
 ds_read_b64_tr_b16 a[238:239], v66 offset:47616
 ds_read_b64_tr_b16 a[240:241], v67 offset:46080
 ds_read_b64_tr_b16 a[242:243], v67 offset:47616
 ds_read_b64_tr_b16 a[244:245], v68 offset:46080
 ds_read_b64_tr_b16 a[246:247], v68 offset:47616
 v_add_u32 v66, 4294941696, v95
 v_add_u32 v67, 4294941696, v87
 v_add_u32 v68, 4294941696, v69
 ds_read_b64_tr_b16 a[248:249], v66 offset:0
 ds_read_b64_tr_b16 a[250:251], v66 offset:1536
 ds_read_b64_tr_b16 a[252:253], v67 offset:0
 ds_read_b64_tr_b16 a[254:255], v67 offset:1536
 ds_read_b64_tr_b16 v[144:145], v68 offset:0
 ds_read_b64_tr_b16 v[146:147], v68 offset:1536
 ds_read_b64_tr_b16 v[148:149], v66 offset:12288
 ds_read_b64_tr_b16 v[150:151], v66 offset:13824
 ds_read_b64_tr_b16 v[152:153], v67 offset:12288
 ds_read_b64_tr_b16 v[154:155], v67 offset:13824
 ds_read_b64_tr_b16 v[156:157], v68 offset:12288
 ds_read_b64_tr_b16 v[158:159], v68 offset:13824
 v_cvt_pk_bf16_f32 v100, v2, v3
 v_cvt_pk_bf16_f32 v101, v4, v5
 v_cvt_pk_bf16_f32 v102, v6, v7
 v_cvt_pk_bf16_f32 v103, v8, v9
 s_waitcnt lgkmcnt(0)
 s_barrier
 v_pk_add_f32 v[42:43], v[34:35], v[36:37]
 v_pk_mul_f32 v[44:45], v[34:35], v[34:35]
 v_pk_add_f32 v[46:47], v[38:39], v[40:41]
 v_pk_fma_f32 v[44:45], v[36:37], v[36:37], v[44:45]
 v_pk_add_f32 v[42:43], v[42:43], v[46:47]
 v_pk_fma_f32 v[44:45], v[38:39], v[38:39], v[44:45]
 v_add_f32_e64 v42, v42, v43
 v_pk_fma_f32 v[44:45], v[40:41], v[40:41], v[44:45]
 s_add_u32 s86, s77, 0
 s_add_u32 s87, s78, 0
 s_add_u32 m0, s101, 0
 s_nop 0
 buffer_load_dwordx4 v138, s[60:63], s86 offen offset:0 sc0 sc1 lds
 s_add_u32 m0, s101, 32
 v_add_f32 v43, v44, v45
 v_add_f32_dpp v42, v42, v42 quad_perm:[1,0,3,2] row_mask:0xf bank_mask:0xf
 buffer_load_dwordx4 v138, s[60:63], s86 offen offset:1024 sc0 sc1 lds
 s_add_u32 m0, s101, 64
 v_add_f32_dpp v43, v43, v43 quad_perm:[1,0,3,2] row_mask:0xf bank_mask:0xf
 v_add_f32_dpp v42, v42, v42 quad_perm:[2,3,0,1] row_mask:0xf bank_mask:0xf
 s_nop 0
 v_add_f32_dpp v43, v43, v43 quad_perm:[2,3,0,1] row_mask:0xf bank_mask:0xf
 buffer_load_dwordx4 v138, s[60:63], s86 offen offset:2048 sc0 sc1 lds
 s_add_u32 m0, s101, 96
 v_add_f32_dpp v42, v42, v42 row_half_mirror row_mask:0xf bank_mask:0xf
 v_add_f32_dpp v43, v43, v43 row_half_mirror row_mask:0xf bank_mask:0xf
 s_nop 0
 v_add_f32_dpp v42, v42, v42 row_mirror row_mask:0xf bank_mask:0xf
 buffer_load_dwordx4 v138, s[60:63], s86 offen offset:3072 sc0 sc1 lds
 s_add_u32 m0, s101, 4224
 v_add_f32_dpp v43, v43, v43 row_mirror row_mask:0xf bank_mask:0xf
 v_add_f32_dpp v42, v42, v42 row_bcast:15 row_mask:0xa bank_mask:0xf
 s_nop 0
 v_add_f32_dpp v43, v43, v43 row_bcast:15 row_mask:0xa bank_mask:0xf
 buffer_load_dwordx4 v138, s[60:63], s87 offen offset:0 sc0 sc1 lds
 s_add_u32 m0, s101, 4256
 v_add_f32_dpp v42, v42, v42 row_bcast:31 row_mask:0xc bank_mask:0xf
 v_add_f32_dpp v43, v43, v43 row_bcast:31 row_mask:0xc bank_mask:0xf
 buffer_load_dwordx4 v138, s[60:63], s87 offen offset:1024 sc0 sc1 lds
 s_add_u32 m0, s101, 4288
 v_readlane_b32 s90, v42, 63
 v_readlane_b32 s91, v43, 63
 v_mov_b32_e64 v45, s96
 buffer_load_dwordx4 v138, s[60:63], s87 offen offset:2048 sc0 sc1 lds
 s_add_u32 m0, s101, 4320
 v_mul_f32 v42, s90, v45
 v_mul_f32 v43, s91, v45
 v_fma_f32 v43, -v42, v42, v43
 buffer_load_dwordx4 v138, s[60:63], s87 offen offset:3072 sc0 sc1 lds
 v_max_f32 v43, 0, v43
 v_add_f32 v43, 0x3727c5ac, v43
 v_rsq_f32 v43, v43
 s_add_u32 m0, s0, 139264
 s_add_u32 s94, s13, 88064
 buffer_load_dwordx4 v88, s[64:67], s94 offen offset:0 lds
 v_mul_f32_e64 v42, v42, v43
 v_pk_fma_f32 v[58:59], v[34:35], v[42:43], v[42:43] op_sel:[0,1,0] op_sel_hi:[1,1,0] neg_lo:[0,0,1] neg_hi:[0,0,1]
 buffer_load_dwordx4 v89, s[64:67], s94 offen offset:1024 lds
 v_pk_fma_f32 v[60:61], v[36:37], v[42:43], v[42:43] op_sel:[0,1,0] op_sel_hi:[1,1,0] neg_lo:[0,0,1] neg_hi:[0,0,1]
 v_pk_fma_f32 v[62:63], v[38:39], v[42:43], v[42:43] op_sel:[0,1,0] op_sel_hi:[1,1,0] neg_lo:[0,0,1] neg_hi:[0,0,1]
 buffer_load_dwordx4 v90, s[64:67], s94 offen offset:2048 lds
 s_add_u32 m0, s0, 151552
 s_add_u32 s94, s13, 176128
 v_pk_fma_f32 v[64:65], v[40:41], v[42:43], v[42:43] op_sel:[0,1,0] op_sel_hi:[1,1,0] neg_lo:[0,0,1] neg_hi:[0,0,1]
 v_cvt_pk_bf16_f32 v50, v58, v59
 buffer_load_dwordx4 v88, s[64:67], s94 offen offset:0 lds
 v_cvt_pk_bf16_f32 v51, v60, v61
 v_cvt_pk_bf16_f32 v52, v62, v63
 buffer_load_dwordx4 v89, s[64:67], s94 offen offset:1024 lds
 v_cvt_pk_bf16_f32 v53, v64, v65
 v_min_u32_e64 v50, -2, v50
 buffer_load_dwordx4 v90, s[64:67], s94 offen offset:2048 lds
 v_min_u32_e64 v51, -2, v51
 v_min_u32_e64 v52, -2, v52
 v_min_u32_e64 v53, -2, v53
 s_add_u32 s15, s76, 4096
 buffer_store_dwordx4 v[50:53], v139, s[60:63], s15 offen sc0 sc1
 s_add_u32 m0, s0, 76800
 s_add_u32 s94, s13, 264192
 buffer_load_dwordx4 v88, s[64:67], s94 offen offset:0 lds
 v_cvt_pk_bf16_f32 v104, v34, v35
 buffer_load_dwordx4 v89, s[64:67], s94 offen offset:1024 lds
 v_cvt_pk_bf16_f32 v105, v36, v37
 buffer_load_dwordx4 v90, s[64:67], s94 offen offset:2048 lds
 v_cvt_pk_bf16_f32 v106, v38, v39
 v_cvt_pk_bf16_f32 v107, v40, v41
 s_waitcnt vmcnt(10)
 v_add_u32 v71, s101, v139
 ds_read_b128 v[2:5], v71 offset:0
 ds_read_b128 v[6:9], v71 offset:1056
 ds_read_b128 v[10:13], v71 offset:2112
 ds_read_b128 v[14:17], v71 offset:3168
 ds_read_b128 v[18:21], v71 offset:4224
 ds_read_b128 v[22:25], v71 offset:5280
 ds_read_b128 v[26:29], v71 offset:6336
 ds_read_b128 v[30:33], v71 offset:7392
 s_waitcnt lgkmcnt(0)
 v_max_u32 v70, v2, v3
 v_max3_u32 v70, v70, v4, v5
 v_max3_u32 v70, v70, v6, v7
 v_max3_u32 v70, v70, v8, v9
 v_max3_u32 v70, v70, v10, v11
 v_max3_u32 v70, v70, v12, v13
 v_max3_u32 v70, v70, v14, v15
 v_max3_u32 v70, v70, v16, v17
 v_max3_u32 v70, v70, v18, v19
 v_max3_u32 v70, v70, v20, v21
 v_max3_u32 v70, v70, v22, v23
 v_max3_u32 v70, v70, v24, v25
 v_max3_u32 v70, v70, v26, v27
 v_max3_u32 v70, v70, v28, v29
 v_max3_u32 v70, v70, v30, v31
 v_max3_u32 v70, v70, v32, v33
 v_cmp_eq_u32 vcc, -1, v70
 s_cbranch_vccnz Lrt_47
Lbk_48:
 s_or_b32 s14, s2, s3
 s_cmp_lg_u32 s14, 0
 s_nop 0
 s_cbranch_scc1 Lep_50
 buffer_store_dword v143, off, s[60:63], 0 sc0 sc1
Lep_50:
 s_waitcnt lgkmcnt(0)
 s_barrier
 ds_read_b128 v[50:53], v132 offset:0
 ds_read_b128 v[54:57], v132 offset:64
 ds_read_b128 v[58:61], v132 offset:128
 s_waitcnt lgkmcnt(1)
 v_mfma_f32_16x16x32_bf16 v[2:5], a[176:179], v[50:53], v[120:123]
 ds_read_b128 v[62:65], v132 offset:192
 ds_read_b64_tr_b16 v[184:185], v95 offset:0
 v_mfma_f32_16x16x32_bf16 v[6:9], a[180:183], v[50:53], v[124:127]
 ds_read_b64_tr_b16 v[186:187], v95 offset:1536
 ds_read_b64_tr_b16 v[188:189], v87 offset:0
 v_mfma_f32_16x16x32_bf16 v[10:13], a[184:187], v[50:53], v[128:131]
 ds_read_b64_tr_b16 v[190:191], v87 offset:1536
 ds_read_b64_tr_b16 v[192:193], v69 offset:0
 v_mfma_f32_16x16x32_bf16 v[2:5], a[188:191], v[54:57], v[2:5]
 ds_read_b128 v[50:53], v132 offset:256
 ds_read_b64_tr_b16 v[194:195], v69 offset:1536
 v_mfma_f32_16x16x32_bf16 v[6:9], a[192:195], v[54:57], v[6:9]
 ds_read_b64_tr_b16 v[196:197], v95 offset:12288
 ds_read_b64_tr_b16 v[198:199], v95 offset:13824
 v_mfma_f32_16x16x32_bf16 v[10:13], a[196:199], v[54:57], v[10:13]
 ds_read_b64_tr_b16 v[200:201], v87 offset:12288
 s_waitcnt lgkmcnt(10)
 v_mfma_f32_16x16x32_bf16 v[2:5], a[200:203], v[58:61], v[2:5]
 ds_read_b128 v[54:57], v132 offset:320
 ds_read_b64_tr_b16 v[202:203], v87 offset:13824
 v_mfma_f32_16x16x32_bf16 v[6:9], a[204:207], v[58:61], v[6:9]
 ds_read_b64_tr_b16 v[204:205], v69 offset:12288
 ds_read_b64_tr_b16 v[206:207], v69 offset:13824
 v_mfma_f32_16x16x32_bf16 v[10:13], a[208:211], v[58:61], v[10:13]
 s_add_u32 s86, s77, 4096
 s_add_u32 s87, s78, 4096
 s_add_u32 m0, s101, 33792
 v_mfma_f32_16x16x32_bf16 v[2:5], a[212:215], v[62:65], v[2:5]
 ds_read_b128 v[58:61], v132 offset:384
 buffer_load_dwordx4 v138, s[60:63], s86 offen offset:0 sc0 sc1 lds
 s_add_u32 m0, s101, 33824
 v_mfma_f32_16x16x32_bf16 v[6:9], a[216:219], v[62:65], v[6:9]
 ds_read_b64_tr_b16 v[208:209], v95 offset:24576
 ds_read_b64_tr_b16 v[210:211], v95 offset:26112
 v_mfma_f32_16x16x32_bf16 v[10:13], a[220:223], v[62:65], v[10:13]
 ds_read_b64_tr_b16 v[212:213], v87 offset:24576
 s_waitcnt lgkmcnt(7)
 v_mfma_f32_16x16x32_bf16 v[2:5], a[224:227], v[50:53], v[2:5]
 ds_read_b128 v[62:65], v132 offset:448
 ds_read_b64_tr_b16 v[214:215], v87 offset:26112
 v_mfma_f32_16x16x32_bf16 v[6:9], a[228:231], v[50:53], v[6:9]
 buffer_load_dwordx4 v138, s[60:63], s86 offen offset:1024 sc0 sc1 lds
 s_add_u32 m0, s101, 33856
 v_mfma_f32_16x16x32_bf16 v[10:13], a[232:235], v[50:53], v[10:13]
 ds_read_b64_tr_b16 v[216:217], v69 offset:24576
 ds_read_b64_tr_b16 v[218:219], v69 offset:26112
 v_mfma_f32_16x16x32_bf16 v[2:5], a[236:239], v[54:57], v[2:5]
 ds_read_b128 v[50:53], v132 offset:512
 v_mfma_f32_16x16x32_bf16 v[6:9], a[240:243], v[54:57], v[6:9]
 s_waitcnt vmcnt(2)
 s_barrier
 v_mfma_f32_16x16x32_bf16 v[10:13], a[244:247], v[54:57], v[10:13]
 ds_read_b64_tr_b16 v[220:221], v95 offset:36864
 ds_read_b64_tr_b16 v[222:223], v95 offset:38400
 buffer_load_dwordx4 v138, s[60:63], s86 offen offset:2048 sc0 sc1 lds
 s_add_u32 m0, s101, 33888
 s_waitcnt lgkmcnt(6)
 v_mfma_f32_16x16x32_bf16 v[2:5], a[248:251], v[58:61], v[2:5]
 ds_read_b128 v[54:57], v132 offset:576
 ds_read_b64_tr_b16 v[224:225], v87 offset:36864
 ds_read_b64_tr_b16 v[226:227], v87 offset:38400
 v_mfma_f32_16x16x32_bf16 v[6:9], a[252:255], v[58:61], v[6:9]
 ds_read_b64_tr_b16 v[228:229], v69 offset:36864
 ds_read_b64_tr_b16 v[230:231], v69 offset:38400
 v_mfma_f32_16x16x32_bf16 v[10:13], v[144:147], v[58:61], v[10:13]
 ds_read_b64_tr_b16 v[232:233], v95 offset:49152
 ds_read_b64_tr_b16 v[234:235], v95 offset:50688
 v_mfma_f32_16x16x32_bf16 v[2:5], v[148:151], v[62:65], v[2:5]
 ds_read_b128 v[58:61], v132 offset:640
 ds_read_b64_tr_b16 v[236:237], v87 offset:49152
 ds_read_b64_tr_b16 v[238:239], v87 offset:50688
 buffer_load_dwordx4 v138, s[60:63], s86 offen offset:3072 sc0 sc1 lds
 s_add_u32 m0, s101, 38016
 v_mfma_f32_16x16x32_bf16 v[6:9], v[152:155], v[62:65], v[6:9]
 ds_read_b64_tr_b16 v[240:241], v69 offset:49152
 ds_read_b64_tr_b16 v[242:243], v69 offset:50688
 v_mfma_f32_16x16x32_bf16 v[10:13], v[156:159], v[62:65], v[10:13]
 v_add_u32 v84, 4294941696, v95
 v_add_u32 v85, 4294941696, v87
 s_waitcnt lgkmcnt(11)
 v_mfma_f32_16x16x32_bf16 v[2:5], v[160:163], v[50:53], v[2:5]
 ds_read_b128 v[62:65], v132 offset:704
 v_add_u32 v86, 4294941696, v69
 ds_read_b64_tr_b16 v[244:245], v84 offset:0
 v_mfma_f32_16x16x32_bf16 v[6:9], v[164:167], v[50:53], v[6:9]
 ds_read_b64_tr_b16 v[246:247], v84 offset:1536
 ds_read_b64_tr_b16 v[248:249], v85 offset:0
 buffer_load_dwordx4 v138, s[60:63], s87 offen offset:0 sc0 sc1 lds
 s_add_u32 m0, s101, 38048
 v_mfma_f32_16x16x32_bf16 v[10:13], v[168:171], v[50:53], v[10:13]
 ds_read_b64_tr_b16 v[250:251], v85 offset:1536
 ds_read_b64_tr_b16 v[252:253], v86 offset:0
 v_mfma_f32_16x16x32_bf16 v[2:5], v[172:175], v[54:57], v[2:5]
 ds_read_b128 v[50:53], v132 offset:768
 ds_read_b64_tr_b16 v[254:255], v86 offset:1536
 v_mfma_f32_16x16x32_bf16 v[6:9], v[176:179], v[54:57], v[6:9]
 v_mfma_f32_16x16x32_bf16 v[10:13], v[180:183], v[54:57], v[10:13]
 buffer_load_dwordx4 v138, s[60:63], s87 offen offset:1024 sc0 sc1 lds
 s_add_u32 m0, s101, 38080
 s_waitcnt lgkmcnt(7)
 v_mfma_f32_16x16x32_bf16 v[2:5], v[184:187], v[58:61], v[2:5]
 ds_read_b128 v[54:57], v132 offset:832
 v_mfma_f32_16x16x32_bf16 v[6:9], v[188:191], v[58:61], v[6:9]
 v_mfma_f32_16x16x32_bf16 v[10:13], v[192:195], v[58:61], v[10:13]
 v_mfma_f32_16x16x32_bf16 v[2:5], v[196:199], v[62:65], v[2:5]
 ds_read_b128 v[58:61], v132 offset:896
 buffer_load_dwordx4 v138, s[60:63], s87 offen offset:2048 sc0 sc1 lds
 s_add_u32 m0, s101, 38112
 v_mfma_f32_16x16x32_bf16 v[6:9], v[200:203], v[62:65], v[6:9]
 v_mfma_f32_16x16x32_bf16 v[10:13], v[204:207], v[62:65], v[10:13]
 s_waitcnt lgkmcnt(1)
 v_mfma_f32_16x16x32_bf16 v[2:5], v[208:211], v[50:53], v[2:5]
 ds_read_b128 v[62:65], v132 offset:960
 v_mfma_f32_16x16x32_bf16 v[6:9], v[212:215], v[50:53], v[6:9]
 s_waitcnt lgkmcnt(0)
 s_barrier
 buffer_load_dwordx4 v138, s[60:63], s87 offen offset:3072 sc0 sc1 lds
 v_add_u32 v75, s101, v139
 v_mfma_f32_16x16x32_bf16 v[10:13], v[216:219], v[50:53], v[10:13]
 s_waitcnt vmcnt(4)
 ds_read_b128 v[66:69], v75 offset:33792
 v_mfma_f32_16x16x32_bf16 v[2:5], v[220:223], v[54:57], v[2:5]
 ds_read_b128 v[50:53], v132 offset:16896
 ds_read_b128 v[70:73], v75 offset:34848
 ds_read_b128 v[76:79], v75 offset:35904
 s_add_u32 m0, s84, 0
 v_mfma_f32_16x16x32_bf16 v[6:9], v[224:227], v[54:57], v[6:9]
 ds_read_b128 v[80:83], v75 offset:36960
 buffer_load_dwordx4 v91, s[68:71], s18 offen offset:0 lds
 v_mfma_f32_16x16x32_bf16 v[10:13], v[228:231], v[54:57], v[10:13]
 v_mfma_f32_16x16x32_bf16 v[2:5], v[232:235], v[58:61], v[2:5]
 ds_read_b128 v[54:57], v132 offset:16960
 v_mfma_f32_16x16x32_bf16 v[6:9], v[236:239], v[58:61], v[6:9]
 v_mfma_f32_16x16x32_bf16 v[10:13], v[240:243], v[58:61], v[10:13]
 v_mfma_f32_16x16x32_bf16 v[2:5], v[244:247], v[62:65], v[2:5]
 ds_read_b128 v[58:61], v132 offset:17024
 buffer_load_dwordx4 v92, s[68:71], s18 offen offset:1024 lds
 v_mfma_f32_16x16x32_bf16 v[6:9], v[248:251], v[62:65], v[6:9]
 s_waitcnt lgkmcnt(2)
 v_max_u32_e64 v74, v66, v67
 v_max3_u32 v74, v74, v68, v69
 v_mfma_f32_16x16x32_bf16 v[10:13], v[252:255], v[62:65], v[10:13]
 v_max3_u32 v74, v74, v70, v71
 v_max3_u32 v74, v74, v72, v73
 s_waitcnt lgkmcnt(1)
 v_mfma_f32_16x16x32_bf16 v[14:17], a[176:179], v[50:53], v[120:123]
 ds_read_b128 v[62:65], v132 offset:17088
 v_max3_u32 v74, v74, v76, v77
 v_max3_u32 v74, v74, v78, v79
 v_mfma_f32_16x16x32_bf16 v[18:21], a[180:183], v[50:53], v[124:127]
 v_max3_u32 v74, v74, v80, v81
 v_max3_u32 v74, v74, v82, v83
 v_mfma_f32_16x16x32_bf16 v[22:25], a[184:187], v[50:53], v[128:131]
 buffer_load_dwordx4 v93, s[68:71], s18 offen offset:2048 lds
 v_mul_f32_e64 v66, v2, v2
 v_mfma_f32_16x16x32_bf16 v[14:17], a[188:191], v[54:57], v[14:17]
 ds_read_b128 v[50:53], v132 offset:17152
 v_mul_f32_e64 v67, v3, v3
 v_mfma_f32_16x16x32_bf16 v[18:21], a[192:195], v[54:57], v[18:21]
 v_mul_f32_e64 v68, v4, v4
 v_mul_f32 v69, v5, v5
 v_mfma_f32_16x16x32_bf16 v[22:25], a[196:199], v[54:57], v[22:25]
 v_fma_f32 v66, v66, s100, v140
 s_waitcnt lgkmcnt(1)
 v_mfma_f32_16x16x32_bf16 v[14:17], a[200:203], v[58:61], v[14:17]
 ds_read_b128 v[54:57], v132 offset:17216
 v_fma_f32 v67, v67, s100, v140
 v_mfma_f32_16x16x32_bf16 v[18:21], a[204:207], v[58:61], v[18:21]
 buffer_load_dwordx4 v94, s[68:71], s18 offen offset:3072 lds
 s_add_u32 m0, s84, 4096
 v_mfma_f32_16x16x32_bf16 v[22:25], a[208:211], v[58:61], v[22:25]
 v_fma_f32 v68, v68, s100, v140
 v_fma_f32 v69, v69, s100, v140
 v_mfma_f32_16x16x32_bf16 v[14:17], a[212:215], v[62:65], v[14:17]
 ds_read_b128 v[58:61], v132 offset:17280
 v_mul_f32_e64 v66, v66, v2
 v_mfma_f32_16x16x32_bf16 v[18:21], a[216:219], v[62:65], v[18:21]
 s_waitcnt vmcnt(4)
 ds_read_b128 v[76:79], v75 offset:38016
 v_mfma_f32_16x16x32_bf16 v[22:25], a[220:223], v[62:65], v[22:25]
 ds_read_b128 v[80:83], v75 offset:39072
 s_waitcnt lgkmcnt(3)
 v_mfma_f32_16x16x32_bf16 v[14:17], a[224:227], v[50:53], v[14:17]
 ds_read_b128 v[62:65], v132 offset:17344
 buffer_load_dwordx4 v91, s[68:71], s19 offen offset:0 lds
 v_mfma_f32_16x16x32_bf16 v[18:21], a[228:231], v[50:53], v[18:21]
 v_mul_f32 v67, v67, v3
 v_mul_f32 v68, v68, v4
 v_mfma_f32_16x16x32_bf16 v[22:25], a[232:235], v[50:53], v[22:25]
 v_mul_f32_e64 v69, v69, v5
 v_mfma_f32_16x16x32_bf16 v[14:17], a[236:239], v[54:57], v[14:17]
 ds_read_b128 v[50:53], v132 offset:17408
 v_mfma_f32_16x16x32_bf16 v[18:21], a[240:243], v[54:57], v[18:21]
 v_exp_f32_e64 v66, v66
 v_mfma_f32_16x16x32_bf16 v[22:25], a[244:247], v[54:57], v[22:25]
 s_waitcnt lgkmcnt(2)
 v_max3_u32 v74, v74, v76, v77
 v_max3_u32 v74, v74, v78, v79
 s_waitcnt lgkmcnt(1)
 v_mfma_f32_16x16x32_bf16 v[14:17], a[248:251], v[58:61], v[14:17]
 ds_read_b128 v[54:57], v132 offset:17472
 v_max3_u32 v74, v74, v80, v81
 v_max3_u32 v74, v74, v82, v83
 v_mfma_f32_16x16x32_bf16 v[18:21], a[252:255], v[58:61], v[18:21]
 ds_read_b128 v[76:79], v75 offset:40128
 ds_read_b128 v[80:83], v75 offset:41184
 v_mfma_f32_16x16x32_bf16 v[22:25], v[144:147], v[58:61], v[22:25]
 v_exp_f32_e64 v67, v67
 v_mfma_f32_16x16x32_bf16 v[14:17], v[148:151], v[62:65], v[14:17]
 ds_read_b128 v[58:61], v132 offset:17536
 v_add_f32 v66, 1.0, v66
 v_mfma_f32_16x16x32_bf16 v[18:21], v[152:155], v[62:65], v[18:21]
 v_exp_f32 v68, v68
 v_mfma_f32_16x16x32_bf16 v[22:25], v[156:159], v[62:65], v[22:25]
 v_add_f32 v67, 1.0, v67
 s_waitcnt lgkmcnt(3)
 v_mfma_f32_16x16x32_bf16 v[14:17], v[160:163], v[50:53], v[14:17]
 ds_read_b128 v[62:65], v132 offset:17600
 v_add_f32 v68, 1.0, v68
 v_mfma_f32_16x16x32_bf16 v[18:21], v[164:167], v[50:53], v[18:21]
 v_exp_f32_e64 v69, v69
 v_mfma_f32_16x16x32_bf16 v[22:25], v[168:171], v[50:53], v[22:25]
 s_waitcnt lgkmcnt(2)
 v_max3_u32 v74, v74, v76, v77
 v_max3_u32 v74, v74, v78, v79
 v_mfma_f32_16x16x32_bf16 v[14:17], v[172:175], v[54:57], v[14:17]
 ds_read_b128 v[50:53], v132 offset:17664
 v_max3_u32 v74, v74, v80, v81
 v_max3_u32 v74, v74, v82, v83
 buffer_load_dwordx4 v92, s[68:71], s19 offen offset:1024 lds
 v_mfma_f32_16x16x32_bf16 v[18:21], v[176:179], v[54:57], v[18:21]
 v_cmp_eq_u32 vcc, -1, v74
 s_cbranch_vccnz Lrt_51
Lbk_52:
 v_mfma_f32_16x16x32_bf16 v[22:25], v[180:183], v[54:57], v[22:25]
 s_barrier
 s_waitcnt lgkmcnt(1)
 v_mfma_f32_16x16x32_bf16 v[14:17], v[184:187], v[58:61], v[14:17]
 ds_read_b128 v[54:57], v132 offset:17728
 v_add_f32 v69, 1.0, v69
 v_mfma_f32_16x16x32_bf16 v[18:21], v[188:191], v[58:61], v[18:21]
 v_rcp_f32 v66, v66
 v_mfma_f32_16x16x32_bf16 v[22:25], v[192:195], v[58:61], v[22:25]
 v_rcp_f32 v67, v67
 v_mfma_f32_16x16x32_bf16 v[14:17], v[196:199], v[62:65], v[14:17]
 ds_read_b128 v[58:61], v132 offset:17792
 v_mul_f32 v66, v66, v2
 v_mfma_f32_16x16x32_bf16 v[18:21], v[200:203], v[62:65], v[18:21]
 v_rcp_f32 v68, v68
 v_mfma_f32_16x16x32_bf16 v[22:25], v[204:207], v[62:65], v[22:25]
 v_mul_f32_e64 v67, v67, v3
 s_waitcnt lgkmcnt(1)
 v_mfma_f32_16x16x32_bf16 v[14:17], v[208:211], v[50:53], v[14:17]
 ds_read_b128 v[62:65], v132 offset:17856
 v_mul_f32 v68, v68, v4
 v_mfma_f32_16x16x32_bf16 v[18:21], v[212:215], v[50:53], v[18:21]
 v_rcp_f32 v69, v69
 v_mfma_f32_16x16x32_bf16 v[22:25], v[216:219], v[50:53], v[22:25]
 v_mul_f32_e64 v69, v69, v5
 v_cvt_pk_bf16_f32 v66, v66, v67
 v_mfma_f32_16x16x32_bf16 v[14:17], v[220:223], v[54:57], v[14:17]
 ds_read_b128 v[50:53], v132 offset:33792
 v_cvt_pk_bf16_f32 v67, v68, v69
 v_mfma_f32_16x16x32_bf16 v[18:21], v[224:227], v[54:57], v[18:21]
 ds_write_b64 v133, v[66:67] offset:0
 v_mul_f32_e64 v70, v6, v6
 v_mfma_f32_16x16x32_bf16 v[22:25], v[228:231], v[54:57], v[22:25]
 v_mul_f32 v71, v7, v7
 s_waitcnt lgkmcnt(2)
 v_mfma_f32_16x16x32_bf16 v[14:17], v[232:235], v[58:61], v[14:17]
 ds_read_b128 v[54:57], v132 offset:33856
 buffer_load_dwordx4 v93, s[68:71], s19 offen offset:2048 lds
 v_mfma_f32_16x16x32_bf16 v[18:21], v[236:239], v[58:61], v[18:21]
 v_mul_f32 v72, v8, v8
 v_mul_f32 v73, v9, v9
 v_mfma_f32_16x16x32_bf16 v[22:25], v[240:243], v[58:61], v[22:25]
 v_fma_f32 v70, v70, s100, v140
 v_fma_f32 v71, v71, s100, v140
 v_mfma_f32_16x16x32_bf16 v[14:17], v[244:247], v[62:65], v[14:17]
 ds_read_b128 v[58:61], v132 offset:33920
 v_fma_f32 v72, v72, s100, v140
 v_mfma_f32_16x16x32_bf16 v[18:21], v[248:251], v[62:65], v[18:21]
 v_fma_f32 v73, v73, s100, v140
 v_mul_f32_e64 v70, v70, v6
 v_mfma_f32_16x16x32_bf16 v[22:25], v[252:255], v[62:65], v[22:25]
 v_mul_f32 v71, v71, v7
 v_mul_f32_e64 v72, v72, v8
 s_waitcnt lgkmcnt(1)
 v_mfma_f32_16x16x32_bf16 v[26:29], a[176:179], v[50:53], v[120:123]
 ds_read_b128 v[62:65], v132 offset:33984
 v_mul_f32 v73, v73, v9
 v_mfma_f32_16x16x32_bf16 v[30:33], a[180:183], v[50:53], v[124:127]
 v_exp_f32 v70, v70
 v_mfma_f32_16x16x32_bf16 v[34:37], a[184:187], v[50:53], v[128:131]
 v_exp_f32 v71, v71
 v_mfma_f32_16x16x32_bf16 v[26:29], a[188:191], v[54:57], v[26:29]
 ds_read_b128 v[50:53], v132 offset:34048
 v_add_f32 v70, 1.0, v70
 v_mfma_f32_16x16x32_bf16 v[30:33], a[192:195], v[54:57], v[30:33]
 v_exp_f32 v72, v72
 v_mfma_f32_16x16x32_bf16 v[34:37], a[196:199], v[54:57], v[34:37]
 v_add_f32_e64 v71, 1.0, v71
 s_waitcnt lgkmcnt(1)
 v_mfma_f32_16x16x32_bf16 v[26:29], a[200:203], v[58:61], v[26:29]
 ds_read_b128 v[54:57], v132 offset:34112
 v_add_f32 v72, 1.0, v72
 v_mfma_f32_16x16x32_bf16 v[30:33], a[204:207], v[58:61], v[30:33]
 v_exp_f32 v73, v73
 v_mfma_f32_16x16x32_bf16 v[34:37], a[208:211], v[58:61], v[34:37]
 v_add_f32_e64 v73, 1.0, v73
 v_mfma_f32_16x16x32_bf16 v[26:29], a[212:215], v[62:65], v[26:29]
 ds_read_b128 v[58:61], v132 offset:34176
 buffer_load_dwordx4 v94, s[68:71], s19 offen offset:3072 lds
 s_add_u32 m0, s84, 8192
 v_mfma_f32_16x16x32_bf16 v[30:33], a[216:219], v[62:65], v[30:33]
 v_rcp_f32 v70, v70
 v_mfma_f32_16x16x32_bf16 v[34:37], a[220:223], v[62:65], v[34:37]
 v_mul_f32 v70, v70, v6
 s_waitcnt lgkmcnt(1)
 v_mfma_f32_16x16x32_bf16 v[26:29], a[224:227], v[50:53], v[26:29]
 ds_read_b128 v[62:65], v132 offset:34240
 v_mfma_f32_16x16x32_bf16 v[30:33], a[228:231], v[50:53], v[30:33]
 v_rcp_f32 v71, v71
 v_mfma_f32_16x16x32_bf16 v[34:37], a[232:235], v[50:53], v[34:37]
 v_rcp_f32 v72, v72
 v_mfma_f32_16x16x32_bf16 v[26:29], a[236:239], v[54:57], v[26:29]
 ds_read_b128 v[50:53], v132 offset:34304
 v_mul_f32 v71, v71, v7
 v_mfma_f32_16x16x32_bf16 v[30:33], a[240:243], v[54:57], v[30:33]
 v_rcp_f32 v73, v73
 v_mfma_f32_16x16x32_bf16 v[34:37], a[244:247], v[54:57], v[34:37]
 v_mul_f32_e64 v72, v72, v8
 s_waitcnt lgkmcnt(1)
 v_mfma_f32_16x16x32_bf16 v[26:29], a[248:251], v[58:61], v[26:29]
 ds_read_b128 v[54:57], v132 offset:34368
 v_mul_f32_e64 v73, v73, v9
 v_mfma_f32_16x16x32_bf16 v[30:33], a[252:255], v[58:61], v[30:33]
 v_cvt_pk_bf16_f32 v70, v70, v71
 v_cvt_pk_bf16_f32 v71, v72, v73
 v_mfma_f32_16x16x32_bf16 v[34:37], v[144:147], v[58:61], v[34:37]
 ds_write_b64 v133, v[70:71] offset:32
 v_mul_f32 v66, v10, v10
 v_mfma_f32_16x16x32_bf16 v[26:29], v[148:151], v[62:65], v[26:29]
 ds_read_b128 v[58:61], v132 offset:34432
 v_mul_f32 v67, v11, v11
 v_mfma_f32_16x16x32_bf16 v[30:33], v[152:155], v[62:65], v[30:33]
 v_mul_f32 v68, v12, v12
 v_mul_f32_e64 v69, v13, v13
 v_mfma_f32_16x16x32_bf16 v[34:37], v[156:159], v[62:65], v[34:37]
 v_fma_f32 v66, v66, s100, v140
 s_waitcnt lgkmcnt(2)
 v_mfma_f32_16x16x32_bf16 v[26:29], v[160:163], v[50:53], v[26:29]
 ds_read_b128 v[62:65], v132 offset:34496
 buffer_load_dwordx4 v91, s[68:71], s20 offen offset:0 lds
 v_mfma_f32_16x16x32_bf16 v[30:33], v[164:167], v[50:53], v[30:33]
 v_fma_f32 v67, v67, s100, v140
 v_fma_f32 v68, v68, s100, v140
 v_mfma_f32_16x16x32_bf16 v[34:37], v[168:171], v[50:53], v[34:37]
 v_fma_f32 v69, v69, s100, v140
 v_mul_f32 v66, v66, v10
 v_mfma_f32_16x16x32_bf16 v[26:29], v[172:175], v[54:57], v[26:29]
 ds_read_b128 v[50:53], v132 offset:34560
 v_mul_f32 v67, v67, v11
 v_mfma_f32_16x16x32_bf16 v[30:33], v[176:179], v[54:57], v[30:33]
 v_mul_f32 v68, v68, v12
 v_mul_f32_e64 v69, v69, v13
 v_mfma_f32_16x16x32_bf16 v[34:37], v[180:183], v[54:57], v[34:37]
 s_waitcnt lgkmcnt(1)
 v_mfma_f32_16x16x32_bf16 v[26:29], v[184:187], v[58:61], v[26:29]
 ds_read_b128 v[54:57], v132 offset:34624
 v_mfma_f32_16x16x32_bf16 v[30:33], v[188:191], v[58:61], v[30:33]
 v_exp_f32 v66, v66
 v_mfma_f32_16x16x32_bf16 v[34:37], v[192:195], v[58:61], v[34:37]
 v_exp_f32 v67, v67
 v_mfma_f32_16x16x32_bf16 v[26:29], v[196:199], v[62:65], v[26:29]
 ds_read_b128 v[58:61], v132 offset:34688
 v_add_f32 v66, 1.0, v66
 v_mfma_f32_16x16x32_bf16 v[30:33], v[200:203], v[62:65], v[30:33]
 v_exp_f32 v68, v68
 v_mfma_f32_16x16x32_bf16 v[34:37], v[204:207], v[62:65], v[34:37]
 v_add_f32 v67, 1.0, v67
 s_waitcnt lgkmcnt(1)
 v_mfma_f32_16x16x32_bf16 v[26:29], v[208:211], v[50:53], v[26:29]
 ds_read_b128 v[62:65], v132 offset:34752
 v_add_f32 v68, 1.0, v68
 v_mfma_f32_16x16x32_bf16 v[30:33], v[212:215], v[50:53], v[30:33]
 v_exp_f32 v69, v69
 v_mfma_f32_16x16x32_bf16 v[34:37], v[216:219], v[50:53], v[34:37]
 v_add_f32_e64 v69, 1.0, v69
 v_mfma_f32_16x16x32_bf16 v[26:29], v[220:223], v[54:57], v[26:29]
 ds_read_b128 v[50:53], v132 offset:50688
 buffer_load_dwordx4 v92, s[68:71], s20 offen offset:1024 lds
 v_mfma_f32_16x16x32_bf16 v[30:33], v[224:227], v[54:57], v[30:33]
 v_rcp_f32 v66, v66
 v_mfma_f32_16x16x32_bf16 v[34:37], v[228:231], v[54:57], v[34:37]
 v_mul_f32_e64 v66, v66, v10
 s_waitcnt lgkmcnt(1)
 v_mfma_f32_16x16x32_bf16 v[26:29], v[232:235], v[58:61], v[26:29]
 ds_read_b128 v[54:57], v132 offset:50752
 v_mfma_f32_16x16x32_bf16 v[30:33], v[236:239], v[58:61], v[30:33]
 v_rcp_f32 v67, v67
 v_mfma_f32_16x16x32_bf16 v[34:37], v[240:243], v[58:61], v[34:37]
 v_rcp_f32 v68, v68
 v_mfma_f32_16x16x32_bf16 v[26:29], v[244:247], v[62:65], v[26:29]
 ds_read_b128 v[58:61], v132 offset:50816
 v_mul_f32 v67, v67, v11
 v_mfma_f32_16x16x32_bf16 v[30:33], v[248:251], v[62:65], v[30:33]
 v_rcp_f32 v69, v69
 v_mfma_f32_16x16x32_bf16 v[34:37], v[252:255], v[62:65], v[34:37]
 v_mul_f32 v68, v68, v12
 v_mul_f32_e64 v69, v69, v13
 s_waitcnt lgkmcnt(1)
 v_mfma_f32_16x16x32_bf16 v[38:41], a[176:179], v[50:53], v[120:123]
 ds_read_b128 v[62:65], v132 offset:50880
 v_cvt_pk_bf16_f32 v66, v66, v67
 v_mfma_f32_16x16x32_bf16 v[42:45], a[180:183], v[50:53], v[124:127]
 v_cvt_pk_bf16_f32 v67, v68, v69
 ds_write_b64 v133, v[66:67] offset:64
 v_mfma_f32_16x16x32_bf16 v[46:49], a[184:187], v[50:53], v[128:131]
 v_mul_f32_e64 v70, v14, v14
 v_mul_f32_e64 v71, v15, v15
 v_mfma_f32_16x16x32_bf16 v[38:41], a[188:191], v[54:57], v[38:41]
 ds_read_b128 v[50:53], v132 offset:50944
 v_mul_f32_e64 v72, v16, v16
 v_mfma_f32_16x16x32_bf16 v[42:45], a[192:195], v[54:57], v[42:45]
 v_mul_f32 v73, v17, v17
 v_fma_f32 v70, v70, s100, v140
 v_mfma_f32_16x16x32_bf16 v[46:49], a[196:199], v[54:57], v[46:49]
 v_fma_f32 v71, v71, s100, v140
 s_waitcnt lgkmcnt(2)
 v_mfma_f32_16x16x32_bf16 v[38:41], a[200:203], v[58:61], v[38:41]
 ds_read_b128 v[54:57], v132 offset:51008
 buffer_load_dwordx4 v93, s[68:71], s20 offen offset:2048 lds
 v_mfma_f32_16x16x32_bf16 v[42:45], a[204:207], v[58:61], v[42:45]
 v_fma_f32 v72, v72, s100, v140
 v_fma_f32 v73, v73, s100, v140
 v_mfma_f32_16x16x32_bf16 v[46:49], a[208:211], v[58:61], v[46:49]
 v_mul_f32 v70, v70, v14
 v_mul_f32 v71, v71, v15
 v_mfma_f32_16x16x32_bf16 v[38:41], a[212:215], v[62:65], v[38:41]
 ds_read_b128 v[58:61], v132 offset:51072
 v_mul_f32_e64 v72, v72, v16
 v_mfma_f32_16x16x32_bf16 v[42:45], a[216:219], v[62:65], v[42:45]
 v_mul_f32 v73, v73, v17
 v_mfma_f32_16x16x32_bf16 v[46:49], a[220:223], v[62:65], v[46:49]
 s_waitcnt lgkmcnt(1)
 v_mfma_f32_16x16x32_bf16 v[38:41], a[224:227], v[50:53], v[38:41]
 ds_read_b128 v[62:65], v132 offset:51136
 v_mfma_f32_16x16x32_bf16 v[42:45], a[228:231], v[50:53], v[42:45]
 v_exp_f32 v70, v70
 v_mfma_f32_16x16x32_bf16 v[46:49], a[232:235], v[50:53], v[46:49]
 v_exp_f32 v71, v71
 v_mfma_f32_16x16x32_bf16 v[38:41], a[236:239], v[54:57], v[38:41]
 ds_read_b128 v[50:53], v132 offset:51200
 v_add_f32 v70, 1.0, v70
 v_mfma_f32_16x16x32_bf16 v[42:45], a[240:243], v[54:57], v[42:45]
 v_exp_f32 v72, v72
 v_mfma_f32_16x16x32_bf16 v[46:49], a[244:247], v[54:57], v[46:49]
 v_add_f32 v71, 1.0, v71
 s_waitcnt lgkmcnt(1)
 v_mfma_f32_16x16x32_bf16 v[38:41], a[248:251], v[58:61], v[38:41]
 ds_read_b128 v[54:57], v132 offset:51264
 v_add_f32_e64 v72, 1.0, v72
 v_mfma_f32_16x16x32_bf16 v[42:45], a[252:255], v[58:61], v[42:45]
 v_exp_f32 v73, v73
 v_mfma_f32_16x16x32_bf16 v[46:49], v[144:147], v[58:61], v[46:49]
 v_add_f32 v73, 1.0, v73
 v_mfma_f32_16x16x32_bf16 v[38:41], v[148:151], v[62:65], v[38:41]
 ds_read_b128 v[58:61], v132 offset:51328
 buffer_load_dwordx4 v94, s[68:71], s20 offen offset:3072 lds
 v_mfma_f32_16x16x32_bf16 v[42:45], v[152:155], v[62:65], v[42:45]
 v_rcp_f32_e64 v70, v70
 v_mfma_f32_16x16x32_bf16 v[46:49], v[156:159], v[62:65], v[46:49]
 v_mul_f32 v70, v70, v14
 s_waitcnt lgkmcnt(1)
 v_mfma_f32_16x16x32_bf16 v[38:41], v[160:163], v[50:53], v[38:41]
 ds_read_b128 v[62:65], v132 offset:51392
 v_mfma_f32_16x16x32_bf16 v[42:45], v[164:167], v[50:53], v[42:45]
 v_rcp_f32 v71, v71
 v_mfma_f32_16x16x32_bf16 v[46:49], v[168:171], v[50:53], v[46:49]
 v_rcp_f32 v72, v72
 v_mfma_f32_16x16x32_bf16 v[38:41], v[172:175], v[54:57], v[38:41]
 ds_read_b128 v[50:53], v132 offset:51456
 v_mul_f32_e64 v71, v71, v15
 v_mfma_f32_16x16x32_bf16 v[42:45], v[176:179], v[54:57], v[42:45]
 v_rcp_f32_e64 v73, v73
 v_mfma_f32_16x16x32_bf16 v[46:49], v[180:183], v[54:57], v[46:49]
 v_mul_f32 v72, v72, v16
 s_waitcnt lgkmcnt(1)
 v_mfma_f32_16x16x32_bf16 v[38:41], v[184:187], v[58:61], v[38:41]
 ds_read_b128 v[54:57], v132 offset:51520
 v_mul_f32_e64 v73, v73, v17
 v_mfma_f32_16x16x32_bf16 v[42:45], v[188:191], v[58:61], v[42:45]
 v_cvt_pk_bf16_f32 v70, v70, v71
 v_cvt_pk_bf16_f32 v71, v72, v73
 v_mfma_f32_16x16x32_bf16 v[46:49], v[192:195], v[58:61], v[46:49]
 ds_write_b64 v133, v[70:71] offset:6400
 v_mul_f32_e64 v66, v18, v18
 v_mfma_f32_16x16x32_bf16 v[38:41], v[196:199], v[62:65], v[38:41]
 ds_read_b128 v[58:61], v132 offset:51584
 v_mul_f32_e64 v67, v19, v19
 v_mfma_f32_16x16x32_bf16 v[42:45], v[200:203], v[62:65], v[42:45]
 v_mul_f32_e64 v68, v20, v20
 v_mul_f32 v69, v21, v21
 v_mfma_f32_16x16x32_bf16 v[46:49], v[204:207], v[62:65], v[46:49]
 v_fma_f32 v66, v66, s100, v140
 s_waitcnt lgkmcnt(2)
 v_mfma_f32_16x16x32_bf16 v[38:41], v[208:211], v[50:53], v[38:41]
 ds_read_b128 v[62:65], v132 offset:51648
 v_fma_f32 v67, v67, s100, v140
 v_mfma_f32_16x16x32_bf16 v[42:45], v[212:215], v[50:53], v[42:45]
 v_fma_f32 v68, v68, s100, v140
 v_fma_f32 v69, v69, s100, v140
 v_mfma_f32_16x16x32_bf16 v[46:49], v[216:219], v[50:53], v[46:49]
 v_mul_f32 v66, v66, v18
 v_mul_f32 v67, v67, v19
 v_mfma_f32_16x16x32_bf16 v[38:41], v[220:223], v[54:57], v[38:41]
 v_mul_f32 v68, v68, v20
 v_mul_f32 v69, v69, v21
 v_mfma_f32_16x16x32_bf16 v[42:45], v[224:227], v[54:57], v[42:45]
 v_exp_f32 v66, v66
 v_mfma_f32_16x16x32_bf16 v[46:49], v[228:231], v[54:57], v[46:49]
 v_add_f32 v66, 1.0, v66
 s_waitcnt lgkmcnt(0)
 v_mfma_f32_16x16x32_bf16 v[38:41], v[232:235], v[58:61], v[38:41]
 v_exp_f32 v67, v67
 v_mfma_f32_16x16x32_bf16 v[42:45], v[236:239], v[58:61], v[42:45]
 v_exp_f32_e64 v68, v68
 v_mfma_f32_16x16x32_bf16 v[46:49], v[240:243], v[58:61], v[46:49]
 v_exp_f32 v69, v69
 v_mfma_f32_16x16x32_bf16 v[38:41], v[244:247], v[62:65], v[38:41]
 v_add_f32 v67, 1.0, v67
 v_add_f32_e64 v68, 1.0, v68
 v_mfma_f32_16x16x32_bf16 v[42:45], v[248:251], v[62:65], v[42:45]
 v_add_f32 v69, 1.0, v69
 v_mfma_f32_16x16x32_bf16 v[46:49], v[252:255], v[62:65], v[46:49]
 v_rcp_f32 v66, v66
 v_rcp_f32 v67, v67
 v_rcp_f32 v68, v68
 v_rcp_f32 v69, v69
 v_mul_f32 v66, v66, v18
 v_mul_f32 v67, v67, v19
 v_mul_f32 v68, v68, v20
 v_mul_f32_e64 v69, v69, v21
 v_cvt_pk_bf16_f32 v66, v66, v67
 v_cvt_pk_bf16_f32 v67, v68, v69
 ds_write_b64 v133, v[66:67] offset:6432
 v_pk_mul_f32 v[70:71], v[22:23], v[22:23]
 v_pk_mul_f32 v[72:73], v[24:25], v[24:25]
 v_pk_fma_f32 v[70:71], v[70:71], s[100:101], v[140:141] op_sel_hi:[1,0,0]
 v_pk_fma_f32 v[72:73], v[72:73], s[100:101], v[140:141] op_sel_hi:[1,0,0]
 v_pk_mul_f32 v[70:71], v[70:71], v[22:23]
 v_pk_mul_f32 v[72:73], v[72:73], v[24:25]
 v_exp_f32 v70, v70
 v_exp_f32 v71, v71
 v_exp_f32 v72, v72
 v_exp_f32 v73, v73
 v_pk_add_f32 v[70:71], v[70:71], 1.0 op_sel_hi:[1,0]
 v_pk_add_f32 v[72:73], v[72:73], 1.0 op_sel_hi:[1,0]
 v_rcp_f32 v70, v70
 v_rcp_f32 v71, v71
 v_rcp_f32_e64 v72, v72
 v_rcp_f32_e64 v73, v73
 v_pk_mul_f32 v[70:71], v[70:71], v[22:23]
 v_pk_mul_f32 v[72:73], v[72:73], v[24:25]
 v_cvt_pk_bf16_f32 v70, v70, v71
 v_cvt_pk_bf16_f32 v71, v72, v73
 ds_write_b64 v133, v[70:71] offset:6464
 s_waitcnt lgkmcnt(0)
 s_barrier
 s_mov_b32 s88, s79
 s_add_u32 s89, s79, 0x1000
 v_mov_b32 v82, -1
 v_mov_b32_e64 v83, -1
 v_mov_b32_e64 v84, -1
 v_mov_b32_e64 v85, -1
 s_add_u32 s14, s76, 0x2000
 s_add_u32 s15, s76, 0x3000
 s_add_u32 m0, s1, 0
 s_nop 0
 buffer_load_dwordx4 v91, s[68:71], s21 offen offset:0 lds
 v_pk_mul_f32 v[66:67], v[26:27], v[26:27]
 buffer_load_dwordx4 v92, s[68:71], s21 offen offset:1024 lds
 v_pk_mul_f32 v[70:71], v[30:31], v[30:31]
 buffer_load_dwordx4 v93, s[68:71], s21 offen offset:2048 lds
 v_pk_mul_f32 v[68:69], v[28:29], v[28:29]
 buffer_load_dwordx4 v94, s[68:71], s21 offen offset:3072 lds
 v_pk_mul_f32 v[72:73], v[32:33], v[32:33]
 s_waitcnt vmcnt(12)
 ds_read_b64_tr_b16 a[128:129], v96 offset:0
 ds_read_b64_tr_b16 a[130:131], v96 offset:1024
 ds_read_b64_tr_b16 a[132:133], v97 offset:0
 ds_read_b64_tr_b16 a[134:135], v97 offset:1024
 ds_read_b64_tr_b16 a[136:137], v98 offset:0
 ds_read_b64_tr_b16 a[138:139], v98 offset:1024
 ds_read_b64_tr_b16 a[140:141], v99 offset:0
 ds_read_b64_tr_b16 a[142:143], v99 offset:1024
 s_add_u32 m0, s1, 4096
 s_nop 0
 buffer_load_dwordx4 v91, s[68:71], s24 offen offset:0 lds
 buffer_store_dwordx4 v[82:85], v139, s[60:63], s14 offen sc0 sc1
 v_pk_fma_f32 v[66:67], v[66:67], s[100:101], v[140:141] op_sel_hi:[1,0,0]
 buffer_load_dwordx4 v92, s[68:71], s24 offen offset:1024 lds
 v_pk_fma_f32 v[70:71], v[70:71], s[100:101], v[140:141] op_sel_hi:[1,0,0]
 buffer_load_dwordx4 v93, s[68:71], s24 offen offset:2048 lds
 v_pk_fma_f32 v[68:69], v[68:69], s[100:101], v[140:141] op_sel_hi:[1,0,0]
 buffer_load_dwordx4 v94, s[68:71], s24 offen offset:3072 lds
 v_pk_fma_f32 v[72:73], v[72:73], s[100:101], v[140:141] op_sel_hi:[1,0,0]
 s_waitcnt vmcnt(13)
 ds_read_b64_tr_b16 a[144:145], v96 offset:4096
 ds_read_b64_tr_b16 a[146:147], v96 offset:5120
 ds_read_b64_tr_b16 a[148:149], v97 offset:4096
 ds_read_b64_tr_b16 a[150:151], v97 offset:5120
 ds_read_b64_tr_b16 a[152:153], v98 offset:4096
 ds_read_b64_tr_b16 a[154:155], v98 offset:5120
 ds_read_b64_tr_b16 a[156:157], v99 offset:4096
 ds_read_b64_tr_b16 a[158:159], v99 offset:5120
 s_add_u32 m0, s1, 8192
 s_nop 0
 buffer_load_dwordx4 v91, s[68:71], s17 offen offset:0 lds
 v_pk_mul_f32 v[66:67], v[66:67], v[26:27]
 buffer_load_dwordx4 v92, s[68:71], s17 offen offset:1024 lds
 v_pk_mul_f32 v[70:71], v[70:71], v[30:31]
 v_pk_mul_f32 v[68:69], v[68:69], v[28:29]
 buffer_load_dwordx4 v93, s[68:71], s17 offen offset:2048 lds
 v_pk_mul_f32 v[72:73], v[72:73], v[32:33]
 buffer_load_dwordx4 v94, s[68:71], s17 offen offset:3072 lds
 s_add_u32 m0, s1, 12288
 v_exp_f32_e64 v66, v66
 buffer_load_dwordx4 v91, s[68:71], s16 offen offset:0 lds
 v_exp_f32_e64 v70, v70
 buffer_load_dwordx4 v92, s[68:71], s16 offen offset:1024 lds
 v_exp_f32_e64 v67, v67
 buffer_load_dwordx4 v93, s[68:71], s16 offen offset:2048 lds
 v_exp_f32_e64 v71, v71
 v_exp_f32_e64 v68, v68
 buffer_load_dwordx4 v94, s[68:71], s16 offen offset:3072 lds
 v_exp_f32 v72, v72
 s_waitcnt lgkmcnt(0)
 s_add_u32 m0, s84, 0
 s_nop 0
 buffer_load_dwordx4 v91, s[68:71], s22 offen offset:0 lds
 v_exp_f32_e64 v69, v69
 buffer_load_dwordx4 v92, s[68:71], s22 offen offset:1024 lds
 v_exp_f32 v73, v73
 buffer_load_dwordx4 v93, s[68:71], s22 offen offset:2048 lds
 v_pk_add_f32 v[66:67], v[66:67], 1.0 op_sel_hi:[1,0]
 v_pk_add_f32 v[70:71], v[70:71], 1.0 op_sel_hi:[1,0]
 buffer_load_dwordx4 v94, s[68:71], s22 offen offset:3072 lds
 v_pk_add_f32 v[68:69], v[68:69], 1.0 op_sel_hi:[1,0]
 s_waitcnt vmcnt(21)
 ds_read_b64_tr_b16 a[160:161], v96 offset:8192
 ds_read_b64_tr_b16 a[162:163], v96 offset:9216
 ds_read_b64_tr_b16 a[164:165], v97 offset:8192
 ds_read_b64_tr_b16 a[166:167], v97 offset:9216
 ds_read_b64_tr_b16 a[168:169], v98 offset:8192
 ds_read_b64_tr_b16 a[170:171], v98 offset:9216
 ds_read_b64_tr_b16 a[172:173], v99 offset:8192
 ds_read_b64_tr_b16 a[174:175], v99 offset:9216
 s_add_u32 m0, s84, 4096
 s_nop 0
 buffer_load_dwordx4 v91, s[68:71], s23 offen offset:0 lds
 v_pk_add_f32 v[72:73], v[72:73], 1.0 op_sel_hi:[1,0]
 buffer_load_dwordx4 v92, s[68:71], s23 offen offset:1024 lds
 v_rcp_f32 v66, v66
 buffer_load_dwordx4 v93, s[68:71], s23 offen offset:2048 lds
 v_rcp_f32 v70, v70
 buffer_load_dwordx4 v94, s[68:71], s23 offen offset:3072 lds
 s_sub_u32 s94, s1, s84
 v_rcp_f32 v67, v67
 v_rcp_f32 v71, v71
 v_add_u32 v76, s94, v96
 v_add_u32_e64 v77, s94, v97
 v_add_u32_e64 v78, s94, v98
 v_add_u32_e64 v79, s94, v99
 s_waitcnt vmcnt(21)
 ds_read_b64_tr_b16 a[0:1], v76 offset:0
 ds_read_b64_tr_b16 a[2:3], v76 offset:1024
 ds_read_b64_tr_b16 a[32:33], v77 offset:0
 ds_read_b64_tr_b16 a[34:35], v77 offset:1024
 ds_read_b64_tr_b16 a[64:65], v78 offset:0
 ds_read_b64_tr_b16 a[66:67], v78 offset:1024
 ds_read_b64_tr_b16 a[96:97], v79 offset:0
 ds_read_b64_tr_b16 a[98:99], v79 offset:1024
 s_waitcnt lgkmcnt(0)
 s_add_u32 m0, s84, 8192
 s_nop 0
 buffer_load_dwordx4 v91, s[68:71], s25 offen offset:0 lds
 v_rcp_f32_e64 v68, v68
 buffer_load_dwordx4 v92, s[68:71], s25 offen offset:1024 lds
 v_rcp_f32 v72, v72
 buffer_load_dwordx4 v93, s[68:71], s25 offen offset:2048 lds
 v_rcp_f32 v69, v69
 buffer_load_dwordx4 v94, s[68:71], s25 offen offset:3072 lds
 s_sub_u32 s94, s1, s84
 v_rcp_f32 v73, v73
 v_add_u32 v76, s94, v96
 v_add_u32 v77, s94, v97
 v_add_u32 v78, s94, v98
 v_add_u32_e64 v79, s94, v99
 s_waitcnt vmcnt(20)
 ds_read_b64_tr_b16 a[12:13], v76 offset:4096
 ds_read_b64_tr_b16 a[14:15], v76 offset:5120
 ds_read_b64_tr_b16 a[44:45], v77 offset:4096
 ds_read_b64_tr_b16 a[46:47], v77 offset:5120
 ds_read_b64_tr_b16 a[76:77], v78 offset:4096
 ds_read_b64_tr_b16 a[78:79], v78 offset:5120
 ds_read_b64_tr_b16 a[108:109], v79 offset:4096
 ds_read_b64_tr_b16 a[110:111], v79 offset:5120
 s_add_u32 m0, s1, 0
 s_nop 0
 buffer_load_dwordx4 v91, s[68:71], s30 offen offset:0 lds
 v_pk_mul_f32 v[66:67], v[66:67], v[26:27]
 v_pk_mul_f32 v[70:71], v[70:71], v[30:31]
 buffer_load_dwordx4 v92, s[68:71], s30 offen offset:1024 lds
 v_pk_mul_f32 v[68:69], v[68:69], v[28:29]
 buffer_load_dwordx4 v93, s[68:71], s30 offen offset:2048 lds
 v_pk_mul_f32 v[72:73], v[72:73], v[32:33]
 buffer_load_dwordx4 v94, s[68:71], s30 offen offset:3072 lds
 s_sub_u32 s94, s1, s84
 v_cvt_pk_bf16_f32 v66, v66, v67
 v_add_u32 v76, s94, v96
 v_add_u32 v77, s94, v97
 v_add_u32 v78, s94, v98
 v_add_u32 v79, s94, v99
 s_waitcnt vmcnt(20)
 ds_read_b64_tr_b16 a[24:25], v76 offset:8192
 ds_read_b64_tr_b16 a[26:27], v76 offset:9216
 ds_read_b64_tr_b16 a[56:57], v77 offset:8192
 ds_read_b64_tr_b16 a[58:59], v77 offset:9216
 ds_read_b64_tr_b16 a[88:89], v78 offset:8192
 ds_read_b64_tr_b16 a[90:91], v78 offset:9216
 ds_read_b64_tr_b16 a[120:121], v79 offset:8192
 ds_read_b64_tr_b16 a[122:123], v79 offset:9216
 s_sub_u32 s94, s1, s84
 v_add_u32 v76, s94, v96
 v_add_u32 v77, s94, v97
 v_add_u32 v78, s94, v98
 v_add_u32 v79, s94, v99
 s_waitcnt vmcnt(16)
 ds_read_b64_tr_b16 a[20:21], v76 offset:12288
 ds_read_b64_tr_b16 a[22:23], v76 offset:13312
 ds_read_b64_tr_b16 a[52:53], v77 offset:12288
 ds_read_b64_tr_b16 a[54:55], v77 offset:13312
 ds_read_b64_tr_b16 a[84:85], v78 offset:12288
 ds_read_b64_tr_b16 a[86:87], v78 offset:13312
 ds_read_b64_tr_b16 a[116:117], v79 offset:12288
 ds_read_b64_tr_b16 a[118:119], v79 offset:13312
 v_cvt_pk_bf16_f32 v70, v70, v71
 v_cvt_pk_bf16_f32 v67, v68, v69
 v_bfe_u32 v86, v1, 3, 2
 v_lshlrev_b32 v86, 13, v86
 v_and_b32 v87, 7, v1
 v_lshl_add_u32 v86, v87, 7, v86
 v_and_b32 v87, 3, v1
 v_lshlrev_b32 v87, 9, v87
 buffer_load_dword v0, v87, s[60:63], s82 offen sc1
 s_add_u32 s14, s80, 4096
 buffer_load_dword v0, v86, s[60:63], s14 offen sc1
 v_cvt_pk_bf16_f32 v71, v72, v73
 buffer_store_dwordx4 v[82:85], v139, s[60:63], s15 offen sc0 sc1
 ds_write_b64 v133, v[66:67] offset:12800
 ds_write_b64 v133, v[70:71] offset:12832
 v_pk_mul_f32 v[66:67], v[34:35], v[34:35]
 v_pk_mul_f32 v[70:71], v[38:39], v[38:39]
 v_pk_mul_f32 v[68:69], v[36:37], v[36:37]
 v_pk_mul_f32 v[72:73], v[40:41], v[40:41]
 v_pk_fma_f32 v[66:67], v[66:67], s[100:101], v[140:141] op_sel_hi:[1,0,0]
 v_pk_fma_f32 v[70:71], v[70:71], s[100:101], v[140:141] op_sel_hi:[1,0,0]
 v_pk_fma_f32 v[68:69], v[68:69], s[100:101], v[140:141] op_sel_hi:[1,0,0]
 v_pk_fma_f32 v[72:73], v[72:73], s[100:101], v[140:141] op_sel_hi:[1,0,0]
 v_pk_mul_f32 v[66:67], v[66:67], v[34:35]
 v_pk_mul_f32 v[70:71], v[70:71], v[38:39]
 v_pk_mul_f32 v[68:69], v[68:69], v[36:37]
 v_pk_mul_f32 v[72:73], v[72:73], v[40:41]
 v_exp_f32 v66, v66
 v_exp_f32 v70, v70
 v_exp_f32 v67, v67
 v_exp_f32 v71, v71
 v_exp_f32 v68, v68
 v_exp_f32 v72, v72
 v_exp_f32 v69, v69
 v_exp_f32 v73, v73
 v_pk_add_f32 v[66:67], v[66:67], 1.0 op_sel_hi:[1,0]
 v_pk_add_f32 v[70:71], v[70:71], 1.0 op_sel_hi:[1,0]
 v_pk_add_f32 v[68:69], v[68:69], 1.0 op_sel_hi:[1,0]
 v_pk_add_f32 v[72:73], v[72:73], 1.0 op_sel_hi:[1,0]
 v_rcp_f32 v66, v66
 v_rcp_f32 v70, v70
 v_rcp_f32 v67, v67
 v_rcp_f32 v71, v71
 v_rcp_f32 v68, v68
 v_rcp_f32 v72, v72
 v_rcp_f32 v69, v69
 v_rcp_f32 v73, v73
 v_pk_mul_f32 v[66:67], v[66:67], v[34:35]
 v_pk_mul_f32 v[70:71], v[70:71], v[38:39]
 v_pk_mul_f32 v[68:69], v[68:69], v[36:37]
 v_pk_mul_f32 v[72:73], v[72:73], v[40:41]
 v_cvt_pk_bf16_f32 v66, v66, v67
 v_cvt_pk_bf16_f32 v70, v70, v71
 v_cvt_pk_bf16_f32 v67, v68, v69
 v_cvt_pk_bf16_f32 v71, v72, v73
 ds_write_b64 v133, v[66:67] offset:12864
 ds_write_b64 v133, v[70:71] offset:19200
 s_waitcnt vmcnt(15)
 ds_read_b64_tr_b16 a[4:5], v96 offset:0
 ds_read_b64_tr_b16 a[6:7], v96 offset:1024
 ds_read_b64_tr_b16 a[36:37], v97 offset:0
 ds_read_b64_tr_b16 a[38:39], v97 offset:1024
 ds_read_b64_tr_b16 a[68:69], v98 offset:0
 ds_read_b64_tr_b16 a[70:71], v98 offset:1024
 ds_read_b64_tr_b16 a[100:101], v99 offset:0
 ds_read_b64_tr_b16 a[102:103], v99 offset:1024
 s_waitcnt vmcnt(11)
 ds_read_b64_tr_b16 a[8:9], v96 offset:4096
 ds_read_b64_tr_b16 a[10:11], v96 offset:5120
 ds_read_b64_tr_b16 a[40:41], v97 offset:4096
 ds_read_b64_tr_b16 a[42:43], v97 offset:5120
 ds_read_b64_tr_b16 a[72:73], v98 offset:4096
 ds_read_b64_tr_b16 a[74:75], v98 offset:5120
 ds_read_b64_tr_b16 a[104:105], v99 offset:4096
 ds_read_b64_tr_b16 a[106:107], v99 offset:5120
 s_waitcnt vmcnt(7)
 ds_read_b64_tr_b16 a[16:17], v96 offset:8192
 ds_read_b64_tr_b16 a[18:19], v96 offset:9216
 ds_read_b64_tr_b16 a[48:49], v97 offset:8192
 ds_read_b64_tr_b16 a[50:51], v97 offset:9216
 ds_read_b64_tr_b16 a[80:81], v98 offset:8192
 ds_read_b64_tr_b16 a[82:83], v98 offset:9216
 ds_read_b64_tr_b16 a[112:113], v99 offset:8192
 ds_read_b64_tr_b16 a[114:115], v99 offset:9216
 s_sub_u32 s94, s1, s84
 v_add_u32 v76, s94, v96
 v_add_u32 v77, s94, v97
 v_add_u32 v78, s94, v98
 v_add_u32_e64 v79, s94, v99
 s_waitcnt vmcnt(3)
 ds_read_b64_tr_b16 a[28:29], v76 offset:0
 ds_read_b64_tr_b16 a[30:31], v76 offset:1024
 ds_read_b64_tr_b16 a[60:61], v77 offset:0
 ds_read_b64_tr_b16 a[62:63], v77 offset:1024
 ds_read_b64_tr_b16 a[92:93], v78 offset:0
 ds_read_b64_tr_b16 a[94:95], v78 offset:1024
 ds_read_b64_tr_b16 a[124:125], v79 offset:0
 ds_read_b64_tr_b16 a[126:127], v79 offset:1024
 s_waitcnt lgkmcnt(0)
 ds_read_b128 v[74:77], v134 offset:0
 ds_read_b128 v[78:81], v134 offset:32
 ds_read_b128 v[82:85], v134 offset:64
 ds_read_b128 v[88:91], v134 offset:96
 ds_read_b128 v[92:95], v134 offset:128
 v_mul_f32 v66, v42, v42
 v_mul_f32 v67, v43, v43
 v_mul_f32 v68, v44, v44
 v_mul_f32_e64 v69, v45, v45
 v_fma_f32 v66, v66, s100, v140
 v_fma_f32 v67, v67, s100, v140
 v_fma_f32 v68, v68, s100, v140
 v_fma_f32 v69, v69, s100, v140
 v_mul_f32 v66, v66, v42
 v_mul_f32 v67, v67, v43
 v_mul_f32 v68, v68, v44
 v_mul_f32 v69, v69, v45
 v_exp_f32 v66, v66
 v_exp_f32 v67, v67
 v_exp_f32 v68, v68
 v_exp_f32 v69, v69
 s_waitcnt lgkmcnt(3)
 v_mfma_f32_32x32x16_bf16 v[2:17], a[128:131], v[74:77], 0
 ds_read_b128 v[96:99], v134 offset:160
 v_add_f32 v66, 1.0, v66
 v_add_f32 v67, 1.0, v67
 v_add_f32 v68, 1.0, v68
 v_add_f32 v69, 1.0, v69
 v_mfma_f32_32x32x16_bf16 v[2:17], a[144:147], v[78:81], v[2:17]
 ds_read_b128 v[74:77], v134 offset:192
 v_rcp_f32 v66, v66
 v_rcp_f32 v67, v67
 s_waitcnt lgkmcnt(3)
 v_mfma_f32_32x32x16_bf16 v[2:17], a[160:163], v[82:85], v[2:17]
 ds_read_b128 v[78:81], v134 offset:224
 v_rcp_f32 v68, v68
 v_rcp_f32 v69, v69
 v_mul_f32_e64 v66, v66, v42
 v_mfma_f32_32x32x16_bf16 v[2:17], a[0:3], v[88:91], v[2:17]
 ds_read_b128 v[82:85], v134 offset:256
 v_mul_f32_e64 v67, v67, v43
 v_mul_f32_e64 v68, v68, v44
 v_mul_f32 v69, v69, v45
 v_cvt_pk_bf16_f32 v66, v66, v67
 s_waitcnt lgkmcnt(3)
 v_mfma_f32_32x32x16_bf16 v[2:17], a[4:7], v[92:95], v[2:17]
 ds_read_b128 v[88:91], v134 offset:288
 s_add_u32 s14, s80, 36864
 buffer_load_dword v0, v86, s[60:63], s14 offen sc1
 v_cvt_pk_bf16_f32 v67, v68, v69
 ds_write_b64 v133, v[66:67] offset:19232
 v_mul_f32 v70, v46, v46
 v_mfma_f32_32x32x16_bf16 v[2:17], a[8:11], v[96:99], v[2:17]
 ds_read_b128 v[92:95], v134 offset:320
 v_mul_f32 v71, v47, v47
 v_mul_f32_e64 v72, v48, v48
 v_mul_f32 v73, v49, v49
 v_fma_f32 v70, v70, s100, v140
 s_waitcnt lgkmcnt(4)
 v_mfma_f32_32x32x16_bf16 v[2:17], a[12:15], v[74:77], v[2:17]
 ds_read_b128 v[96:99], v134 offset:0
 v_fma_f32 v71, v71, s100, v140
 v_fma_f32 v72, v72, s100, v140
 v_fma_f32 v73, v73, s100, v140
 v_mul_f32 v70, v70, v46
 v_mul_f32 v71, v71, v47
 v_mfma_f32_32x32x16_bf16 v[2:17], a[16:19], v[78:81], v[2:17]
 ds_read_b128 v[74:77], v134 offset:32
 v_mul_f32 v72, v72, v48
 v_mul_f32 v73, v73, v49
 v_exp_f32 v70, v70
 s_waitcnt lgkmcnt(4)
 v_mfma_f32_32x32x16_bf16 v[2:17], a[20:23], v[82:85], v[2:17]
 ds_read_b128 v[78:81], v134 offset:64
 v_exp_f32 v71, v71
 v_exp_f32 v72, v72
 v_add_f32_e64 v70, 1.0, v70
 v_mfma_f32_32x32x16_bf16 v[2:17], a[24:27], v[88:91], v[2:17]
 ds_read_b128 v[82:85], v134 offset:96
 v_exp_f32 v73, v73
 v_add_f32 v71, 1.0, v71
 v_add_f32 v72, 1.0, v72
 s_waitcnt lgkmcnt(3)
 v_mfma_f32_32x32x16_bf16 v[2:17], a[28:31], v[92:95], v[2:17]
 ds_read_b128 v[88:91], v134 offset:128
 v_add_f32 v73, 1.0, v73
 v_rcp_f32 v70, v70
 v_rcp_f32_e64 v71, v71
 v_mfma_f32_32x32x16_bf16 v[50:65], a[132:135], v[96:99], 0
 ds_read_b128 v[92:95], v134 offset:160
 v_rcp_f32 v72, v72
 v_rcp_f32_e64 v73, v73
 s_waitcnt lgkmcnt(3)
 v_mfma_f32_32x32x16_bf16 v[50:65], a[148:151], v[74:77], v[50:65]
 ds_read_b128 v[96:99], v134 offset:192
 v_mul_f32 v70, v70, v46
 v_mul_f32 v71, v71, v47
 v_mul_f32_e64 v72, v72, v48
 v_mul_f32 v73, v73, v49
 v_cvt_pk_bf16_f32 v70, v70, v71
 v_mfma_f32_32x32x16_bf16 v[50:65], a[164:167], v[78:81], v[50:65]
 ds_read_b128 v[74:77], v134 offset:224
 v_cvt_pk_bf16_f32 v18, v2, v3
 v_cvt_pk_bf16_f32 v19, v4, v5
 v_cvt_pk_bf16_f32 v20, v6, v7
 v_cvt_pk_bf16_f32 v21, v8, v9
 s_waitcnt lgkmcnt(3)
 v_mfma_f32_32x32x16_bf16 v[50:65], a[32:35], v[82:85], v[50:65]
 ds_read_b128 v[78:81], v134 offset:256
 v_permlane32_swap_b32 v18, v20
 v_permlane32_swap_b32 v19, v21
 v_cvt_pk_bf16_f32 v71, v72, v73
 v_mfma_f32_32x32x16_bf16 v[50:65], a[36:39], v[88:91], v[50:65]
 ds_read_b128 v[82:85], v134 offset:288
 ds_write_b64 v133, v[70:71] offset:19264
 s_waitcnt lgkmcnt(4)
 v_mfma_f32_32x32x16_bf16 v[50:65], a[40:43], v[92:95], v[50:65]
 ds_read_b128 v[88:91], v134 offset:320
 buffer_store_dwordx4 v[18:21], v135, s[60:63], s88 offen offset:0 sc0 sc1
 v_mfma_f32_32x32x16_bf16 v[50:65], a[44:47], v[96:99], v[50:65]
 ds_read_b128 v[92:95], v134 offset:0
 s_waitcnt lgkmcnt(4)
 v_mfma_f32_32x32x16_bf16 v[50:65], a[48:51], v[74:77], v[50:65]
 ds_read_b128 v[96:99], v134 offset:32
 v_cvt_pk_bf16_f32 v22, v10, v11
 v_cvt_pk_bf16_f32 v23, v12, v13
 v_cvt_pk_bf16_f32 v24, v14, v15
 v_cvt_pk_bf16_f32 v25, v16, v17
 v_mfma_f32_32x32x16_bf16 v[50:65], a[52:55], v[78:81], v[50:65]
 ds_read_b128 v[74:77], v134 offset:64
 v_permlane32_swap_b32 v22, v24
 v_permlane32_swap_b32 v23, v25
 s_waitcnt lgkmcnt(3)
 v_mfma_f32_32x32x16_bf16 v[50:65], a[56:59], v[82:85], v[50:65]
 ds_read_b128 v[78:81], v134 offset:96
 v_mfma_f32_32x32x16_bf16 v[50:65], a[60:63], v[88:91], v[50:65]
 ds_read_b128 v[82:85], v134 offset:128
 buffer_store_dwordx4 v[22:25], v135, s[60:63], s88 offen offset:128 sc0 sc1
 s_waitcnt lgkmcnt(3)
 v_mfma_f32_32x32x16_bf16 v[2:17], a[136:139], v[92:95], 0
 ds_read_b128 v[88:91], v134 offset:160
 v_mfma_f32_32x32x16_bf16 v[2:17], a[152:155], v[96:99], v[2:17]
 ds_read_b128 v[92:95], v134 offset:192
 s_waitcnt lgkmcnt(3)
 v_mfma_f32_32x32x16_bf16 v[2:17], a[168:171], v[74:77], v[2:17]
 ds_read_b128 v[96:99], v134 offset:224
 s_nop 1
 v_cvt_pk_bf16_f32 v18, v50, v51
 v_cvt_pk_bf16_f32 v19, v52, v53
 v_cvt_pk_bf16_f32 v20, v54, v55
 v_cvt_pk_bf16_f32 v21, v56, v57
 v_mfma_f32_32x32x16_bf16 v[2:17], a[64:67], v[78:81], v[2:17]
 ds_read_b128 v[74:77], v134 offset:256
 v_permlane32_swap_b32 v18, v20
 v_permlane32_swap_b32 v19, v21
 s_waitcnt lgkmcnt(3)
 v_mfma_f32_32x32x16_bf16 v[2:17], a[68:71], v[82:85], v[2:17]
 ds_read_b128 v[78:81], v134 offset:288
 v_mfma_f32_32x32x16_bf16 v[2:17], a[72:75], v[88:91], v[2:17]
 ds_read_b128 v[82:85], v134 offset:320
 buffer_store_dwordx4 v[18:21], v135, s[60:63], s88 offen offset:256 sc0 sc1
 s_waitcnt lgkmcnt(3)
 v_mfma_f32_32x32x16_bf16 v[2:17], a[76:79], v[92:95], v[2:17]
 ds_read_b128 v[88:91], v134 offset:0
 v_mfma_f32_32x32x16_bf16 v[2:17], a[80:83], v[96:99], v[2:17]
 ds_read_b128 v[92:95], v134 offset:32
 v_cvt_pk_bf16_f32 v22, v58, v59
 v_cvt_pk_bf16_f32 v23, v60, v61
 v_cvt_pk_bf16_f32 v24, v62, v63
 v_cvt_pk_bf16_f32 v25, v64, v65
 s_waitcnt lgkmcnt(3)
 v_mfma_f32_32x32x16_bf16 v[2:17], a[84:87], v[74:77], v[2:17]
 ds_read_b128 v[96:99], v134 offset:64
 v_permlane32_swap_b32 v22, v24
 v_permlane32_swap_b32 v23, v25
 v_mfma_f32_32x32x16_bf16 v[2:17], a[88:91], v[78:81], v[2:17]
 ds_read_b128 v[74:77], v134 offset:96
 s_waitcnt lgkmcnt(3)
 v_mfma_f32_32x32x16_bf16 v[2:17], a[92:95], v[82:85], v[2:17]
 ds_read_b128 v[78:81], v134 offset:128
 buffer_store_dwordx4 v[22:25], v135, s[60:63], s88 offen offset:384 sc0 sc1
 v_mfma_f32_32x32x16_bf16 v[50:65], a[140:143], v[88:91], 0
 ds_read_b128 v[82:85], v134 offset:160
 s_waitcnt lgkmcnt(3)
 v_mfma_f32_32x32x16_bf16 v[50:65], a[156:159], v[92:95], v[50:65]
 ds_read_b128 v[88:91], v134 offset:192
 v_bfe_u32 v87, v1, 3, 1
 v_lshlrev_b32 v87, 5, v87
 v_and_or_b32 v87, v1, 7, v87
 v_lshlrev_b32_e64 v87, 7, v87
 s_add_u32 s12, s76, 8192
 buffer_load_dword v0, v87, s[60:63], s12 offen sc1
 v_mfma_f32_32x32x16_bf16 v[50:65], a[172:175], v[96:99], v[50:65]
 ds_read_b128 v[92:95], v134 offset:224
 v_cvt_pk_bf16_f32 v18, v2, v3
 v_cvt_pk_bf16_f32 v19, v4, v5
 v_cvt_pk_bf16_f32 v20, v6, v7
 v_cvt_pk_bf16_f32 v21, v8, v9
 s_waitcnt lgkmcnt(3)
 v_mfma_f32_32x32x16_bf16 v[50:65], a[96:99], v[74:77], v[50:65]
 ds_read_b128 v[96:99], v134 offset:256
 v_permlane32_swap_b32 v18, v20
 v_permlane32_swap_b32 v19, v21
 v_mfma_f32_32x32x16_bf16 v[50:65], a[100:103], v[78:81], v[50:65]
 ds_read_b128 v[74:77], v134 offset:288
 s_waitcnt lgkmcnt(3)
 v_mfma_f32_32x32x16_bf16 v[50:65], a[104:107], v[82:85], v[50:65]
 ds_read_b128 v[78:81], v134 offset:320
 buffer_store_dwordx4 v[18:21], v135, s[60:63], s88 offen offset:512 sc0 sc1
 v_mfma_f32_32x32x16_bf16 v[50:65], a[108:111], v[88:91], v[50:65]
 s_lshl_b32 s12, s5, 2
 s_add_u32 s12, s12, s3
 s_lshl_b32 s12, s12, 9
 v_lshrrev_b32 v87, 4, v1
 v_lshl_add_u32 v87, v87, 7, s12
 v_min_u32 v87, Lslow-Lpc, v87
 global_load_dword v0, v87, s[28:29]
 s_waitcnt lgkmcnt(2)
 v_mfma_f32_32x32x16_bf16 v[50:65], a[112:115], v[92:95], v[50:65]
 v_cvt_pk_bf16_f32 v22, v10, v11
 v_cvt_pk_bf16_f32 v23, v12, v13
 v_cvt_pk_bf16_f32 v24, v14, v15
 v_cvt_pk_bf16_f32 v25, v16, v17
 v_mfma_f32_32x32x16_bf16 v[50:65], a[116:119], v[96:99], v[50:65]
 v_permlane32_swap_b32 v22, v24
 v_permlane32_swap_b32 v23, v25
 s_waitcnt lgkmcnt(0)
 v_mfma_f32_32x32x16_bf16 v[50:65], a[120:123], v[74:77], v[50:65]
 v_mfma_f32_32x32x16_bf16 v[50:65], a[124:127], v[78:81], v[50:65]
 buffer_store_dwordx4 v[22:25], v135, s[60:63], s88 offen offset:640 sc0 sc1
 s_waitcnt lgkmcnt(0)
 s_barrier
 ds_read_b128 v[74:77], v134 offset:12800
 ds_read_b128 v[78:81], v134 offset:12832
 ds_read_b128 v[82:85], v134 offset:12864
 ds_read_b128 v[26:29], v134 offset:12896
 ds_read_b128 v[30:33], v134 offset:12928
 s_waitcnt lgkmcnt(3)
 v_mfma_f32_32x32x16_bf16 v[2:17], a[128:131], v[74:77], 0
 ds_read_b128 v[34:37], v134 offset:12960
 s_nop 0
 v_cvt_pk_bf16_f32 v18, v50, v51
 v_cvt_pk_bf16_f32 v19, v52, v53
 v_cvt_pk_bf16_f32 v20, v54, v55
 v_cvt_pk_bf16_f32 v21, v56, v57
 v_and_b32 v38, 15, v1
 v_mfma_f32_32x32x16_bf16 v[2:17], a[144:147], v[78:81], v[2:17]
 ds_read_b128 v[74:77], v134 offset:12992
 v_permlane32_swap_b32 v18, v20
 v_permlane32_swap_b32 v19, v21
 s_waitcnt lgkmcnt(3)
 v_mfma_f32_32x32x16_bf16 v[2:17], a[160:163], v[82:85], v[2:17]
 ds_read_b128 v[78:81], v134 offset:13024
 v_and_b32_e64 v39, 1, v1
 v_lshlrev_b32_e64 v39, 4, v39
 v_mov_b32 v40, 0x3f80
 v_lshlrev_b32_e64 v39, v39, v40
 v_lshrrev_b32_e64 v38, 1, v38
 v_mfma_f32_32x32x16_bf16 v[2:17], a[0:3], v[26:29], v[2:17]
 ds_read_b128 v[82:85], v134 offset:13056
 buffer_store_dwordx4 v[18:21], v135, s[60:63], s88 offen offset:768 sc0 sc1
 v_cmp_eq_u32 vcc, 0, v38
 v_cmp_eq_u32 s[92:93], 1, v38
 v_mov_b32 v41, 0
 s_waitcnt lgkmcnt(3)
 v_mfma_f32_32x32x16_bf16 v[2:17], a[4:7], v[30:33], v[2:17]
 ds_read_b128 v[26:29], v134 offset:13088
 v_cndmask_b32 v88, 0, v39, vcc
 v_cndmask_b32 v89, 0, v39, s[92:93]
 v_cmp_eq_u32 vcc, 2, v38
 v_cmp_eq_u32 s[92:93], 3, v38
 v_mov_b32_e64 v41, 0
 v_mfma_f32_32x32x16_bf16 v[2:17], a[8:11], v[34:37], v[2:17]
 ds_read_b128 v[30:33], v134 offset:13120
 v_cvt_pk_bf16_f32 v22, v58, v59
 v_cvt_pk_bf16_f32 v23, v60, v61
 v_cvt_pk_bf16_f32 v24, v62, v63
 v_cvt_pk_bf16_f32 v25, v64, v65
 s_waitcnt lgkmcnt(3)
 v_mfma_f32_32x32x16_bf16 v[2:17], a[12:15], v[74:77], v[2:17]
 ds_read_b128 v[34:37], v134 offset:12800
 v_permlane32_swap_b32 v22, v24
 v_permlane32_swap_b32 v23, v25
 s_add_u32 s14, s80, 0
 buffer_load_dword v0, v86, s[60:63], s14 offen sc1
 v_mfma_f32_32x32x16_bf16 v[2:17], a[16:19], v[78:81], v[2:17]
 ds_read_b128 v[74:77], v134 offset:12832
 v_cndmask_b32 v90, 0, v39, vcc
 v_cndmask_b32 v91, 0, v39, s[92:93]
 v_cmp_eq_u32 vcc, 4, v38
 v_cmp_eq_u32 s[92:93], 5, v38
 s_waitcnt lgkmcnt(3)
 v_mfma_f32_32x32x16_bf16 v[2:17], a[20:23], v[82:85], v[2:17]
 ds_read_b128 v[78:81], v134 offset:12864
 buffer_store_dwordx4 v[22:25], v135, s[60:63], s88 offen offset:896 sc0 sc1
 s_add_u32 s14, s80, 32768
 buffer_load_dword v0, v86, s[60:63], s14 offen sc1
 v_mov_b32_e64 v41, 0
 v_cndmask_b32 v92, 0, v39, vcc
 v_mfma_f32_32x32x16_bf16 v[2:17], a[24:27], v[26:29], v[2:17]
 ds_read_b128 v[82:85], v134 offset:12896
 v_cndmask_b32 v93, 0, v39, s[92:93]
 v_cmp_eq_u32 vcc, 6, v38
 v_cmp_eq_u32 s[92:93], 7, v38
 v_mov_b32_e64 v41, 0
 s_waitcnt lgkmcnt(3)
 v_mfma_f32_32x32x16_bf16 v[2:17], a[28:31], v[30:33], v[2:17]
 ds_read_b128 v[26:29], v134 offset:12928
 v_cndmask_b32 v94, 0, v39, vcc
 v_cndmask_b32 v95, 0, v39, s[92:93]
 s_mul_i32 s14, s3, 2080
 s_add_u32 s14, s14, 67584
 v_lshl_add_u32 v96, v1, 5, s14
 v_mfma_f32_32x32x16_bf16 v[50:65], a[132:135], v[34:37], 0
 ds_read_b128 v[30:33], v134 offset:12960
 s_waitcnt lgkmcnt(3)
 v_mfma_f32_32x32x16_bf16 v[50:65], a[148:151], v[74:77], v[50:65]
 ds_read_b128 v[34:37], v134 offset:12992
 v_mfma_f32_32x32x16_bf16 v[50:65], a[164:167], v[78:81], v[50:65]
 ds_read_b128 v[74:77], v134 offset:13024
 v_cvt_pk_bf16_f32 v18, v2, v3
 v_cvt_pk_bf16_f32 v19, v4, v5
 v_cvt_pk_bf16_f32 v20, v6, v7
 v_cvt_pk_bf16_f32 v21, v8, v9
 s_waitcnt lgkmcnt(3)
 v_mfma_f32_32x32x16_bf16 v[50:65], a[32:35], v[82:85], v[50:65]
 ds_read_b128 v[78:81], v134 offset:13056
 v_permlane32_swap_b32 v18, v20
 v_permlane32_swap_b32 v19, v21
 v_mfma_f32_32x32x16_bf16 v[50:65], a[36:39], v[26:29], v[50:65]
 ds_read_b128 v[82:85], v134 offset:13088
 s_waitcnt lgkmcnt(3)
 v_mfma_f32_32x32x16_bf16 v[50:65], a[40:43], v[30:33], v[50:65]
 ds_read_b128 v[26:29], v134 offset:13120
 buffer_store_dwordx4 v[18:21], v135, s[60:63], s89 offen offset:0 sc0 sc1
 v_mfma_f32_32x32x16_bf16 v[50:65], a[44:47], v[34:37], v[50:65]
 ds_read_b128 v[30:33], v134 offset:12800
 s_waitcnt lgkmcnt(3)
 v_mfma_f32_32x32x16_bf16 v[50:65], a[48:51], v[74:77], v[50:65]
 ds_read_b128 v[34:37], v134 offset:12832
 v_cvt_pk_bf16_f32 v22, v10, v11
 v_cvt_pk_bf16_f32 v23, v12, v13
 v_cvt_pk_bf16_f32 v24, v14, v15
 v_cvt_pk_bf16_f32 v25, v16, v17
 v_mfma_f32_32x32x16_bf16 v[50:65], a[52:55], v[78:81], v[50:65]
 ds_read_b128 v[74:77], v134 offset:12864
 v_permlane32_swap_b32 v22, v24
 v_permlane32_swap_b32 v23, v25
 s_waitcnt lgkmcnt(3)
 v_mfma_f32_32x32x16_bf16 v[50:65], a[56:59], v[82:85], v[50:65]
 ds_read_b128 v[78:81], v134 offset:12896
 v_mfma_f32_32x32x16_bf16 v[50:65], a[60:63], v[26:29], v[50:65]
 ds_read_b128 v[82:85], v134 offset:12928
 buffer_store_dwordx4 v[22:25], v135, s[60:63], s89 offen offset:128 sc0 sc1
 s_waitcnt lgkmcnt(3)
 v_mfma_f32_32x32x16_bf16 v[2:17], a[136:139], v[30:33], 0
 ds_read_b128 v[26:29], v134 offset:12960
 s_lshl_b32 s14, s9, 2
 s_add_u32 s14, s14, s82
 s_waitcnt vmcnt(3)
 buffer_store_dword v143, off, s[60:63], s14 offset:0 sc0 sc1
 v_mfma_f32_32x32x16_bf16 v[2:17], a[152:155], v[34:37], v[2:17]
 ds_read_b128 v[30:33], v134 offset:12992
 s_waitcnt lgkmcnt(3)
 v_mfma_f32_32x32x16_bf16 v[2:17], a[168:171], v[74:77], v[2:17]
 ds_read_b128 v[34:37], v134 offset:13024
 v_cvt_pk_bf16_f32 v18, v50, v51
 v_cvt_pk_bf16_f32 v19, v52, v53
 v_cvt_pk_bf16_f32 v20, v54, v55
 v_cvt_pk_bf16_f32 v21, v56, v57
 v_mfma_f32_32x32x16_bf16 v[2:17], a[64:67], v[78:81], v[2:17]
 ds_read_b128 v[74:77], v134 offset:13056
 v_permlane32_swap_b32 v18, v20
 v_permlane32_swap_b32 v19, v21
 s_waitcnt lgkmcnt(3)
 v_mfma_f32_32x32x16_bf16 v[2:17], a[68:71], v[82:85], v[2:17]
 ds_read_b128 v[78:81], v134 offset:13088
 v_mfma_f32_32x32x16_bf16 v[2:17], a[72:75], v[26:29], v[2:17]
 ds_read_b128 v[82:85], v134 offset:13120
 buffer_store_dwordx4 v[18:21], v135, s[60:63], s89 offen offset:256 sc0 sc1
 s_waitcnt lgkmcnt(3)
 v_mfma_f32_32x32x16_bf16 v[2:17], a[76:79], v[30:33], v[2:17]
 ds_read_b128 v[26:29], v134 offset:12800
 v_mfma_f32_32x32x16_bf16 v[2:17], a[80:83], v[34:37], v[2:17]
 ds_read_b128 v[30:33], v134 offset:12832
 v_cvt_pk_bf16_f32 v22, v58, v59
 v_cvt_pk_bf16_f32 v23, v60, v61
 v_cvt_pk_bf16_f32 v24, v62, v63
 v_cvt_pk_bf16_f32 v25, v64, v65
 s_waitcnt lgkmcnt(3)
 v_mfma_f32_32x32x16_bf16 v[2:17], a[84:87], v[74:77], v[2:17]
 ds_read_b128 v[34:37], v134 offset:12864
 v_permlane32_swap_b32 v22, v24
 v_permlane32_swap_b32 v23, v25
 v_mfma_f32_32x32x16_bf16 v[2:17], a[88:91], v[78:81], v[2:17]
 ds_read_b128 v[74:77], v134 offset:12896
 s_waitcnt lgkmcnt(3)
 v_mfma_f32_32x32x16_bf16 v[2:17], a[92:95], v[82:85], v[2:17]
 ds_read_b128 v[78:81], v134 offset:12928
 buffer_store_dwordx4 v[22:25], v135, s[60:63], s89 offen offset:384 sc0 sc1
 v_mfma_f32_32x32x16_bf16 v[50:65], a[140:143], v[26:29], 0
 ds_read_b128 v[82:85], v134 offset:12960
 s_waitcnt lgkmcnt(3)
 v_mfma_f32_32x32x16_bf16 v[50:65], a[156:159], v[30:33], v[50:65]
 ds_read_b128 v[26:29], v134 offset:12992
 v_mfma_f32_32x32x16_bf16 v[50:65], a[172:175], v[34:37], v[50:65]
 ds_read_b128 v[30:33], v134 offset:13024
 s_nop 2
 v_cvt_pk_bf16_f32 v18, v2, v3
 v_cvt_pk_bf16_f32 v19, v4, v5
 v_cvt_pk_bf16_f32 v20, v6, v7
 v_cvt_pk_bf16_f32 v21, v8, v9
 s_waitcnt lgkmcnt(3)
 v_mfma_f32_32x32x16_bf16 v[50:65], a[96:99], v[74:77], v[50:65]
 ds_read_b128 v[34:37], v134 offset:13056
 v_permlane32_swap_b32 v18, v20
 v_permlane32_swap_b32 v19, v21
 v_mfma_f32_32x32x16_bf16 v[50:65], a[100:103], v[78:81], v[50:65]
 ds_read_b128 v[74:77], v134 offset:13088
 buffer_load_dword v87, v142, s[60:63], s82 offen offset:0 sc0 sc1
 s_waitcnt lgkmcnt(3)
 v_mfma_f32_32x32x16_bf16 v[50:65], a[104:107], v[82:85], v[50:65]
 ds_read_b128 v[78:81], v134 offset:13120
 buffer_store_dwordx4 v[18:21], v135, s[60:63], s89 offen offset:512 sc0 sc1
 v_mfma_f32_32x32x16_bf16 v[50:65], a[108:111], v[26:29], v[50:65]
 s_waitcnt lgkmcnt(2)
 v_mfma_f32_32x32x16_bf16 v[50:65], a[112:115], v[30:33], v[50:65]
 v_cvt_pk_bf16_f32 v22, v10, v11
 v_cvt_pk_bf16_f32 v23, v12, v13
 v_cvt_pk_bf16_f32 v24, v14, v15
 v_cvt_pk_bf16_f32 v25, v16, v17
 v_mfma_f32_32x32x16_bf16 v[50:65], a[116:119], v[34:37], v[50:65]
 v_permlane32_swap_b32 v22, v24
 v_permlane32_swap_b32 v23, v25
 s_waitcnt lgkmcnt(0)
 v_mfma_f32_32x32x16_bf16 v[50:65], a[120:123], v[74:77], v[50:65]
 v_mfma_f32_32x32x16_bf16 v[50:65], a[124:127], v[78:81], v[50:65]
 buffer_store_dwordx4 v[22:25], v135, s[60:63], s89 offen offset:640 sc0 sc1
 v_lshlrev_b32 v74, 16, v100
 v_and_b32 v75, s98, v100
 v_lshlrev_b32 v76, 16, v101
 v_and_b32 v77, s98, v101
 v_lshlrev_b32 v78, 16, v102
 v_and_b32 v79, s98, v102
 v_lshlrev_b32 v80, 16, v103
 v_and_b32 v81, s98, v103
 s_nop 2
 v_cvt_pk_bf16_f32 v18, v50, v51
 v_cvt_pk_bf16_f32 v19, v52, v53
 v_cvt_pk_bf16_f32 v20, v54, v55
 v_cvt_pk_bf16_f32 v21, v56, v57
 v_cvt_pk_bf16_f32 v22, v58, v59
 v_cvt_pk_bf16_f32 v23, v60, v61
 v_cvt_pk_bf16_f32 v24, v62, v63
 v_cvt_pk_bf16_f32 v25, v64, v65
 v_permlane32_swap_b32 v18, v20
 v_permlane32_swap_b32 v19, v21
 buffer_store_dwordx4 v[18:21], v135, s[60:63], s89 offen offset:768 sc0 sc1
 v_permlane32_swap_b32 v22, v24
 v_permlane32_swap_b32 v23, v25
 buffer_store_dwordx4 v[22:25], v135, s[60:63], s89 offen offset:896 sc0 sc1
 s_add_u32 s14, s80, 0
 s_add_u32 s15, s81, 0
 s_waitcnt vmcnt(4)
 v_cmp_ne_u32 vcc, s7, v87
 s_cbranch_vccnz Lrt_54
Lbk_55:
 buffer_load_dwordx4 v[26:29], v136, s[60:63], s14 offen offset:0 sc0 sc1
 buffer_load_dwordx4 v[30:33], v136, s[60:63], s15 offen offset:0 sc0 sc1
 buffer_load_dwordx4 v[34:37], v136, s[60:63], s14 offen offset:256 sc0 sc1
 buffer_load_dwordx4 v[38:41], v136, s[60:63], s15 offen offset:256 sc0 sc1
 buffer_load_dwordx4 v[42:45], v136, s[60:63], s14 offen offset:512 sc0 sc1
 buffer_load_dwordx4 v[46:49], v136, s[60:63], s15 offen offset:512 sc0 sc1
 buffer_load_dwordx4 v[66:69], v136, s[60:63], s14 offen offset:768 sc0 sc1
 buffer_load_dwordx4 v[70:73], v136, s[60:63], s15 offen offset:768 sc0 sc1
 v_lshlrev_b32 v10, 16, v116
 v_and_b32 v11, s98, v116
 v_lshlrev_b32 v12, 16, v117
 v_and_b32 v13, s98, v117
 v_lshlrev_b32 v14, 16, v118
 v_and_b32 v15, s98, v118
 v_lshlrev_b32_e64 v16, 16, v119
 v_and_b32_e64 v17, s98, v119
 v_pk_add_f32 v[74:75], v[74:75], v[10:11]
 v_pk_add_f32 v[76:77], v[76:77], v[12:13]
 v_pk_add_f32 v[78:79], v[78:79], v[14:15]
 v_pk_add_f32 v[80:81], v[80:81], v[16:17]
 s_lshl_b32 s14, s9, 2
 s_add_u32 s14, s14, s82
 s_waitcnt vmcnt(8)
 buffer_store_dword v143, off, s[60:63], s14 offset:512 sc0 sc1
 s_waitcnt vmcnt(8)
 v_mfma_f32_16x16x32_bf16 v[2:5], v[88:91], v[26:29], 0
 s_waitcnt vmcnt(7)
 v_mfma_f32_16x16x32_bf16 v[2:5], v[88:91], v[30:33], v[2:5]
 s_waitcnt vmcnt(6)
 v_mfma_f32_16x16x32_bf16 v[2:5], v[92:95], v[34:37], v[2:5]
 s_waitcnt vmcnt(5)
 v_mfma_f32_16x16x32_bf16 v[2:5], v[92:95], v[38:41], v[2:5]
 s_waitcnt vmcnt(4)
 v_mfma_f32_16x16x32_bf16 v[6:9], v[88:91], v[42:45], 0
 s_waitcnt vmcnt(3)
 v_mfma_f32_16x16x32_bf16 v[6:9], v[88:91], v[46:49], v[6:9]
 s_waitcnt vmcnt(2)
 v_mfma_f32_16x16x32_bf16 v[6:9], v[92:95], v[66:69], v[6:9]
 s_waitcnt vmcnt(1)
 v_mfma_f32_16x16x32_bf16 v[6:9], v[92:95], v[70:73], v[6:9]
 ds_write_b128 v137, v[2:5] offset:0
 s_nop 6
 ds_write_b128 v137, v[6:9] offset:256
 s_waitcnt lgkmcnt(0)
 s_barrier
 ds_read_b128 v[2:5], v96
 ds_read_b128 v[6:9], v96 offset:16
 buffer_load_dword v87, v142, s[60:63], s82 offen offset:512 sc0 sc1
 v_lshlrev_b32 v18, 16, v108
 v_and_b32 v19, s98, v108
 v_lshlrev_b32 v20, 16, v109
 v_and_b32 v21, s98, v109
 v_lshlrev_b32 v22, 16, v110
 v_and_b32 v23, s98, v110
 v_lshlrev_b32 v24, 16, v111
 v_and_b32 v25, s98, v111
 s_waitcnt lgkmcnt(1)
 v_pk_add_f32 v[2:3], v[2:3], v[74:75]
 v_pk_add_f32 v[4:5], v[4:5], v[76:77]
 s_waitcnt lgkmcnt(0)
 v_pk_add_f32 v[6:7], v[6:7], v[78:79]
 v_pk_add_f32 v[8:9], v[8:9], v[80:81]
 v_pk_add_f32 v[10:11], v[2:3], v[4:5]
 v_pk_mul_f32 v[12:13], v[2:3], v[2:3]
 v_pk_add_f32 v[14:15], v[6:7], v[8:9]
 v_pk_fma_f32 v[12:13], v[4:5], v[4:5], v[12:13]
 v_pk_add_f32 v[10:11], v[10:11], v[14:15]
 v_pk_fma_f32 v[12:13], v[6:7], v[6:7], v[12:13]
 v_add_f32_e64 v10, v10, v11
 v_pk_fma_f32 v[12:13], v[8:9], v[8:9], v[12:13]
 v_add_f32 v11, v12, v13
 v_add_f32_dpp v10, v10, v10 quad_perm:[1,0,3,2] row_mask:0xf bank_mask:0xf
 v_lshlrev_b32 v74, 16, v104
 v_add_f32_dpp v11, v11, v11 quad_perm:[1,0,3,2] row_mask:0xf bank_mask:0xf
 v_and_b32_e64 v75, s98, v104
 v_add_f32_dpp v10, v10, v10 quad_perm:[2,3,0,1] row_mask:0xf bank_mask:0xf
 v_lshlrev_b32_e64 v76, 16, v105
 v_add_f32_dpp v11, v11, v11 quad_perm:[2,3,0,1] row_mask:0xf bank_mask:0xf
 v_and_b32_e64 v77, s98, v105
 v_add_f32_dpp v10, v10, v10 row_half_mirror row_mask:0xf bank_mask:0xf
 v_lshlrev_b32_e64 v78, 16, v106
 v_add_f32_dpp v11, v11, v11 row_half_mirror row_mask:0xf bank_mask:0xf
 v_and_b32_e64 v79, s98, v106
 v_add_f32_dpp v10, v10, v10 row_mirror row_mask:0xf bank_mask:0xf
 v_lshlrev_b32_e64 v80, 16, v107
 v_add_f32_dpp v11, v11, v11 row_mirror row_mask:0xf bank_mask:0xf
 v_and_b32 v81, s98, v107
 v_add_f32_dpp v10, v10, v10 row_bcast:15 row_mask:0xa bank_mask:0xf
 v_add_f32_dpp v11, v11, v11 row_bcast:15 row_mask:0xa bank_mask:0xf
 s_nop 0
 v_add_f32_dpp v10, v10, v10 row_bcast:31 row_mask:0xc bank_mask:0xf
 v_add_f32_dpp v11, v11, v11 row_bcast:31 row_mask:0xc bank_mask:0xf
 v_readlane_b32 s92, v10, 63
 v_readlane_b32 s93, v11, 63
 v_mov_b32 v13, s96
 v_mul_f32 v10, s92, v13
 v_mul_f32 v11, s93, v13
 v_fma_f32 v11, -v10, v10, v11
 v_max_f32 v11, 0, v11
 v_add_f32 v11, 0x3727c5ac, v11
 v_rsq_f32 v11, v11
 s_nop 0
 v_mul_f32 v10, v10, v11
 s_add_u32 s14, s80, 4096
 s_add_u32 s15, s81, 4096
 s_waitcnt vmcnt(0)
 v_cmp_ne_u32 vcc, s7, v87
 s_cbranch_vccnz Lrt_57
Lbk_58:
 buffer_load_dwordx4 v[34:37], v136, s[60:63], s14 offen offset:0 sc0 sc1
 v_pk_fma_f32 v[26:27], v[2:3], v[10:11], v[10:11] op_sel:[0,1,0] op_sel_hi:[1,1,0] neg_lo:[0,0,1] neg_hi:[0,0,1]
 v_pk_fma_f32 v[28:29], v[4:5], v[10:11], v[10:11] op_sel:[0,1,0] op_sel_hi:[1,1,0] neg_lo:[0,0,1] neg_hi:[0,0,1]
 v_pk_fma_f32 v[30:31], v[6:7], v[10:11], v[10:11] op_sel:[0,1,0] op_sel_hi:[1,1,0] neg_lo:[0,0,1] neg_hi:[0,0,1]
 v_pk_fma_f32 v[32:33], v[8:9], v[10:11], v[10:11] op_sel:[0,1,0] op_sel_hi:[1,1,0] neg_lo:[0,0,1] neg_hi:[0,0,1]
 v_pk_fma_f32 v[2:3], v[26:27], v[18:19], v[2:3]
 v_pk_fma_f32 v[4:5], v[28:29], v[20:21], v[4:5]
 v_pk_fma_f32 v[6:7], v[30:31], v[22:23], v[6:7]
 buffer_load_dwordx4 v[38:41], v136, s[60:63], s15 offen offset:0 sc0 sc1
 v_pk_fma_f32 v[8:9], v[32:33], v[24:25], v[8:9]
 v_pk_add_f32 v[10:11], v[2:3], v[4:5]
 v_pk_mul_f32 v[12:13], v[2:3], v[2:3]
 v_pk_add_f32 v[14:15], v[6:7], v[8:9]
 v_pk_fma_f32 v[12:13], v[4:5], v[4:5], v[12:13]
 v_pk_add_f32 v[10:11], v[10:11], v[14:15]
 v_pk_fma_f32 v[12:13], v[6:7], v[6:7], v[12:13]
 v_add_f32 v10, v10, v11
 buffer_load_dwordx4 v[42:45], v136, s[60:63], s14 offen offset:256 sc0 sc1
 v_pk_fma_f32 v[12:13], v[8:9], v[8:9], v[12:13]
 v_add_f32 v11, v12, v13
 v_add_f32_dpp v10, v10, v10 quad_perm:[1,0,3,2] row_mask:0xf bank_mask:0xf
 v_lshlrev_b32 v66, 16, v116
 v_add_f32_dpp v11, v11, v11 quad_perm:[1,0,3,2] row_mask:0xf bank_mask:0xf
 v_and_b32 v67, s98, v116
 v_add_f32_dpp v10, v10, v10 quad_perm:[2,3,0,1] row_mask:0xf bank_mask:0xf
 v_lshlrev_b32_e64 v68, 16, v117
 buffer_load_dwordx4 v[46:49], v136, s[60:63], s15 offen offset:256 sc0 sc1
 v_add_f32_dpp v11, v11, v11 quad_perm:[2,3,0,1] row_mask:0xf bank_mask:0xf
 v_and_b32 v69, s98, v117
 v_add_f32_dpp v10, v10, v10 row_half_mirror row_mask:0xf bank_mask:0xf
 v_lshlrev_b32 v70, 16, v118
 v_add_f32_dpp v11, v11, v11 row_half_mirror row_mask:0xf bank_mask:0xf
 v_and_b32 v71, s98, v118
 v_add_f32_dpp v10, v10, v10 row_mirror row_mask:0xf bank_mask:0xf
 v_lshlrev_b32 v72, 16, v119
 buffer_load_dwordx4 v[50:53], v136, s[60:63], s14 offen offset:512 sc0 sc1
 v_add_f32_dpp v11, v11, v11 row_mirror row_mask:0xf bank_mask:0xf
 v_and_b32_e64 v73, s98, v119
 v_add_f32_dpp v10, v10, v10 row_bcast:15 row_mask:0xa bank_mask:0xf
 v_pk_add_f32 v[74:75], v[74:75], v[66:67]
 v_add_f32_dpp v11, v11, v11 row_bcast:15 row_mask:0xa bank_mask:0xf
 v_pk_add_f32 v[76:77], v[76:77], v[68:69]
 v_add_f32_dpp v10, v10, v10 row_bcast:31 row_mask:0xc bank_mask:0xf
 v_pk_add_f32 v[78:79], v[78:79], v[70:71]
 buffer_load_dwordx4 v[54:57], v136, s[60:63], s15 offen offset:512 sc0 sc1
 v_add_f32_dpp v11, v11, v11 row_bcast:31 row_mask:0xc bank_mask:0xf
 v_pk_add_f32 v[80:81], v[80:81], v[72:73]
 v_readlane_b32 s92, v10, 63
 v_readlane_b32 s93, v11, 63
 v_mov_b32 v13, s96
 v_mul_f32 v10, s92, v13
 v_mul_f32_e64 v11, s93, v13
 v_fma_f32 v11, -v10, v10, v11
 buffer_load_dwordx4 v[58:61], v136, s[60:63], s14 offen offset:768 sc0 sc1
 v_max_f32 v11, 0, v11
 v_add_f32 v11, 0x3727c5ac, v11
 v_rsq_f32 v11, v11
 s_nop 0
 v_mul_f32 v10, v10, v11
 v_pk_fma_f32 v[26:27], v[2:3], v[10:11], v[10:11] op_sel:[0,1,0] op_sel_hi:[1,1,0] neg_lo:[0,0,1] neg_hi:[0,0,1]
 v_pk_fma_f32 v[28:29], v[4:5], v[10:11], v[10:11] op_sel:[0,1,0] op_sel_hi:[1,1,0] neg_lo:[0,0,1] neg_hi:[0,0,1]
 v_pk_fma_f32 v[30:31], v[6:7], v[10:11], v[10:11] op_sel:[0,1,0] op_sel_hi:[1,1,0] neg_lo:[0,0,1] neg_hi:[0,0,1]
 v_pk_fma_f32 v[32:33], v[8:9], v[10:11], v[10:11] op_sel:[0,1,0] op_sel_hi:[1,1,0] neg_lo:[0,0,1] neg_hi:[0,0,1]
 buffer_load_dwordx4 v[62:65], v136, s[60:63], s15 offen offset:768 sc0 sc1
 v_cvt_pk_bf16_f32 v18, v26, v27
 v_cvt_pk_bf16_f32 v19, v28, v29
 v_cvt_pk_bf16_f32 v20, v30, v31
 v_cvt_pk_bf16_f32 v21, v32, v33
 v_min_u32 v18, -2, v18
 v_min_u32 v19, -2, v19
 v_min_u32 v20, -2, v20
 v_min_u32 v21, -2, v21
 s_add_u32 s12, s76, 8192
 buffer_store_dwordx4 v[18:21], v139, s[60:63], s12 offen sc0 sc1
 v_pk_add_f32 v[26:27], v[2:3], v[66:67]
 v_pk_add_f32 v[28:29], v[4:5], v[68:69]
 v_pk_add_f32 v[30:31], v[6:7], v[70:71]
 v_pk_add_f32 v[32:33], v[8:9], v[72:73]
 ds_write_b128 v96, v[26:29] offset:0
 ds_write_b128 v96, v[30:33] offset:16
 s_add_u32 s77, s77, 8192
 s_add_u32 s78, s78, 8192
 s_add_u32 s82, s82, 1024
 s_waitcnt vmcnt(8)
 v_mfma_f32_16x16x32_bf16 v[10:13], v[88:91], v[34:37], 0
 s_waitcnt vmcnt(7)
 v_mfma_f32_16x16x32_bf16 v[10:13], v[88:91], v[38:41], v[10:13]
 s_waitcnt vmcnt(6)
 v_mfma_f32_16x16x32_bf16 v[10:13], v[92:95], v[42:45], v[10:13]
 s_waitcnt vmcnt(5)
 v_mfma_f32_16x16x32_bf16 v[10:13], v[92:95], v[46:49], v[10:13]
 s_waitcnt vmcnt(4)
 v_mfma_f32_16x16x32_bf16 v[14:17], v[88:91], v[50:53], 0
 s_waitcnt vmcnt(3)
 v_mfma_f32_16x16x32_bf16 v[14:17], v[88:91], v[54:57], v[14:17]
 s_waitcnt vmcnt(2)
 v_mfma_f32_16x16x32_bf16 v[14:17], v[92:95], v[58:61], v[14:17]
 s_waitcnt vmcnt(1)
 v_mfma_f32_16x16x32_bf16 v[14:17], v[92:95], v[62:65], v[14:17]
 ds_write_b128 v137, v[10:13] offset:34816
 s_nop 6
 ds_write_b128 v137, v[14:17] offset:35072
 s_waitcnt lgkmcnt(0)
 s_barrier
 ds_read_b128 v[2:5], v96 offset:34816
 ds_read_b128 v[6:9], v96 offset:34832
 v_lshlrev_b32 v18, 16, v112
 v_and_b32_e64 v19, s98, v112
 v_lshlrev_b32_e64 v20, 16, v113
 v_and_b32_e64 v21, s98, v113
 v_lshlrev_b32_e64 v22, 16, v114
 v_and_b32 v23, s98, v114
 s_add_u32 s86, s77, 0
 s_add_u32 s87, s78, 0
 s_add_u32 m0, s101, 0
 s_nop 0
 buffer_load_dwordx4 v138, s[60:63], s86 offen offset:0 sc0 sc1 lds
 s_add_u32 m0, s101, 32
 v_lshlrev_b32 v24, 16, v115
 v_and_b32_e64 v25, s98, v115
 s_waitcnt lgkmcnt(1)
 v_pk_add_f32 v[2:3], v[2:3], v[74:75]
 v_pk_add_f32 v[4:5], v[4:5], v[76:77]
 s_waitcnt lgkmcnt(0)
 v_pk_add_f32 v[6:7], v[6:7], v[78:79]
 v_pk_add_f32 v[8:9], v[8:9], v[80:81]
 buffer_load_dwordx4 v138, s[60:63], s86 offen offset:1024 sc0 sc1 lds
 s_add_u32 m0, s101, 64
 v_pk_add_f32 v[10:11], v[2:3], v[4:5]
 v_pk_mul_f32 v[12:13], v[2:3], v[2:3]
 v_pk_add_f32 v[14:15], v[6:7], v[8:9]
 v_pk_fma_f32 v[12:13], v[4:5], v[4:5], v[12:13]
 v_pk_add_f32 v[10:11], v[10:11], v[14:15]
 v_pk_fma_f32 v[12:13], v[6:7], v[6:7], v[12:13]
 buffer_load_dwordx4 v138, s[60:63], s86 offen offset:2048 sc0 sc1 lds
 s_add_u32 m0, s101, 96
 v_add_f32_e64 v10, v10, v11
 v_pk_fma_f32 v[12:13], v[8:9], v[8:9], v[12:13]
 v_add_f32_e64 v11, v12, v13
 v_add_f32_dpp v10, v10, v10 quad_perm:[1,0,3,2] row_mask:0xf bank_mask:0xf
 s_nop 0
 v_add_f32_dpp v11, v11, v11 quad_perm:[1,0,3,2] row_mask:0xf bank_mask:0xf
 v_add_f32_dpp v10, v10, v10 quad_perm:[2,3,0,1] row_mask:0xf bank_mask:0xf
 s_nop 0
 v_add_f32_dpp v11, v11, v11 quad_perm:[2,3,0,1] row_mask:0xf bank_mask:0xf
 buffer_load_dwordx4 v138, s[60:63], s86 offen offset:3072 sc0 sc1 lds
 s_add_u32 m0, s101, 4224
 v_add_f32_dpp v10, v10, v10 row_half_mirror row_mask:0xf bank_mask:0xf
 v_add_f32_dpp v11, v11, v11 row_half_mirror row_mask:0xf bank_mask:0xf
 s_nop 0
 v_add_f32_dpp v10, v10, v10 row_mirror row_mask:0xf bank_mask:0xf
 v_add_f32_dpp v11, v11, v11 row_mirror row_mask:0xf bank_mask:0xf
 s_nop 0
 v_add_f32_dpp v10, v10, v10 row_bcast:15 row_mask:0xa bank_mask:0xf
 v_add_f32_dpp v11, v11, v11 row_bcast:15 row_mask:0xa bank_mask:0xf
 buffer_load_dwordx4 v138, s[60:63], s87 offen offset:0 sc0 sc1 lds
 s_add_u32 m0, s101, 4256
 v_add_f32_dpp v10, v10, v10 row_bcast:31 row_mask:0xc bank_mask:0xf
 v_add_f32_dpp v11, v11, v11 row_bcast:31 row_mask:0xc bank_mask:0xf
 v_readlane_b32 s92, v10, 63
 v_readlane_b32 s93, v11, 63
 v_mov_b32 v13, s96
 v_mul_f32 v10, s92, v13
 buffer_load_dwordx4 v138, s[60:63], s87 offen offset:1024 sc0 sc1 lds
 s_add_u32 m0, s101, 4288
 v_mul_f32 v11, s93, v13
 v_fma_f32 v11, -v10, v10, v11
 v_max_f32 v11, 0, v11
 v_add_f32 v11, 0x3727c5ac, v11
 v_rsq_f32 v11, v11
 s_nop 0
 v_mul_f32_e64 v10, v10, v11
 v_pk_fma_f32 v[26:27], v[2:3], v[10:11], v[10:11] op_sel:[0,1,0] op_sel_hi:[1,1,0] neg_lo:[0,0,1] neg_hi:[0,0,1]
 buffer_load_dwordx4 v138, s[60:63], s87 offen offset:2048 sc0 sc1 lds
 s_add_u32 m0, s101, 4320
 v_pk_fma_f32 v[28:29], v[4:5], v[10:11], v[10:11] op_sel:[0,1,0] op_sel_hi:[1,1,0] neg_lo:[0,0,1] neg_hi:[0,0,1]
 v_pk_fma_f32 v[30:31], v[6:7], v[10:11], v[10:11] op_sel:[0,1,0] op_sel_hi:[1,1,0] neg_lo:[0,0,1] neg_hi:[0,0,1]
 v_pk_fma_f32 v[32:33], v[8:9], v[10:11], v[10:11] op_sel:[0,1,0] op_sel_hi:[1,1,0] neg_lo:[0,0,1] neg_hi:[0,0,1]
 v_pk_fma_f32 v[2:3], v[26:27], v[18:19], v[2:3]
 v_pk_fma_f32 v[4:5], v[28:29], v[20:21], v[4:5]
 v_pk_fma_f32 v[6:7], v[30:31], v[22:23], v[6:7]
 buffer_load_dwordx4 v138, s[60:63], s87 offen offset:3072 sc0 sc1 lds
 v_pk_fma_f32 v[8:9], v[32:33], v[24:25], v[8:9]
 v_pk_add_f32 v[10:11], v[2:3], v[4:5]
 v_pk_mul_f32 v[12:13], v[2:3], v[2:3]
 v_pk_add_f32 v[14:15], v[6:7], v[8:9]
 v_pk_fma_f32 v[12:13], v[4:5], v[4:5], v[12:13]
 v_pk_add_f32 v[10:11], v[10:11], v[14:15]
 v_pk_fma_f32 v[12:13], v[6:7], v[6:7], v[12:13]
 v_add_f32 v10, v10, v11
 v_pk_fma_f32 v[12:13], v[8:9], v[8:9], v[12:13]
 v_add_f32 v11, v12, v13
 v_add_f32_dpp v10, v10, v10 quad_perm:[1,0,3,2] row_mask:0xf bank_mask:0xf
 v_pk_add_f32 v[78:79], v[2:3], v[66:67]
 v_add_f32_dpp v11, v11, v11 quad_perm:[1,0,3,2] row_mask:0xf bank_mask:0xf
 v_pk_add_f32 v[80:81], v[4:5], v[68:69]
 v_add_f32_dpp v10, v10, v10 quad_perm:[2,3,0,1] row_mask:0xf bank_mask:0xf
 v_pk_add_f32 v[82:83], v[6:7], v[70:71]
 v_add_f32_dpp v11, v11, v11 quad_perm:[2,3,0,1] row_mask:0xf bank_mask:0xf
 v_pk_add_f32 v[84:85], v[8:9], v[72:73]
 v_add_f32_dpp v10, v10, v10 row_half_mirror row_mask:0xf bank_mask:0xf
 ds_write_b128 v96, v[78:81] offset:34816
 v_add_f32_dpp v11, v11, v11 row_half_mirror row_mask:0xf bank_mask:0xf
 ds_write_b128 v96, v[82:85] offset:34832
 v_add_f32_dpp v10, v10, v10 row_mirror row_mask:0xf bank_mask:0xf
 v_add_f32_dpp v11, v11, v11 row_mirror row_mask:0xf bank_mask:0xf
 s_nop 0
 v_add_f32_dpp v10, v10, v10 row_bcast:15 row_mask:0xa bank_mask:0xf
 v_add_f32_dpp v11, v11, v11 row_bcast:15 row_mask:0xa bank_mask:0xf
 s_nop 0
 v_add_f32_dpp v10, v10, v10 row_bcast:31 row_mask:0xc bank_mask:0xf
 v_add_f32_dpp v11, v11, v11 row_bcast:31 row_mask:0xc bank_mask:0xf
 v_readlane_b32 s92, v10, 63
 v_readlane_b32 s93, v11, 63
 v_mov_b32 v13, s96
 v_mul_f32 v10, s92, v13
 v_mul_f32 v11, s93, v13
 v_fma_f32 v11, -v10, v10, v11
 v_max_f32 v11, 0, v11
 v_add_f32 v11, 0x3727c5ac, v11
 v_rsq_f32 v11, v11
 s_waitcnt vmcnt(0)
 v_add_u32_e64 v37, s101, v139
 ds_read_b128 v[38:41], v37 offset:0
 ds_read_b128 v[42:45], v37 offset:1056
 ds_read_b128 v[46:49], v37 offset:2112
 ds_read_b128 v[50:53], v37 offset:3168
 ds_read_b128 v[54:57], v37 offset:4224
 ds_read_b128 v[58:61], v37 offset:5280
 ds_read_b128 v[62:65], v37 offset:6336
 ds_read_b128 v[66:69], v37 offset:7392
 v_mul_f32_e64 v10, v10, v11
 v_pk_fma_f32 v[26:27], v[2:3], v[10:11], v[10:11] op_sel:[0,1,0] op_sel_hi:[1,1,0] neg_lo:[0,0,1] neg_hi:[0,0,1]
 v_pk_fma_f32 v[28:29], v[4:5], v[10:11], v[10:11] op_sel:[0,1,0] op_sel_hi:[1,1,0] neg_lo:[0,0,1] neg_hi:[0,0,1]
 v_pk_fma_f32 v[30:31], v[6:7], v[10:11], v[10:11] op_sel:[0,1,0] op_sel_hi:[1,1,0] neg_lo:[0,0,1] neg_hi:[0,0,1]
 v_pk_fma_f32 v[32:33], v[8:9], v[10:11], v[10:11] op_sel:[0,1,0] op_sel_hi:[1,1,0] neg_lo:[0,0,1] neg_hi:[0,0,1]
 v_cvt_pk_bf16_f32 v18, v26, v27
 v_cvt_pk_bf16_f32 v19, v28, v29
 v_cvt_pk_bf16_f32 v20, v30, v31
 v_cvt_pk_bf16_f32 v21, v32, v33
 v_min_u32 v18, -2, v18
 v_min_u32 v19, -2, v19
 v_min_u32 v20, -2, v20
 v_min_u32 v21, -2, v21
 s_add_u32 s12, s76, 12288
 buffer_store_dwordx4 v[18:21], v139, s[60:63], s12 offen sc0 sc1
 s_waitcnt lgkmcnt(0)
 v_max_u32 v36, v38, v39
 v_max3_u32 v36, v36, v40, v41
 v_max3_u32 v36, v36, v42, v43
 v_max3_u32 v36, v36, v44, v45
 v_max3_u32 v36, v36, v46, v47
 v_max3_u32 v36, v36, v48, v49
 v_max3_u32 v36, v36, v50, v51
 v_max3_u32 v36, v36, v52, v53
 v_max3_u32 v36, v36, v54, v55
 v_max3_u32 v36, v36, v56, v57
 v_max3_u32 v36, v36, v58, v59
 v_max3_u32 v36, v36, v60, v61
 v_max3_u32 v36, v36, v62, v63
 v_max3_u32 v36, v36, v64, v65
 v_max3_u32 v36, v36, v66, v67
 v_max3_u32 v36, v36, v68, v69
 v_cmp_eq_u32 vcc, -1, v36
 s_cbranch_vccnz Lrt_60
Lbk_61:
 s_waitcnt lgkmcnt(0)
 s_barrier
 ds_read_b128 v[50:53], v132 offset:0
 ds_read_b128 v[54:57], v132 offset:64
 ds_read_b128 v[58:61], v132 offset:128
 s_waitcnt lgkmcnt(1)
 v_mfma_f32_16x16x32_bf16 v[2:5], a[176:179], v[50:53], v[120:123]
 ds_read_b128 v[62:65], v132 offset:192
 v_mfma_f32_16x16x32_bf16 v[6:9], a[180:183], v[50:53], v[124:127]
 v_mfma_f32_16x16x32_bf16 v[10:13], a[184:187], v[50:53], v[128:131]
 v_mfma_f32_16x16x32_bf16 v[2:5], a[188:191], v[54:57], v[2:5]
 ds_read_b128 v[50:53], v132 offset:256
 v_mfma_f32_16x16x32_bf16 v[6:9], a[192:195], v[54:57], v[6:9]
 v_mfma_f32_16x16x32_bf16 v[10:13], a[196:199], v[54:57], v[10:13]
 s_waitcnt lgkmcnt(1)
 v_mfma_f32_16x16x32_bf16 v[2:5], a[200:203], v[58:61], v[2:5]
 ds_read_b128 v[54:57], v132 offset:320
 v_mfma_f32_16x16x32_bf16 v[6:9], a[204:207], v[58:61], v[6:9]
 v_mfma_f32_16x16x32_bf16 v[10:13], a[208:211], v[58:61], v[10:13]
 v_mfma_f32_16x16x32_bf16 v[2:5], a[212:215], v[62:65], v[2:5]
 ds_read_b128 v[58:61], v132 offset:384
 v_mfma_f32_16x16x32_bf16 v[6:9], a[216:219], v[62:65], v[6:9]
 v_mfma_f32_16x16x32_bf16 v[10:13], a[220:223], v[62:65], v[10:13]
 s_waitcnt lgkmcnt(1)
 v_mfma_f32_16x16x32_bf16 v[2:5], a[224:227], v[50:53], v[2:5]
 ds_read_b128 v[62:65], v132 offset:448
 v_mfma_f32_16x16x32_bf16 v[6:9], a[228:231], v[50:53], v[6:9]
 v_mfma_f32_16x16x32_bf16 v[10:13], a[232:235], v[50:53], v[10:13]
 v_mfma_f32_16x16x32_bf16 v[2:5], a[236:239], v[54:57], v[2:5]
 ds_read_b128 v[50:53], v132 offset:512
 v_mfma_f32_16x16x32_bf16 v[6:9], a[240:243], v[54:57], v[6:9]
 v_mfma_f32_16x16x32_bf16 v[10:13], a[244:247], v[54:57], v[10:13]
 s_waitcnt lgkmcnt(1)
 v_mfma_f32_16x16x32_bf16 v[2:5], a[248:251], v[58:61], v[2:5]
 ds_read_b128 v[54:57], v132 offset:576
 v_mfma_f32_16x16x32_bf16 v[6:9], a[252:255], v[58:61], v[6:9]
 s_add_u32 s86, s77, 4096
 s_add_u32 s87, s78, 4096
 s_add_u32 m0, s101, 33792
 v_mfma_f32_16x16x32_bf16 v[10:13], v[144:147], v[58:61], v[10:13]
 buffer_load_dwordx4 v138, s[60:63], s86 offen offset:0 sc0 sc1 lds
 s_add_u32 m0, s101, 33824
 v_mfma_f32_16x16x32_bf16 v[2:5], v[148:151], v[62:65], v[2:5]
 ds_read_b128 v[58:61], v132 offset:640
 v_mfma_f32_16x16x32_bf16 v[6:9], v[152:155], v[62:65], v[6:9]
 v_mfma_f32_16x16x32_bf16 v[10:13], v[156:159], v[62:65], v[10:13]
 s_waitcnt lgkmcnt(1)
 v_mfma_f32_16x16x32_bf16 v[2:5], v[160:163], v[50:53], v[2:5]
 ds_read_b128 v[62:65], v132 offset:704
 buffer_load_dwordx4 v138, s[60:63], s86 offen offset:1024 sc0 sc1 lds
 s_add_u32 m0, s101, 33856
 v_mfma_f32_16x16x32_bf16 v[6:9], v[164:167], v[50:53], v[6:9]
 v_mfma_f32_16x16x32_bf16 v[10:13], v[168:171], v[50:53], v[10:13]
 v_mfma_f32_16x16x32_bf16 v[2:5], v[172:175], v[54:57], v[2:5]
 ds_read_b128 v[50:53], v132 offset:768
 v_mfma_f32_16x16x32_bf16 v[6:9], v[176:179], v[54:57], v[6:9]
 buffer_load_dwordx4 v138, s[60:63], s86 offen offset:2048 sc0 sc1 lds
 s_add_u32 m0, s101, 33888
 v_mfma_f32_16x16x32_bf16 v[10:13], v[180:183], v[54:57], v[10:13]
 s_waitcnt lgkmcnt(1)
 v_mfma_f32_16x16x32_bf16 v[2:5], v[184:187], v[58:61], v[2:5]
 ds_read_b128 v[54:57], v132 offset:832
 v_mfma_f32_16x16x32_bf16 v[6:9], v[188:191], v[58:61], v[6:9]
 v_mfma_f32_16x16x32_bf16 v[10:13], v[192:195], v[58:61], v[10:13]
 buffer_load_dwordx4 v138, s[60:63], s86 offen offset:3072 sc0 sc1 lds
 s_add_u32 m0, s101, 38016
 v_mfma_f32_16x16x32_bf16 v[2:5], v[196:199], v[62:65], v[2:5]
 ds_read_b128 v[58:61], v132 offset:896
 v_mfma_f32_16x16x32_bf16 v[6:9], v[200:203], v[62:65], v[6:9]
 v_mfma_f32_16x16x32_bf16 v[10:13], v[204:207], v[62:65], v[10:13]
 s_waitcnt lgkmcnt(1)
 v_mfma_f32_16x16x32_bf16 v[2:5], v[208:211], v[50:53], v[2:5]
 ds_read_b128 v[62:65], v132 offset:960
 buffer_load_dwordx4 v138, s[60:63], s87 offen offset:0 sc0 sc1 lds
 s_add_u32 m0, s101, 38048
 v_mfma_f32_16x16x32_bf16 v[6:9], v[212:215], v[50:53], v[6:9]
 v_mfma_f32_16x16x32_bf16 v[10:13], v[216:219], v[50:53], v[10:13]
 v_mfma_f32_16x16x32_bf16 v[2:5], v[220:223], v[54:57], v[2:5]
 ds_read_b128 v[50:53], v132 offset:16896
 v_mfma_f32_16x16x32_bf16 v[6:9], v[224:227], v[54:57], v[6:9]
 buffer_load_dwordx4 v138, s[60:63], s87 offen offset:1024 sc0 sc1 lds
 s_add_u32 m0, s101, 38080
 v_mfma_f32_16x16x32_bf16 v[10:13], v[228:231], v[54:57], v[10:13]
 s_waitcnt lgkmcnt(1)
 v_mfma_f32_16x16x32_bf16 v[2:5], v[232:235], v[58:61], v[2:5]
 ds_read_b128 v[54:57], v132 offset:16960
 v_mfma_f32_16x16x32_bf16 v[6:9], v[236:239], v[58:61], v[6:9]
 v_mfma_f32_16x16x32_bf16 v[10:13], v[240:243], v[58:61], v[10:13]
 buffer_load_dwordx4 v138, s[60:63], s87 offen offset:2048 sc0 sc1 lds
 s_add_u32 m0, s101, 38112
 v_mfma_f32_16x16x32_bf16 v[2:5], v[244:247], v[62:65], v[2:5]
 ds_read_b128 v[58:61], v132 offset:17024
 v_mfma_f32_16x16x32_bf16 v[6:9], v[248:251], v[62:65], v[6:9]
 v_mfma_f32_16x16x32_bf16 v[10:13], v[252:255], v[62:65], v[10:13]
 s_waitcnt lgkmcnt(1)
 v_mfma_f32_16x16x32_bf16 v[14:17], a[176:179], v[50:53], v[120:123]
 ds_read_b128 v[62:65], v132 offset:17088
 buffer_load_dwordx4 v138, s[60:63], s87 offen offset:3072 sc0 sc1 lds
 v_mfma_f32_16x16x32_bf16 v[18:21], a[180:183], v[50:53], v[124:127]
 v_mfma_f32_16x16x32_bf16 v[22:25], a[184:187], v[50:53], v[128:131]
 v_mul_f32 v66, v2, v2
 v_mul_f32_e64 v67, v3, v3
 v_mfma_f32_16x16x32_bf16 v[14:17], a[188:191], v[54:57], v[14:17]
 ds_read_b128 v[50:53], v132 offset:17152
 v_add_u32 v75, s101, v139
 v_mfma_f32_16x16x32_bf16 v[18:21], a[192:195], v[54:57], v[18:21]
 s_waitcnt vmcnt(6)
 ds_read_b128 v[76:79], v75 offset:33792
 ds_read_b128 v[80:83], v75 offset:34848
 v_mfma_f32_16x16x32_bf16 v[22:25], a[196:199], v[54:57], v[22:25]
 v_mul_f32 v68, v4, v4
 s_waitcnt lgkmcnt(3)
 v_mfma_f32_16x16x32_bf16 v[14:17], a[200:203], v[58:61], v[14:17]
 ds_read_b128 v[54:57], v132 offset:17216
 v_mul_f32_e64 v69, v5, v5
 v_mfma_f32_16x16x32_bf16 v[18:21], a[204:207], v[58:61], v[18:21]
 v_fma_f32 v66, v66, s100, v140
 v_fma_f32 v67, v67, s100, v140
 v_mfma_f32_16x16x32_bf16 v[22:25], a[208:211], v[58:61], v[22:25]
 v_fma_f32 v68, v68, s100, v140
 v_fma_f32 v69, v69, s100, v140
 v_mfma_f32_16x16x32_bf16 v[14:17], a[212:215], v[62:65], v[14:17]
 ds_read_b128 v[58:61], v132 offset:17280
 s_waitcnt lgkmcnt(2)
 v_max_u32 v74, v76, v77
 v_mfma_f32_16x16x32_bf16 v[18:21], a[216:219], v[62:65], v[18:21]
 v_max3_u32 v74, v74, v78, v79
 v_max3_u32 v74, v74, v80, v81
 v_mfma_f32_16x16x32_bf16 v[22:25], a[220:223], v[62:65], v[22:25]
 v_max3_u32 v74, v74, v82, v83
 s_waitcnt vmcnt(4)
 ds_read_b128 v[76:79], v75 offset:35904
 ds_read_b128 v[80:83], v75 offset:36960
 s_waitcnt lgkmcnt(3)
 v_mfma_f32_16x16x32_bf16 v[14:17], a[224:227], v[50:53], v[14:17]
 ds_read_b128 v[62:65], v132 offset:17344
 v_mul_f32 v66, v66, v2
 v_mfma_f32_16x16x32_bf16 v[18:21], a[228:231], v[50:53], v[18:21]
 v_mul_f32 v67, v67, v3
 v_mul_f32 v68, v68, v4
 v_mfma_f32_16x16x32_bf16 v[22:25], a[232:235], v[50:53], v[22:25]
 v_mul_f32 v69, v69, v5
 v_mfma_f32_16x16x32_bf16 v[14:17], a[236:239], v[54:57], v[14:17]
 ds_read_b128 v[50:53], v132 offset:17408
 v_mfma_f32_16x16x32_bf16 v[18:21], a[240:243], v[54:57], v[18:21]
 s_waitcnt lgkmcnt(2)
 v_max3_u32 v74, v74, v76, v77
 v_mfma_f32_16x16x32_bf16 v[22:25], a[244:247], v[54:57], v[22:25]
 v_max3_u32 v74, v74, v78, v79
 v_max3_u32 v74, v74, v80, v81
 s_waitcnt lgkmcnt(1)
 v_mfma_f32_16x16x32_bf16 v[14:17], a[248:251], v[58:61], v[14:17]
 ds_read_b128 v[54:57], v132 offset:17472
 v_max3_u32 v74, v74, v82, v83
 s_waitcnt vmcnt(2)
 ds_read_b128 v[76:79], v75 offset:38016
 ds_read_b128 v[80:83], v75 offset:39072
 v_mfma_f32_16x16x32_bf16 v[18:21], a[252:255], v[58:61], v[18:21]
 v_exp_f32 v66, v66
 v_mfma_f32_16x16x32_bf16 v[22:25], v[144:147], v[58:61], v[22:25]
 v_exp_f32 v67, v67
 v_mfma_f32_16x16x32_bf16 v[14:17], v[148:151], v[62:65], v[14:17]
 ds_read_b128 v[58:61], v132 offset:17536
 v_add_f32 v66, 1.0, v66
 v_mfma_f32_16x16x32_bf16 v[18:21], v[152:155], v[62:65], v[18:21]
 v_exp_f32 v68, v68
 v_mfma_f32_16x16x32_bf16 v[22:25], v[156:159], v[62:65], v[22:25]
 s_waitcnt lgkmcnt(1)
 v_max3_u32 v74, v74, v76, v77
 v_mfma_f32_16x16x32_bf16 v[14:17], v[160:163], v[50:53], v[14:17]
 ds_read_b128 v[62:65], v132 offset:17600
 v_max3_u32 v74, v74, v78, v79
 v_max3_u32 v74, v74, v80, v81
 v_mfma_f32_16x16x32_bf16 v[18:21], v[164:167], v[50:53], v[18:21]
 v_max3_u32 v74, v74, v82, v83
 s_waitcnt vmcnt(0)
 ds_read_b128 v[76:79], v75 offset:40128
 ds_read_b128 v[80:83], v75 offset:41184
 v_mfma_f32_16x16x32_bf16 v[22:25], v[168:171], v[50:53], v[22:25]
 v_exp_f32 v69, v69
 v_mfma_f32_16x16x32_bf16 v[14:17], v[172:175], v[54:57], v[14:17]
 ds_read_b128 v[50:53], v132 offset:17664
 v_add_f32_e64 v67, 1.0, v67
 v_mfma_f32_16x16x32_bf16 v[18:21], v[176:179], v[54:57], v[18:21]
 v_add_f32_e64 v68, 1.0, v68
 v_add_f32_e64 v69, 1.0, v69
 v_mfma_f32_16x16x32_bf16 v[22:25], v[180:183], v[54:57], v[22:25]
 s_waitcnt lgkmcnt(3)
 v_mfma_f32_16x16x32_bf16 v[14:17], v[184:187], v[58:61], v[14:17]
 ds_read_b128 v[54:57], v132 offset:17728
 s_waitcnt lgkmcnt(2)
 v_max3_u32 v74, v74, v76, v77
 v_mfma_f32_16x16x32_bf16 v[18:21], v[188:191], v[58:61], v[18:21]
 v_max3_u32 v74, v74, v78, v79
 v_max3_u32 v74, v74, v80, v81
 v_mfma_f32_16x16x32_bf16 v[22:25], v[192:195], v[58:61], v[22:25]
 v_max3_u32 v74, v74, v82, v83
 v_mfma_f32_16x16x32_bf16 v[14:17], v[196:199], v[62:65], v[14:17]
 ds_read_b128 v[58:61], v132 offset:17792
 v_cmp_eq_u32 vcc, -1, v74
 s_cbranch_vccnz Lrt_63
Lbk_64:
 s_barrier
 v_mfma_f32_16x16x32_bf16 v[18:21], v[200:203], v[62:65], v[18:21]
 v_rcp_f32 v66, v66
 v_mfma_f32_16x16x32_bf16 v[22:25], v[204:207], v[62:65], v[22:25]
 v_mul_f32 v66, v66, v2
 s_waitcnt lgkmcnt(1)
 v_mfma_f32_16x16x32_bf16 v[14:17], v[208:211], v[50:53], v[14:17]
 ds_read_b128 v[62:65], v132 offset:17856
 v_mfma_f32_16x16x32_bf16 v[18:21], v[212:215], v[50:53], v[18:21]
 v_rcp_f32_e64 v67, v67
 v_mfma_f32_16x16x32_bf16 v[22:25], v[216:219], v[50:53], v[22:25]
 v_rcp_f32_e64 v68, v68
 v_mfma_f32_16x16x32_bf16 v[14:17], v[220:223], v[54:57], v[14:17]
 ds_read_b128 v[50:53], v132 offset:33792
 v_mul_f32_e64 v67, v67, v3
 v_mfma_f32_16x16x32_bf16 v[18:21], v[224:227], v[54:57], v[18:21]
 v_rcp_f32_e64 v69, v69
 v_mfma_f32_16x16x32_bf16 v[22:25], v[228:231], v[54:57], v[22:25]
 v_mul_f32 v68, v68, v4
 s_waitcnt lgkmcnt(1)
 v_mfma_f32_16x16x32_bf16 v[14:17], v[232:235], v[58:61], v[14:17]
 ds_read_b128 v[54:57], v132 offset:33856
 v_mul_f32_e64 v69, v69, v5
 v_mfma_f32_16x16x32_bf16 v[18:21], v[236:239], v[58:61], v[18:21]
 v_cvt_pk_bf16_f32 v66, v66, v67
 v_cvt_pk_bf16_f32 v67, v68, v69
 v_mfma_f32_16x16x32_bf16 v[22:25], v[240:243], v[58:61], v[22:25]
 ds_write_b64 v133, v[66:67] offset:0
 v_mul_f32_e64 v70, v6, v6
 v_mfma_f32_16x16x32_bf16 v[14:17], v[244:247], v[62:65], v[14:17]
 ds_read_b128 v[58:61], v132 offset:33920
 v_mul_f32_e64 v71, v7, v7
 v_mfma_f32_16x16x32_bf16 v[18:21], v[248:251], v[62:65], v[18:21]
 v_mul_f32_e64 v72, v8, v8
 v_mul_f32 v73, v9, v9
 v_mfma_f32_16x16x32_bf16 v[22:25], v[252:255], v[62:65], v[22:25]
 v_fma_f32 v70, v70, s100, v140
 v_fma_f32 v71, v71, s100, v140
 s_waitcnt lgkmcnt(2)
 v_mfma_f32_16x16x32_bf16 v[26:29], a[176:179], v[50:53], v[120:123]
 ds_read_b128 v[62:65], v132 offset:33984
 v_fma_f32 v72, v72, s100, v140
 v_mfma_f32_16x16x32_bf16 v[30:33], a[180:183], v[50:53], v[124:127]
 v_fma_f32 v73, v73, s100, v140
 v_mul_f32 v70, v70, v6
 v_mfma_f32_16x16x32_bf16 v[34:37], a[184:187], v[50:53], v[128:131]
 v_mul_f32 v71, v71, v7
 v_mul_f32_e64 v72, v72, v8
 v_mfma_f32_16x16x32_bf16 v[26:29], a[188:191], v[54:57], v[26:29]
 ds_read_b128 v[50:53], v132 offset:34048
 v_mul_f32 v73, v73, v9
 v_mfma_f32_16x16x32_bf16 v[30:33], a[192:195], v[54:57], v[30:33]
 v_exp_f32 v70, v70
 v_mfma_f32_16x16x32_bf16 v[34:37], a[196:199], v[54:57], v[34:37]
 v_add_f32 v70, 1.0, v70
 s_waitcnt lgkmcnt(1)
 v_mfma_f32_16x16x32_bf16 v[26:29], a[200:203], v[58:61], v[26:29]
 ds_read_b128 v[54:57], v132 offset:34112
 v_mfma_f32_16x16x32_bf16 v[30:33], a[204:207], v[58:61], v[30:33]
 v_exp_f32 v71, v71
 v_mfma_f32_16x16x32_bf16 v[34:37], a[208:211], v[58:61], v[34:37]
 v_exp_f32 v72, v72
 v_mfma_f32_16x16x32_bf16 v[26:29], a[212:215], v[62:65], v[26:29]
 ds_read_b128 v[58:61], v132 offset:34176
 v_add_f32 v71, 1.0, v71
 v_mfma_f32_16x16x32_bf16 v[30:33], a[216:219], v[62:65], v[30:33]
 v_exp_f32 v73, v73
 v_mfma_f32_16x16x32_bf16 v[34:37], a[220:223], v[62:65], v[34:37]
 v_add_f32 v72, 1.0, v72
 s_waitcnt lgkmcnt(1)
 v_mfma_f32_16x16x32_bf16 v[26:29], a[224:227], v[50:53], v[26:29]
 ds_read_b128 v[62:65], v132 offset:34240
 v_add_f32_e64 v73, 1.0, v73
 v_mfma_f32_16x16x32_bf16 v[30:33], a[228:231], v[50:53], v[30:33]
 v_rcp_f32 v70, v70
 v_mfma_f32_16x16x32_bf16 v[34:37], a[232:235], v[50:53], v[34:37]
 v_rcp_f32 v71, v71
 v_mfma_f32_16x16x32_bf16 v[26:29], a[236:239], v[54:57], v[26:29]
 ds_read_b128 v[50:53], v132 offset:34304
 v_mul_f32 v70, v70, v6
 v_mfma_f32_16x16x32_bf16 v[30:33], a[240:243], v[54:57], v[30:33]
 v_rcp_f32 v72, v72
 v_mfma_f32_16x16x32_bf16 v[34:37], a[244:247], v[54:57], v[34:37]
 v_mul_f32 v71, v71, v7
 s_waitcnt lgkmcnt(1)
 v_mfma_f32_16x16x32_bf16 v[26:29], a[248:251], v[58:61], v[26:29]
 ds_read_b128 v[54:57], v132 offset:34368
 v_mul_f32_e64 v72, v72, v8
 v_mfma_f32_16x16x32_bf16 v[30:33], a[252:255], v[58:61], v[30:33]
 v_rcp_f32 v73, v73
 v_mfma_f32_16x16x32_bf16 v[34:37], v[144:147], v[58:61], v[34:37]
 v_mul_f32 v73, v73, v9
 v_cvt_pk_bf16_f32 v70, v70, v71
 v_mfma_f32_16x16x32_bf16 v[26:29], v[148:151], v[62:65], v[26:29]
 ds_read_b128 v[58:61], v132 offset:34432
 v_cvt_pk_bf16_f32 v71, v72, v73
 v_mfma_f32_16x16x32_bf16 v[30:33], v[152:155], v[62:65], v[30:33]
 ds_write_b64 v133, v[70:71] offset:32
 v_mul_f32 v66, v10, v10
 v_mfma_f32_16x16x32_bf16 v[34:37], v[156:159], v[62:65], v[34:37]
 v_mul_f32_e64 v67, v11, v11
 s_waitcnt lgkmcnt(2)
 v_mfma_f32_16x16x32_bf16 v[26:29], v[160:163], v[50:53], v[26:29]
 ds_read_b128 v[62:65], v132 offset:34496
 v_mul_f32 v68, v12, v12
 v_mfma_f32_16x16x32_bf16 v[30:33], v[164:167], v[50:53], v[30:33]
 v_mul_f32 v69, v13, v13
 v_fma_f32 v66, v66, s100, v140
 v_mfma_f32_16x16x32_bf16 v[34:37], v[168:171], v[50:53], v[34:37]
 v_fma_f32 v67, v67, s100, v140
 v_fma_f32 v68, v68, s100, v140
 v_mfma_f32_16x16x32_bf16 v[26:29], v[172:175], v[54:57], v[26:29]
 ds_read_b128 v[50:53], v132 offset:34560
 v_fma_f32 v69, v69, s100, v140
 v_mfma_f32_16x16x32_bf16 v[30:33], v[176:179], v[54:57], v[30:33]
 v_mul_f32 v66, v66, v10
 v_mul_f32 v67, v67, v11
 v_mfma_f32_16x16x32_bf16 v[34:37], v[180:183], v[54:57], v[34:37]
 v_mul_f32 v68, v68, v12
 s_waitcnt lgkmcnt(1)
 v_mfma_f32_16x16x32_bf16 v[26:29], v[184:187], v[58:61], v[26:29]
 ds_read_b128 v[54:57], v132 offset:34624
 v_mul_f32 v69, v69, v13
 v_mfma_f32_16x16x32_bf16 v[30:33], v[188:191], v[58:61], v[30:33]
 v_exp_f32 v66, v66
 v_mfma_f32_16x16x32_bf16 v[34:37], v[192:195], v[58:61], v[34:37]
 v_exp_f32 v67, v67
 v_mfma_f32_16x16x32_bf16 v[26:29], v[196:199], v[62:65], v[26:29]
 ds_read_b128 v[58:61], v132 offset:34688
 v_add_f32 v66, 1.0, v66
 v_mfma_f32_16x16x32_bf16 v[30:33], v[200:203], v[62:65], v[30:33]
 v_exp_f32 v68, v68
 v_mfma_f32_16x16x32_bf16 v[34:37], v[204:207], v[62:65], v[34:37]
 v_add_f32_e64 v67, 1.0, v67
 s_waitcnt lgkmcnt(1)
 v_mfma_f32_16x16x32_bf16 v[26:29], v[208:211], v[50:53], v[26:29]
 ds_read_b128 v[62:65], v132 offset:34752
 v_add_f32 v68, 1.0, v68
 v_mfma_f32_16x16x32_bf16 v[30:33], v[212:215], v[50:53], v[30:33]
 v_exp_f32 v69, v69
 v_mfma_f32_16x16x32_bf16 v[34:37], v[216:219], v[50:53], v[34:37]
 v_add_f32 v69, 1.0, v69
 v_mfma_f32_16x16x32_bf16 v[26:29], v[220:223], v[54:57], v[26:29]
 ds_read_b128 v[50:53], v132 offset:50688
 v_mfma_f32_16x16x32_bf16 v[30:33], v[224:227], v[54:57], v[30:33]
 v_rcp_f32 v66, v66
 v_mfma_f32_16x16x32_bf16 v[34:37], v[228:231], v[54:57], v[34:37]
 v_mul_f32 v66, v66, v10
 s_waitcnt lgkmcnt(1)
 v_mfma_f32_16x16x32_bf16 v[26:29], v[232:235], v[58:61], v[26:29]
 ds_read_b128 v[54:57], v132 offset:50752
 v_mfma_f32_16x16x32_bf16 v[30:33], v[236:239], v[58:61], v[30:33]
 v_rcp_f32 v67, v67
 v_mfma_f32_16x16x32_bf16 v[34:37], v[240:243], v[58:61], v[34:37]
 v_rcp_f32 v68, v68
 v_mfma_f32_16x16x32_bf16 v[26:29], v[244:247], v[62:65], v[26:29]
 ds_read_b128 v[58:61], v132 offset:50816
 v_mul_f32_e64 v67, v67, v11
 v_mfma_f32_16x16x32_bf16 v[30:33], v[248:251], v[62:65], v[30:33]
 v_rcp_f32_e64 v69, v69
 v_mfma_f32_16x16x32_bf16 v[34:37], v[252:255], v[62:65], v[34:37]
 v_mul_f32 v68, v68, v12
 v_mul_f32_e64 v69, v69, v13
 s_waitcnt lgkmcnt(1)
 v_mfma_f32_16x16x32_bf16 v[38:41], a[176:179], v[50:53], v[120:123]
 ds_read_b128 v[62:65], v132 offset:50880
 v_cvt_pk_bf16_f32 v66, v66, v67
 v_mfma_f32_16x16x32_bf16 v[42:45], a[180:183], v[50:53], v[124:127]
 v_cvt_pk_bf16_f32 v67, v68, v69
 ds_write_b64 v133, v[66:67] offset:64
 v_mfma_f32_16x16x32_bf16 v[46:49], a[184:187], v[50:53], v[128:131]
 v_mul_f32_e64 v70, v14, v14
 v_mul_f32_e64 v71, v15, v15
 v_mfma_f32_16x16x32_bf16 v[38:41], a[188:191], v[54:57], v[38:41]
 ds_read_b128 v[50:53], v132 offset:50944
 v_mul_f32_e64 v72, v16, v16
 v_mfma_f32_16x16x32_bf16 v[42:45], a[192:195], v[54:57], v[42:45]
 v_mul_f32 v73, v17, v17
 v_fma_f32 v70, v70, s100, v140
 v_mfma_f32_16x16x32_bf16 v[46:49], a[196:199], v[54:57], v[46:49]
 v_fma_f32 v71, v71, s100, v140
 s_waitcnt lgkmcnt(2)
 v_mfma_f32_16x16x32_bf16 v[38:41], a[200:203], v[58:61], v[38:41]
 ds_read_b128 v[54:57], v132 offset:51008
 v_fma_f32 v72, v72, s100, v140
 v_mfma_f32_16x16x32_bf16 v[42:45], a[204:207], v[58:61], v[42:45]
 v_fma_f32 v73, v73, s100, v140
 v_mul_f32 v70, v70, v14
 v_mfma_f32_16x16x32_bf16 v[46:49], a[208:211], v[58:61], v[46:49]
 v_mul_f32 v71, v71, v15
 v_mul_f32_e64 v72, v72, v16
 v_mfma_f32_16x16x32_bf16 v[38:41], a[212:215], v[62:65], v[38:41]
 ds_read_b128 v[58:61], v132 offset:51072
 v_mul_f32 v73, v73, v17
 v_mfma_f32_16x16x32_bf16 v[42:45], a[216:219], v[62:65], v[42:45]
 v_exp_f32 v70, v70
 v_mfma_f32_16x16x32_bf16 v[46:49], a[220:223], v[62:65], v[46:49]
 v_add_f32 v70, 1.0, v70
 s_waitcnt lgkmcnt(1)
 v_mfma_f32_16x16x32_bf16 v[38:41], a[224:227], v[50:53], v[38:41]
 ds_read_b128 v[62:65], v132 offset:51136
 v_mfma_f32_16x16x32_bf16 v[42:45], a[228:231], v[50:53], v[42:45]
 v_exp_f32 v71, v71
 v_mfma_f32_16x16x32_bf16 v[46:49], a[232:235], v[50:53], v[46:49]
 v_exp_f32 v72, v72
 v_mfma_f32_16x16x32_bf16 v[38:41], a[236:239], v[54:57], v[38:41]
 ds_read_b128 v[50:53], v132 offset:51200
 v_add_f32 v71, 1.0, v71
 v_mfma_f32_16x16x32_bf16 v[42:45], a[240:243], v[54:57], v[42:45]
 v_exp_f32 v73, v73
 v_mfma_f32_16x16x32_bf16 v[46:49], a[244:247], v[54:57], v[46:49]
 v_add_f32 v72, 1.0, v72
 s_waitcnt lgkmcnt(1)
 v_mfma_f32_16x16x32_bf16 v[38:41], a[248:251], v[58:61], v[38:41]
 ds_read_b128 v[54:57], v132 offset:51264
 v_add_f32_e64 v73, 1.0, v73
 v_mfma_f32_16x16x32_bf16 v[42:45], a[252:255], v[58:61], v[42:45]
 v_rcp_f32 v70, v70
 v_mfma_f32_16x16x32_bf16 v[46:49], v[144:147], v[58:61], v[46:49]
 v_rcp_f32 v71, v71
 v_mfma_f32_16x16x32_bf16 v[38:41], v[148:151], v[62:65], v[38:41]
 ds_read_b128 v[58:61], v132 offset:51328
 v_mul_f32 v70, v70, v14
 v_mfma_f32_16x16x32_bf16 v[42:45], v[152:155], v[62:65], v[42:45]
 v_rcp_f32 v72, v72
 v_mfma_f32_16x16x32_bf16 v[46:49], v[156:159], v[62:65], v[46:49]
 v_mul_f32 v71, v71, v15
 s_waitcnt lgkmcnt(1)
 v_mfma_f32_16x16x32_bf16 v[38:41], v[160:163], v[50:53], v[38:41]
 ds_read_b128 v[62:65], v132 offset:51392
 v_mul_f32_e64 v72, v72, v16
 v_mfma_f32_16x16x32_bf16 v[42:45], v[164:167], v[50:53], v[42:45]
 v_rcp_f32 v73, v73
 v_mfma_f32_16x16x32_bf16 v[46:49], v[168:171], v[50:53], v[46:49]
 v_mul_f32 v73, v73, v17
 v_cvt_pk_bf16_f32 v70, v70, v71
 v_mfma_f32_16x16x32_bf16 v[38:41], v[172:175], v[54:57], v[38:41]
 ds_read_b128 v[50:53], v132 offset:51456
 v_cvt_pk_bf16_f32 v71, v72, v73
 v_mfma_f32_16x16x32_bf16 v[42:45], v[176:179], v[54:57], v[42:45]
 ds_write_b64 v133, v[70:71] offset:6400
 v_mul_f32 v66, v18, v18
 v_mfma_f32_16x16x32_bf16 v[46:49], v[180:183], v[54:57], v[46:49]
 v_mul_f32_e64 v67, v19, v19
 s_waitcnt lgkmcnt(2)
 v_mfma_f32_16x16x32_bf16 v[38:41], v[184:187], v[58:61], v[38:41]
 ds_read_b128 v[54:57], v132 offset:51520
 v_mul_f32 v68, v20, v20
 v_mfma_f32_16x16x32_bf16 v[42:45], v[188:191], v[58:61], v[42:45]
 v_mul_f32 v69, v21, v21
 v_fma_f32 v66, v66, s100, v140
 v_mfma_f32_16x16x32_bf16 v[46:49], v[192:195], v[58:61], v[46:49]
 v_fma_f32 v67, v67, s100, v140
 v_fma_f32 v68, v68, s100, v140
 v_mfma_f32_16x16x32_bf16 v[38:41], v[196:199], v[62:65], v[38:41]
 ds_read_b128 v[58:61], v132 offset:51584
 v_fma_f32 v69, v69, s100, v140
 v_mfma_f32_16x16x32_bf16 v[42:45], v[200:203], v[62:65], v[42:45]
 v_mul_f32 v66, v66, v18
 v_mul_f32 v67, v67, v19
 v_mfma_f32_16x16x32_bf16 v[46:49], v[204:207], v[62:65], v[46:49]
 v_mul_f32 v68, v68, v20
 s_waitcnt lgkmcnt(1)
 v_mfma_f32_16x16x32_bf16 v[38:41], v[208:211], v[50:53], v[38:41]
 ds_read_b128 v[62:65], v132 offset:51648
 v_mul_f32 v69, v69, v21
 v_mfma_f32_16x16x32_bf16 v[42:45], v[212:215], v[50:53], v[42:45]
 v_exp_f32 v66, v66
 v_mfma_f32_16x16x32_bf16 v[46:49], v[216:219], v[50:53], v[46:49]
 v_exp_f32 v67, v67
 v_mfma_f32_16x16x32_bf16 v[38:41], v[220:223], v[54:57], v[38:41]
 v_exp_f32 v68, v68
 v_mfma_f32_16x16x32_bf16 v[42:45], v[224:227], v[54:57], v[42:45]
 v_exp_f32_e64 v69, v69
 v_mfma_f32_16x16x32_bf16 v[46:49], v[228:231], v[54:57], v[46:49]
 v_add_f32 v66, 1.0, v66
 s_waitcnt lgkmcnt(0)
 v_mfma_f32_16x16x32_bf16 v[38:41], v[232:235], v[58:61], v[38:41]
 v_add_f32 v67, 1.0, v67
 v_add_f32 v68, 1.0, v68
 v_mfma_f32_16x16x32_bf16 v[42:45], v[236:239], v[58:61], v[42:45]
 v_add_f32 v69, 1.0, v69
 v_mfma_f32_16x16x32_bf16 v[46:49], v[240:243], v[58:61], v[46:49]
 v_rcp_f32 v66, v66
 v_mfma_f32_16x16x32_bf16 v[38:41], v[244:247], v[62:65], v[38:41]
 v_rcp_f32 v67, v67
 v_mfma_f32_16x16x32_bf16 v[42:45], v[248:251], v[62:65], v[42:45]
 v_rcp_f32 v68, v68
 v_mfma_f32_16x16x32_bf16 v[46:49], v[252:255], v[62:65], v[46:49]
 v_rcp_f32 v69, v69
 v_mul_f32 v66, v66, v18
 v_mul_f32 v67, v67, v19
 v_mul_f32 v68, v68, v20
 v_mul_f32_e64 v69, v69, v21
 v_cvt_pk_bf16_f32 v66, v66, v67
 v_cvt_pk_bf16_f32 v67, v68, v69
 ds_write_b64 v133, v[66:67] offset:6432
 v_pk_mul_f32 v[70:71], v[22:23], v[22:23]
 v_pk_mul_f32 v[72:73], v[24:25], v[24:25]
 v_pk_fma_f32 v[70:71], v[70:71], s[100:101], v[140:141] op_sel_hi:[1,0,0]
 v_pk_fma_f32 v[72:73], v[72:73], s[100:101], v[140:141] op_sel_hi:[1,0,0]
 v_pk_mul_f32 v[70:71], v[70:71], v[22:23]
 v_pk_mul_f32 v[72:73], v[72:73], v[24:25]
 v_exp_f32 v70, v70
 v_exp_f32 v71, v71
 v_exp_f32 v72, v72
 v_exp_f32 v73, v73
 v_pk_add_f32 v[70:71], v[70:71], 1.0 op_sel_hi:[1,0]
 v_pk_add_f32 v[72:73], v[72:73], 1.0 op_sel_hi:[1,0]
 v_rcp_f32 v70, v70
 v_rcp_f32 v71, v71
 v_rcp_f32 v72, v72
 v_rcp_f32_e64 v73, v73
 v_pk_mul_f32 v[70:71], v[70:71], v[22:23]
 v_pk_mul_f32 v[72:73], v[72:73], v[24:25]
 v_cvt_pk_bf16_f32 v70, v70, v71
 v_cvt_pk_bf16_f32 v71, v72, v73
 ds_write_b64 v133, v[70:71] offset:6464
 s_waitcnt lgkmcnt(0)
 s_barrier
 s_mov_b32 s88, s79
 s_add_u32 s89, s79, 0x1000
 ds_read_b128 v[74:77], v134 offset:0
 ds_read_b128 v[78:81], v134 offset:32
 ds_read_b128 v[82:85], v134 offset:64
 ds_read_b128 v[88:91], v134 offset:96
 ds_read_b128 v[92:95], v134 offset:128
 v_pk_mul_f32 v[66:67], v[26:27], v[26:27]
 v_pk_mul_f32 v[68:69], v[28:29], v[28:29]
 v_pk_fma_f32 v[66:67], v[66:67], s[100:101], v[140:141] op_sel_hi:[1,0,0]
 v_pk_fma_f32 v[68:69], v[68:69], s[100:101], v[140:141] op_sel_hi:[1,0,0]
 v_pk_mul_f32 v[66:67], v[66:67], v[26:27]
 v_pk_mul_f32 v[68:69], v[68:69], v[28:29]
 v_exp_f32 v66, v66
 v_exp_f32 v67, v67
 v_exp_f32 v68, v68
 v_exp_f32 v69, v69
 v_pk_add_f32 v[66:67], v[66:67], 1.0 op_sel_hi:[1,0]
 v_pk_add_f32 v[68:69], v[68:69], 1.0 op_sel_hi:[1,0]
 v_rcp_f32 v66, v66
 v_rcp_f32 v67, v67
 v_rcp_f32_e64 v68, v68
 v_rcp_f32_e64 v69, v69
 v_pk_mul_f32 v[66:67], v[66:67], v[26:27]
 v_pk_mul_f32 v[68:69], v[68:69], v[28:29]
 v_cvt_pk_bf16_f32 v66, v66, v67
 v_cvt_pk_bf16_f32 v67, v68, v69
 ds_write_b64 v133, v[66:67] offset:12800
 s_waitcnt lgkmcnt(4)
 v_mfma_f32_32x32x16_bf16 v[2:17], a[128:131], v[74:77], 0
 ds_read_b128 v[96:99], v134 offset:160
 v_mul_f32 v70, v30, v30
 v_mul_f32 v71, v31, v31
 v_mul_f32 v72, v32, v32
 v_mul_f32_e64 v73, v33, v33
 v_fma_f32 v70, v70, s100, v140
 v_mfma_f32_32x32x16_bf16 v[2:17], a[144:147], v[78:81], v[2:17]
 ds_read_b128 v[74:77], v134 offset:192
 v_fma_f32 v71, v71, s100, v140
 v_fma_f32 v72, v72, s100, v140
 v_fma_f32 v73, v73, s100, v140
 v_mul_f32 v70, v70, v30
 s_waitcnt lgkmcnt(4)
 v_mfma_f32_32x32x16_bf16 v[2:17], a[160:163], v[82:85], v[2:17]
 ds_read_b128 v[78:81], v134 offset:224
 v_mul_f32 v71, v71, v31
 v_mul_f32 v72, v72, v32
 v_mul_f32 v73, v73, v33
 v_exp_f32 v70, v70
 v_mfma_f32_32x32x16_bf16 v[2:17], a[0:3], v[88:91], v[2:17]
 ds_read_b128 v[82:85], v134 offset:256
 v_exp_f32 v71, v71
 v_exp_f32_e64 v72, v72
 s_waitcnt lgkmcnt(3)
 v_mfma_f32_32x32x16_bf16 v[2:17], a[4:7], v[92:95], v[2:17]
 ds_read_b128 v[88:91], v134 offset:288
 v_exp_f32 v73, v73
 v_add_f32 v70, 1.0, v70
 v_add_f32 v71, 1.0, v71
 v_add_f32 v72, 1.0, v72
 v_mfma_f32_32x32x16_bf16 v[2:17], a[8:11], v[96:99], v[2:17]
 ds_read_b128 v[92:95], v134 offset:320
 v_add_f32 v73, 1.0, v73
 v_rcp_f32_e64 v70, v70
 s_waitcnt lgkmcnt(3)
 v_mfma_f32_32x32x16_bf16 v[2:17], a[12:15], v[74:77], v[2:17]
 ds_read_b128 v[96:99], v134 offset:0
 v_rcp_f32 v71, v71
 v_rcp_f32 v72, v72
 v_mul_f32_e64 v70, v70, v30
 v_mfma_f32_32x32x16_bf16 v[2:17], a[16:19], v[78:81], v[2:17]
 ds_read_b128 v[74:77], v134 offset:32
 v_rcp_f32 v73, v73
 v_mul_f32 v71, v71, v31
 v_mul_f32 v72, v72, v32
 s_waitcnt lgkmcnt(3)
 v_mfma_f32_32x32x16_bf16 v[2:17], a[20:23], v[82:85], v[2:17]
 ds_read_b128 v[78:81], v134 offset:64
 v_mul_f32_e64 v73, v73, v33
 v_cvt_pk_bf16_f32 v70, v70, v71
 v_cvt_pk_bf16_f32 v71, v72, v73
 ds_write_b64 v133, v[70:71] offset:12832
 v_mul_f32_e64 v66, v34, v34
 v_mfma_f32_32x32x16_bf16 v[2:17], a[24:27], v[88:91], v[2:17]
 ds_read_b128 v[82:85], v134 offset:96
 v_mul_f32 v67, v35, v35
 v_mul_f32 v68, v36, v36
 v_mul_f32 v69, v37, v37
 v_fma_f32 v66, v66, s100, v140
 s_waitcnt lgkmcnt(4)
 v_mfma_f32_32x32x16_bf16 v[2:17], a[28:31], v[92:95], v[2:17]
 ds_read_b128 v[88:91], v134 offset:128
 v_fma_f32 v67, v67, s100, v140
 v_fma_f32 v68, v68, s100, v140
 v_fma_f32 v69, v69, s100, v140
 v_mul_f32 v66, v66, v34
 v_mul_f32 v67, v67, v35
 v_mfma_f32_32x32x16_bf16 v[50:65], a[132:135], v[96:99], 0
 ds_read_b128 v[92:95], v134 offset:160
 v_mul_f32 v68, v68, v36
 v_mul_f32 v69, v69, v37
 v_exp_f32 v66, v66
 s_waitcnt lgkmcnt(4)
 v_mfma_f32_32x32x16_bf16 v[50:65], a[148:151], v[74:77], v[50:65]
 ds_read_b128 v[96:99], v134 offset:192
 v_exp_f32 v67, v67
 v_exp_f32 v68, v68
 v_add_f32_e64 v66, 1.0, v66
 v_mfma_f32_32x32x16_bf16 v[50:65], a[164:167], v[78:81], v[50:65]
 ds_read_b128 v[74:77], v134 offset:224
 v_cvt_pk_bf16_f32 v18, v2, v3
 v_cvt_pk_bf16_f32 v19, v4, v5
 v_cvt_pk_bf16_f32 v20, v6, v7
 v_cvt_pk_bf16_f32 v21, v8, v9
 s_waitcnt lgkmcnt(3)
 v_mfma_f32_32x32x16_bf16 v[50:65], a[32:35], v[82:85], v[50:65]
 ds_read_b128 v[78:81], v134 offset:256
 v_permlane32_swap_b32 v18, v20
 v_permlane32_swap_b32 v19, v21
 v_add_f32 v67, 1.0, v67
 v_mfma_f32_32x32x16_bf16 v[50:65], a[36:39], v[88:91], v[50:65]
 ds_read_b128 v[82:85], v134 offset:288
 v_exp_f32_e64 v69, v69
 v_add_f32_e64 v68, 1.0, v68
 v_add_f32 v69, 1.0, v69
 s_waitcnt lgkmcnt(3)
 v_mfma_f32_32x32x16_bf16 v[50:65], a[40:43], v[92:95], v[50:65]
 ds_read_b128 v[88:91], v134 offset:320
 buffer_store_dwordx4 v[18:21], v135, s[60:63], s88 offen offset:0 sc0 sc1
 v_rcp_f32_e64 v66, v66
 v_rcp_f32_e64 v67, v67
 v_mfma_f32_32x32x16_bf16 v[50:65], a[44:47], v[96:99], v[50:65]
 ds_read_b128 v[92:95], v134 offset:0
 v_rcp_f32 v68, v68
 v_rcp_f32_e64 v69, v69
 s_waitcnt lgkmcnt(3)
 v_mfma_f32_32x32x16_bf16 v[50:65], a[48:51], v[74:77], v[50:65]
 ds_read_b128 v[96:99], v134 offset:32
 v_cvt_pk_bf16_f32 v22, v10, v11
 v_cvt_pk_bf16_f32 v23, v12, v13
 v_cvt_pk_bf16_f32 v24, v14, v15
 v_cvt_pk_bf16_f32 v25, v16, v17
 v_mul_f32 v66, v66, v34
 v_mfma_f32_32x32x16_bf16 v[50:65], a[52:55], v[78:81], v[50:65]
 ds_read_b128 v[74:77], v134 offset:64
 v_permlane32_swap_b32 v22, v24
 v_permlane32_swap_b32 v23, v25
 s_waitcnt lgkmcnt(3)
 v_mfma_f32_32x32x16_bf16 v[50:65], a[56:59], v[82:85], v[50:65]
 ds_read_b128 v[78:81], v134 offset:96
 v_mul_f32 v67, v67, v35
 v_mul_f32 v68, v68, v36
 v_mul_f32_e64 v69, v69, v37
 v_cvt_pk_bf16_f32 v66, v66, v67
 v_cvt_pk_bf16_f32 v67, v68, v69
 v_mfma_f32_32x32x16_bf16 v[50:65], a[60:63], v[88:91], v[50:65]
 ds_read_b128 v[82:85], v134 offset:128
 buffer_store_dwordx4 v[22:25], v135, s[60:63], s88 offen offset:128 sc0 sc1
 ds_write_b64 v133, v[66:67] offset:12864
 v_mul_f32 v70, v38, v38
 v_mul_f32 v71, v39, v39
 v_mul_f32 v72, v40, v40
 s_waitcnt lgkmcnt(4)
 v_mfma_f32_32x32x16_bf16 v[2:17], a[136:139], v[92:95], 0
 ds_read_b128 v[88:91], v134 offset:160
 v_mul_f32_e64 v73, v41, v41
 v_fma_f32 v70, v70, s100, v140
 v_fma_f32 v71, v71, s100, v140
 v_fma_f32 v72, v72, s100, v140
 v_fma_f32 v73, v73, s100, v140
 v_mfma_f32_32x32x16_bf16 v[2:17], a[152:155], v[96:99], v[2:17]
 ds_read_b128 v[92:95], v134 offset:192
 v_mul_f32 v70, v70, v38
 v_mul_f32 v71, v71, v39
 v_mul_f32 v72, v72, v40
 v_mul_f32_e64 v73, v73, v41
 s_waitcnt lgkmcnt(4)
 v_mfma_f32_32x32x16_bf16 v[2:17], a[168:171], v[74:77], v[2:17]
 ds_read_b128 v[96:99], v134 offset:224
 v_cvt_pk_bf16_f32 v18, v50, v51
 v_cvt_pk_bf16_f32 v19, v52, v53
 v_cvt_pk_bf16_f32 v20, v54, v55
 v_cvt_pk_bf16_f32 v21, v56, v57
 v_mfma_f32_32x32x16_bf16 v[2:17], a[64:67], v[78:81], v[2:17]
 ds_read_b128 v[74:77], v134 offset:256
 v_permlane32_swap_b32 v18, v20
 v_permlane32_swap_b32 v19, v21
 s_waitcnt lgkmcnt(3)
 v_mfma_f32_32x32x16_bf16 v[2:17], a[68:71], v[82:85], v[2:17]
 ds_read_b128 v[78:81], v134 offset:288
 v_exp_f32 v70, v70
 v_exp_f32 v71, v71
 v_add_f32 v70, 1.0, v70
 v_mfma_f32_32x32x16_bf16 v[2:17], a[72:75], v[88:91], v[2:17]
 ds_read_b128 v[82:85], v134 offset:320
 buffer_store_dwordx4 v[18:21], v135, s[60:63], s88 offen offset:256 sc0 sc1
 v_exp_f32 v72, v72
 v_add_f32_e64 v71, 1.0, v71
 s_waitcnt lgkmcnt(3)
 v_mfma_f32_32x32x16_bf16 v[2:17], a[76:79], v[92:95], v[2:17]
 ds_read_b128 v[88:91], v134 offset:0
 v_exp_f32_e64 v73, v73
 v_add_f32_e64 v72, 1.0, v72
 v_add_f32_e64 v73, 1.0, v73
 v_mfma_f32_32x32x16_bf16 v[2:17], a[80:83], v[96:99], v[2:17]
 ds_read_b128 v[92:95], v134 offset:32
 v_cvt_pk_bf16_f32 v22, v58, v59
 v_cvt_pk_bf16_f32 v23, v60, v61
 v_cvt_pk_bf16_f32 v24, v62, v63
 v_cvt_pk_bf16_f32 v25, v64, v65
 s_waitcnt lgkmcnt(3)
 v_mfma_f32_32x32x16_bf16 v[2:17], a[84:87], v[74:77], v[2:17]
 ds_read_b128 v[96:99], v134 offset:64
 v_permlane32_swap_b32 v22, v24
 v_permlane32_swap_b32 v23, v25
 v_mfma_f32_32x32x16_bf16 v[2:17], a[88:91], v[78:81], v[2:17]
 ds_read_b128 v[74:77], v134 offset:96
 v_rcp_f32 v70, v70
 v_rcp_f32 v71, v71
 s_waitcnt lgkmcnt(3)
 v_mfma_f32_32x32x16_bf16 v[2:17], a[92:95], v[82:85], v[2:17]
 ds_read_b128 v[78:81], v134 offset:128
 buffer_store_dwordx4 v[22:25], v135, s[60:63], s88 offen offset:384 sc0 sc1
 v_rcp_f32 v72, v72
 v_rcp_f32 v73, v73
 v_mfma_f32_32x32x16_bf16 v[50:65], a[140:143], v[88:91], 0
 ds_read_b128 v[82:85], v134 offset:160
 v_mul_f32 v70, v70, v38
 v_mul_f32 v71, v71, v39
 v_mul_f32_e64 v72, v72, v40
 v_mul_f32 v73, v73, v41
 s_waitcnt lgkmcnt(3)
 v_mfma_f32_32x32x16_bf16 v[50:65], a[156:159], v[92:95], v[50:65]
 ds_read_b128 v[88:91], v134 offset:192
 v_cvt_pk_bf16_f32 v70, v70, v71
 v_cvt_pk_bf16_f32 v71, v72, v73
 ds_write_b64 v133, v[70:71] offset:19200
 v_mul_f32 v66, v42, v42
 v_mul_f32 v67, v43, v43
 v_mfma_f32_32x32x16_bf16 v[50:65], a[172:175], v[96:99], v[50:65]
 ds_read_b128 v[92:95], v134 offset:224
 v_cvt_pk_bf16_f32 v18, v2, v3
 v_cvt_pk_bf16_f32 v19, v4, v5
 v_cvt_pk_bf16_f32 v20, v6, v7
 v_cvt_pk_bf16_f32 v21, v8, v9
 s_waitcnt lgkmcnt(4)
 v_mfma_f32_32x32x16_bf16 v[50:65], a[96:99], v[74:77], v[50:65]
 ds_read_b128 v[96:99], v134 offset:256
 v_permlane32_swap_b32 v18, v20
 v_permlane32_swap_b32 v19, v21
 v_mul_f32 v68, v44, v44
 v_mfma_f32_32x32x16_bf16 v[50:65], a[100:103], v[78:81], v[50:65]
 ds_read_b128 v[74:77], v134 offset:288
 v_mul_f32 v69, v45, v45
 v_fma_f32 v66, v66, s100, v140
 v_fma_f32 v67, v67, s100, v140
 v_fma_f32 v68, v68, s100, v140
 s_waitcnt lgkmcnt(4)
 v_mfma_f32_32x32x16_bf16 v[50:65], a[104:107], v[82:85], v[50:65]
 ds_read_b128 v[78:81], v134 offset:320
 buffer_store_dwordx4 v[18:21], v135, s[60:63], s88 offen offset:512 sc0 sc1
 v_fma_f32 v69, v69, s100, v140
 v_mul_f32 v66, v66, v42
 v_mul_f32 v67, v67, v43
 v_mul_f32 v68, v68, v44
 v_mfma_f32_32x32x16_bf16 v[50:65], a[108:111], v[88:91], v[50:65]
 v_mul_f32 v69, v69, v45
 v_exp_f32 v66, v66
 v_exp_f32_e64 v67, v67
 s_waitcnt lgkmcnt(2)
 v_mfma_f32_32x32x16_bf16 v[50:65], a[112:115], v[92:95], v[50:65]
 v_cvt_pk_bf16_f32 v22, v10, v11
 v_cvt_pk_bf16_f32 v23, v12, v13
 v_cvt_pk_bf16_f32 v24, v14, v15
 v_cvt_pk_bf16_f32 v25, v16, v17
 v_exp_f32 v68, v68
 v_mfma_f32_32x32x16_bf16 v[50:65], a[116:119], v[96:99], v[50:65]
 v_permlane32_swap_b32 v22, v24
 v_permlane32_swap_b32 v23, v25
 v_add_f32 v66, 1.0, v66
 s_waitcnt lgkmcnt(0)
 v_mfma_f32_32x32x16_bf16 v[50:65], a[120:123], v[74:77], v[50:65]
 v_exp_f32 v69, v69
 v_add_f32 v67, 1.0, v67
 v_add_f32 v68, 1.0, v68
 v_add_f32_e64 v69, 1.0, v69
 v_mfma_f32_32x32x16_bf16 v[50:65], a[124:127], v[78:81], v[50:65]
 buffer_store_dwordx4 v[22:25], v135, s[60:63], s88 offen offset:640 sc0 sc1
 v_rcp_f32 v66, v66
 v_rcp_f32 v67, v67
 v_mul_f32 v66, v66, v42
 v_rcp_f32 v68, v68
 v_rcp_f32 v69, v69
 v_mul_f32 v67, v67, v43
 v_mul_f32 v68, v68, v44
 v_mul_f32 v69, v69, v45
 v_cvt_pk_bf16_f32 v66, v66, v67
 v_cvt_pk_bf16_f32 v67, v68, v69
 ds_write_b64 v133, v[66:67] offset:19232
 v_pk_mul_f32 v[70:71], v[46:47], v[46:47]
 v_pk_mul_f32 v[72:73], v[48:49], v[48:49]
 v_pk_fma_f32 v[70:71], v[70:71], s[100:101], v[140:141] op_sel_hi:[1,0,0]
 v_pk_fma_f32 v[72:73], v[72:73], s[100:101], v[140:141] op_sel_hi:[1,0,0]
 v_pk_mul_f32 v[70:71], v[70:71], v[46:47]
 v_pk_mul_f32 v[72:73], v[72:73], v[48:49]
 v_exp_f32 v70, v70
 v_exp_f32 v71, v71
 v_exp_f32 v72, v72
 v_exp_f32 v73, v73
 v_pk_add_f32 v[70:71], v[70:71], 1.0 op_sel_hi:[1,0]
 v_pk_add_f32 v[72:73], v[72:73], 1.0 op_sel_hi:[1,0]
 v_rcp_f32 v70, v70
 v_rcp_f32 v71, v71
 v_rcp_f32 v72, v72
 v_rcp_f32 v73, v73
 v_pk_mul_f32 v[70:71], v[70:71], v[46:47]
 v_pk_mul_f32 v[72:73], v[72:73], v[48:49]
 v_cvt_pk_bf16_f32 v70, v70, v71
 v_cvt_pk_bf16_f32 v71, v72, v73
 ds_write_b64 v133, v[70:71] offset:19264
 s_waitcnt lgkmcnt(0)
 s_barrier
 ds_read_b128 v[74:77], v134 offset:12800
 ds_read_b128 v[78:81], v134 offset:12832
 ds_read_b128 v[82:85], v134 offset:12864
 ds_read_b128 v[26:29], v134 offset:12896
 ds_read_b128 v[30:33], v134 offset:12928
 s_waitcnt lgkmcnt(3)
 v_mfma_f32_32x32x16_bf16 v[2:17], a[128:131], v[74:77], 0
 ds_read_b128 v[34:37], v134 offset:12960
 v_cvt_pk_bf16_f32 v18, v50, v51
 v_cvt_pk_bf16_f32 v19, v52, v53
 v_cvt_pk_bf16_f32 v20, v54, v55
 v_cvt_pk_bf16_f32 v21, v56, v57
 v_and_b32_e64 v38, 15, v1
 v_mfma_f32_32x32x16_bf16 v[2:17], a[144:147], v[78:81], v[2:17]
 ds_read_b128 v[74:77], v134 offset:12992
 v_permlane32_swap_b32 v18, v20
 v_permlane32_swap_b32 v19, v21
 s_waitcnt lgkmcnt(3)
 v_mfma_f32_32x32x16_bf16 v[2:17], a[160:163], v[82:85], v[2:17]
 ds_read_b128 v[78:81], v134 offset:13024
 v_and_b32_e64 v39, 1, v1
 v_lshlrev_b32_e64 v39, 4, v39
 v_mov_b32 v40, 0x3f80
 v_lshlrev_b32_e64 v39, v39, v40
 v_lshrrev_b32_e64 v38, 1, v38
 v_mfma_f32_32x32x16_bf16 v[2:17], a[0:3], v[26:29], v[2:17]
 ds_read_b128 v[82:85], v134 offset:13056
 buffer_store_dwordx4 v[18:21], v135, s[60:63], s88 offen offset:768 sc0 sc1
 v_cmp_eq_u32 vcc, 0, v38
 v_cmp_eq_u32 s[92:93], 1, v38
 v_mov_b32_e64 v41, 0
 s_waitcnt lgkmcnt(3)
 v_mfma_f32_32x32x16_bf16 v[2:17], a[4:7], v[30:33], v[2:17]
 ds_read_b128 v[26:29], v134 offset:13088
 v_cndmask_b32 v88, 0, v39, vcc
 v_cndmask_b32 v89, 0, v39, s[92:93]
 v_cmp_eq_u32 vcc, 2, v38
 v_cmp_eq_u32 s[92:93], 3, v38
 v_mov_b32_e64 v41, 0
 v_mfma_f32_32x32x16_bf16 v[2:17], a[8:11], v[34:37], v[2:17]
 ds_read_b128 v[30:33], v134 offset:13120
 v_cvt_pk_bf16_f32 v22, v58, v59
 v_cvt_pk_bf16_f32 v23, v60, v61
 v_cvt_pk_bf16_f32 v24, v62, v63
 v_cvt_pk_bf16_f32 v25, v64, v65
 s_waitcnt lgkmcnt(3)
 v_mfma_f32_32x32x16_bf16 v[2:17], a[12:15], v[74:77], v[2:17]
 ds_read_b128 v[34:37], v134 offset:12800
 v_permlane32_swap_b32 v22, v24
 v_permlane32_swap_b32 v23, v25
 v_cndmask_b32 v90, 0, v39, vcc
 v_mfma_f32_32x32x16_bf16 v[2:17], a[16:19], v[78:81], v[2:17]
 ds_read_b128 v[74:77], v134 offset:12832
 v_cndmask_b32 v91, 0, v39, s[92:93]
 v_cmp_eq_u32 vcc, 4, v38
 v_cmp_eq_u32 s[92:93], 5, v38
 v_mov_b32_e64 v41, 0
 s_waitcnt lgkmcnt(3)
 v_mfma_f32_32x32x16_bf16 v[2:17], a[20:23], v[82:85], v[2:17]
 ds_read_b128 v[78:81], v134 offset:12864
 buffer_store_dwordx4 v[22:25], v135, s[60:63], s88 offen offset:896 sc0 sc1
 v_cndmask_b32 v92, 0, v39, vcc
 v_cndmask_b32 v93, 0, v39, s[92:93]
 v_cmp_eq_u32 vcc, 6, v38
 v_cmp_eq_u32 s[92:93], 7, v38
 v_mfma_f32_32x32x16_bf16 v[2:17], a[24:27], v[26:29], v[2:17]
 ds_read_b128 v[82:85], v134 offset:12896
 v_mov_b32 v41, 0
 v_cndmask_b32 v94, 0, v39, vcc
 v_cndmask_b32 v95, 0, v39, s[92:93]
 s_mul_i32 s14, s3, 2080
 s_waitcnt lgkmcnt(3)
 v_mfma_f32_32x32x16_bf16 v[2:17], a[28:31], v[30:33], v[2:17]
 ds_read_b128 v[26:29], v134 offset:12928
 s_add_u32 s14, s14, 67584
 v_lshl_add_u32 v96, v1, 5, s14
 v_mfma_f32_32x32x16_bf16 v[50:65], a[132:135], v[34:37], 0
 ds_read_b128 v[30:33], v134 offset:12960
 s_waitcnt lgkmcnt(3)
 v_mfma_f32_32x32x16_bf16 v[50:65], a[148:151], v[74:77], v[50:65]
 ds_read_b128 v[34:37], v134 offset:12992
 v_mfma_f32_32x32x16_bf16 v[50:65], a[164:167], v[78:81], v[50:65]
 ds_read_b128 v[74:77], v134 offset:13024
 s_nop 1
 v_cvt_pk_bf16_f32 v18, v2, v3
 v_cvt_pk_bf16_f32 v19, v4, v5
 v_cvt_pk_bf16_f32 v20, v6, v7
 v_cvt_pk_bf16_f32 v21, v8, v9
 s_waitcnt lgkmcnt(3)
 v_mfma_f32_32x32x16_bf16 v[50:65], a[32:35], v[82:85], v[50:65]
 ds_read_b128 v[78:81], v134 offset:13056
 v_permlane32_swap_b32 v18, v20
 v_permlane32_swap_b32 v19, v21
 v_mfma_f32_32x32x16_bf16 v[50:65], a[36:39], v[26:29], v[50:65]
 ds_read_b128 v[82:85], v134 offset:13088
 s_waitcnt lgkmcnt(3)
 v_mfma_f32_32x32x16_bf16 v[50:65], a[40:43], v[30:33], v[50:65]
 ds_read_b128 v[26:29], v134 offset:13120
 buffer_store_dwordx4 v[18:21], v135, s[60:63], s89 offen offset:0 sc0 sc1
 v_mfma_f32_32x32x16_bf16 v[50:65], a[44:47], v[34:37], v[50:65]
 ds_read_b128 v[30:33], v134 offset:12800
 s_waitcnt lgkmcnt(3)
 v_mfma_f32_32x32x16_bf16 v[50:65], a[48:51], v[74:77], v[50:65]
 ds_read_b128 v[34:37], v134 offset:12832
 v_cvt_pk_bf16_f32 v22, v10, v11
 v_cvt_pk_bf16_f32 v23, v12, v13
 v_cvt_pk_bf16_f32 v24, v14, v15
 v_cvt_pk_bf16_f32 v25, v16, v17
 v_mfma_f32_32x32x16_bf16 v[50:65], a[52:55], v[78:81], v[50:65]
 ds_read_b128 v[74:77], v134 offset:12864
 v_permlane32_swap_b32 v22, v24
 v_permlane32_swap_b32 v23, v25
 s_waitcnt lgkmcnt(3)
 v_mfma_f32_32x32x16_bf16 v[50:65], a[56:59], v[82:85], v[50:65]
 ds_read_b128 v[78:81], v134 offset:12896
 v_mfma_f32_32x32x16_bf16 v[50:65], a[60:63], v[26:29], v[50:65]
 ds_read_b128 v[82:85], v134 offset:12928
 buffer_store_dwordx4 v[22:25], v135, s[60:63], s89 offen offset:128 sc0 sc1
 s_waitcnt lgkmcnt(3)
 v_mfma_f32_32x32x16_bf16 v[2:17], a[136:139], v[30:33], 0
 ds_read_b128 v[26:29], v134 offset:12960
 s_lshl_b32 s14, s9, 2
 s_add_u32 s14, s14, s82
 s_waitcnt vmcnt(2)
 buffer_store_dword v143, off, s[60:63], s14 offset:0 sc0 sc1
 v_mfma_f32_32x32x16_bf16 v[2:17], a[152:155], v[34:37], v[2:17]
 ds_read_b128 v[30:33], v134 offset:12992
 s_waitcnt lgkmcnt(3)
 v_mfma_f32_32x32x16_bf16 v[2:17], a[168:171], v[74:77], v[2:17]
 ds_read_b128 v[34:37], v134 offset:13024
 v_cvt_pk_bf16_f32 v18, v50, v51
 v_cvt_pk_bf16_f32 v19, v52, v53
 v_cvt_pk_bf16_f32 v20, v54, v55
 v_cvt_pk_bf16_f32 v21, v56, v57
 v_mfma_f32_32x32x16_bf16 v[2:17], a[64:67], v[78:81], v[2:17]
 ds_read_b128 v[74:77], v134 offset:13056
 v_permlane32_swap_b32 v18, v20
 v_permlane32_swap_b32 v19, v21
 s_waitcnt lgkmcnt(3)
 v_mfma_f32_32x32x16_bf16 v[2:17], a[68:71], v[82:85], v[2:17]
 ds_read_b128 v[78:81], v134 offset:13088
 v_mfma_f32_32x32x16_bf16 v[2:17], a[72:75], v[26:29], v[2:17]
 ds_read_b128 v[82:85], v134 offset:13120
 buffer_store_dwordx4 v[18:21], v135, s[60:63], s89 offen offset:256 sc0 sc1
 s_waitcnt lgkmcnt(3)
 v_mfma_f32_32x32x16_bf16 v[2:17], a[76:79], v[30:33], v[2:17]
 ds_read_b128 v[26:29], v134 offset:12800
 v_mfma_f32_32x32x16_bf16 v[2:17], a[80:83], v[34:37], v[2:17]
 ds_read_b128 v[30:33], v134 offset:12832
 v_cvt_pk_bf16_f32 v22, v58, v59
 v_cvt_pk_bf16_f32 v23, v60, v61
 v_cvt_pk_bf16_f32 v24, v62, v63
 v_cvt_pk_bf16_f32 v25, v64, v65
 s_waitcnt lgkmcnt(3)
 v_mfma_f32_32x32x16_bf16 v[2:17], a[84:87], v[74:77], v[2:17]
 ds_read_b128 v[34:37], v134 offset:12864
 v_permlane32_swap_b32 v22, v24
 v_permlane32_swap_b32 v23, v25
 v_mfma_f32_32x32x16_bf16 v[2:17], a[88:91], v[78:81], v[2:17]
 ds_read_b128 v[74:77], v134 offset:12896
 s_waitcnt lgkmcnt(3)
 v_mfma_f32_32x32x16_bf16 v[2:17], a[92:95], v[82:85], v[2:17]
 ds_read_b128 v[78:81], v134 offset:12928
 buffer_store_dwordx4 v[22:25], v135, s[60:63], s89 offen offset:384 sc0 sc1
 v_mfma_f32_32x32x16_bf16 v[50:65], a[140:143], v[26:29], 0
 ds_read_b128 v[82:85], v134 offset:12960
 s_waitcnt lgkmcnt(3)
 v_mfma_f32_32x32x16_bf16 v[50:65], a[156:159], v[30:33], v[50:65]
 ds_read_b128 v[26:29], v134 offset:12992
 v_mfma_f32_32x32x16_bf16 v[50:65], a[172:175], v[34:37], v[50:65]
 ds_read_b128 v[30:33], v134 offset:13024
 s_nop 2
 v_cvt_pk_bf16_f32 v18, v2, v3
 v_cvt_pk_bf16_f32 v19, v4, v5
 v_cvt_pk_bf16_f32 v20, v6, v7
 v_cvt_pk_bf16_f32 v21, v8, v9
 s_waitcnt lgkmcnt(3)
 v_mfma_f32_32x32x16_bf16 v[50:65], a[96:99], v[74:77], v[50:65]
 ds_read_b128 v[34:37], v134 offset:13056
 v_permlane32_swap_b32 v18, v20
 v_permlane32_swap_b32 v19, v21
 v_mfma_f32_32x32x16_bf16 v[50:65], a[100:103], v[78:81], v[50:65]
 ds_read_b128 v[74:77], v134 offset:13088
 buffer_load_dword v87, v142, s[60:63], s82 offen offset:0 sc0 sc1
 s_waitcnt lgkmcnt(3)
 v_mfma_f32_32x32x16_bf16 v[50:65], a[104:107], v[82:85], v[50:65]
 ds_read_b128 v[78:81], v134 offset:13120
 buffer_store_dwordx4 v[18:21], v135, s[60:63], s89 offen offset:512 sc0 sc1
 v_mfma_f32_32x32x16_bf16 v[50:65], a[108:111], v[26:29], v[50:65]
 s_waitcnt lgkmcnt(2)
 v_mfma_f32_32x32x16_bf16 v[50:65], a[112:115], v[30:33], v[50:65]
 v_cvt_pk_bf16_f32 v22, v10, v11
 v_cvt_pk_bf16_f32 v23, v12, v13
 v_cvt_pk_bf16_f32 v24, v14, v15
 v_cvt_pk_bf16_f32 v25, v16, v17
 v_mfma_f32_32x32x16_bf16 v[50:65], a[116:119], v[34:37], v[50:65]
 v_permlane32_swap_b32 v22, v24
 v_permlane32_swap_b32 v23, v25
 s_waitcnt lgkmcnt(0)
 v_mfma_f32_32x32x16_bf16 v[50:65], a[120:123], v[74:77], v[50:65]
 v_mfma_f32_32x32x16_bf16 v[50:65], a[124:127], v[78:81], v[50:65]
 buffer_store_dwordx4 v[22:25], v135, s[60:63], s89 offen offset:640 sc0 sc1
 ds_read_b128 v[2:5], v137
 ds_read_b128 v[6:9], v137 offset:256
 ds_read_b128 v[10:13], v137 offset:34816
 ds_read_b128 v[14:17], v137 offset:35072
 s_nop 6
 v_cvt_pk_bf16_f32 v18, v50, v51
 v_cvt_pk_bf16_f32 v19, v52, v53
 v_cvt_pk_bf16_f32 v20, v54, v55
 v_cvt_pk_bf16_f32 v21, v56, v57
 v_cvt_pk_bf16_f32 v22, v58, v59
 v_cvt_pk_bf16_f32 v23, v60, v61
 v_cvt_pk_bf16_f32 v24, v62, v63
 v_cvt_pk_bf16_f32 v25, v64, v65
 v_permlane32_swap_b32 v18, v20
 v_permlane32_swap_b32 v19, v21
 buffer_store_dwordx4 v[18:21], v135, s[60:63], s89 offen offset:768 sc0 sc1
 v_permlane32_swap_b32 v22, v24
 v_permlane32_swap_b32 v23, v25
 buffer_store_dwordx4 v[22:25], v135, s[60:63], s89 offen offset:896 sc0 sc1
 s_add_u32 s14, s80, 0
 s_add_u32 s15, s81, 0
 s_waitcnt vmcnt(4)
 v_cmp_ne_u32 vcc, s7, v87
 s_cbranch_vccnz Lrt_66
Lbk_67:
 buffer_load_dwordx4 v[26:29], v136, s[60:63], s14 offen offset:0 sc0 sc1
 buffer_load_dwordx4 v[30:33], v136, s[60:63], s15 offen offset:0 sc0 sc1
 buffer_load_dwordx4 v[34:37], v136, s[60:63], s14 offen offset:256 sc0 sc1
 buffer_load_dwordx4 v[38:41], v136, s[60:63], s15 offen offset:256 sc0 sc1
 buffer_load_dwordx4 v[42:45], v136, s[60:63], s14 offen offset:512 sc0 sc1
 buffer_load_dwordx4 v[46:49], v136, s[60:63], s15 offen offset:512 sc0 sc1
 buffer_load_dwordx4 v[66:69], v136, s[60:63], s14 offen offset:768 sc0 sc1
 buffer_load_dwordx4 v[70:73], v136, s[60:63], s15 offen offset:768 sc0 sc1
 v_bfe_u32 v18, v1, 1, 2
 v_lshlrev_b32_e64 v18, 10, v18
 v_subrev_u32 v19, 67584, v137
 v_bfe_u32 v20, v1, 1, 2
 v_mul_u32_u24 v20, 2080, v20
 v_sub_u32 v19, v19, v20
 v_lshrrev_b32 v19, 1, v19
 v_add_u32 v18, v18, v19
 s_lshl_b32 s86, s6, 13
 s_add_u32 s87, s86, 4096
 s_lshl_b32 s14, s9, 2
 s_add_u32 s14, s14, s82
 s_waitcnt vmcnt(8)
 buffer_store_dword v143, off, s[60:63], s14 offset:512 sc0 sc1
 s_waitcnt vmcnt(8) lgkmcnt(3)
 v_mfma_f32_16x16x32_bf16 v[2:5], v[88:91], v[26:29], v[2:5]
 s_waitcnt vmcnt(7)
 v_mfma_f32_16x16x32_bf16 v[2:5], v[88:91], v[30:33], v[2:5]
 s_waitcnt vmcnt(6)
 v_mfma_f32_16x16x32_bf16 v[2:5], v[92:95], v[34:37], v[2:5]
 s_waitcnt vmcnt(5)
 v_mfma_f32_16x16x32_bf16 v[2:5], v[92:95], v[38:41], v[2:5]
 s_waitcnt vmcnt(4) lgkmcnt(2)
 v_mfma_f32_16x16x32_bf16 v[6:9], v[88:91], v[42:45], v[6:9]
 s_waitcnt vmcnt(3)
 v_mfma_f32_16x16x32_bf16 v[6:9], v[88:91], v[46:49], v[6:9]
 s_waitcnt vmcnt(2)
 v_mfma_f32_16x16x32_bf16 v[6:9], v[92:95], v[66:69], v[6:9]
 s_waitcnt vmcnt(1)
 v_mfma_f32_16x16x32_bf16 v[6:9], v[92:95], v[70:73], v[6:9]
 buffer_load_dword v87, v142, s[60:63], s82 offen offset:512 sc0 sc1
 s_add_u32 s14, s80, 4096
 s_add_u32 s15, s81, 4096
 s_waitcnt vmcnt(0)
 v_cmp_ne_u32 vcc, s7, v87
 s_cbranch_vccnz Lrt_69
Lbk_70:
 buffer_load_dwordx4 v[34:37], v136, s[60:63], s14 offen offset:0 sc0 sc1
 buffer_load_dwordx4 v[38:41], v136, s[60:63], s15 offen offset:0 sc0 sc1
 buffer_load_dwordx4 v[42:45], v136, s[60:63], s14 offen offset:256 sc0 sc1
 buffer_load_dwordx4 v[46:49], v136, s[60:63], s15 offen offset:256 sc0 sc1
 buffer_load_dwordx4 v[50:53], v136, s[60:63], s14 offen offset:512 sc0 sc1
 buffer_load_dwordx4 v[54:57], v136, s[60:63], s15 offen offset:512 sc0 sc1
 buffer_load_dwordx4 v[58:61], v136, s[60:63], s14 offen offset:768 sc0 sc1
 buffer_load_dwordx4 v[62:65], v136, s[60:63], s15 offen offset:768 sc0 sc1
 v_cvt_pk_bf16_f32 v20, v2, v3
 v_cvt_pk_bf16_f32 v21, v4, v5
 buffer_store_dwordx2 v[20:21], v18, s[72:75], s86 offen offset:0 nt
 v_cvt_pk_bf16_f32 v22, v6, v7
 v_cvt_pk_bf16_f32 v23, v8, v9
 buffer_store_dwordx2 v[22:23], v18, s[72:75], s86 offen offset:128 nt
 s_waitcnt vmcnt(9) lgkmcnt(1)
 v_mfma_f32_16x16x32_bf16 v[10:13], v[88:91], v[34:37], v[10:13]
 s_waitcnt vmcnt(8)
 v_mfma_f32_16x16x32_bf16 v[10:13], v[88:91], v[38:41], v[10:13]
 s_waitcnt vmcnt(7)
 v_mfma_f32_16x16x32_bf16 v[10:13], v[92:95], v[42:45], v[10:13]
 s_waitcnt vmcnt(6)
 v_mfma_f32_16x16x32_bf16 v[10:13], v[92:95], v[46:49], v[10:13]
 s_waitcnt vmcnt(5) lgkmcnt(0)
 v_mfma_f32_16x16x32_bf16 v[14:17], v[88:91], v[50:53], v[14:17]
 s_waitcnt vmcnt(4)
 v_mfma_f32_16x16x32_bf16 v[14:17], v[88:91], v[54:57], v[14:17]
 s_waitcnt vmcnt(3)
 v_mfma_f32_16x16x32_bf16 v[14:17], v[92:95], v[58:61], v[14:17]
 s_waitcnt vmcnt(2)
 v_mfma_f32_16x16x32_bf16 v[14:17], v[92:95], v[62:65], v[14:17]
 v_cvt_pk_bf16_f32 v20, v10, v11
 v_cvt_pk_bf16_f32 v21, v12, v13
 buffer_store_dwordx2 v[20:21], v18, s[72:75], s87 offen offset:0 nt
 s_nop 4
 v_cvt_pk_bf16_f32 v22, v14, v15
 v_cvt_pk_bf16_f32 v23, v16, v17
 buffer_store_dwordx2 v[22:23], v18, s[72:75], s87 offen offset:128 nt
 s_endpgm
 s_nop 0
Lrt_41:
 s_nop 7
 s_nop 7
 s_mov_b32 s85, 0
 s_mov_b32 s83, m0
Llp_43:
 buffer_load_dword v82, v84, s[60:63], s89 offen sc1
 buffer_load_dword v83, v84, s[60:63], s89 offen offset:2048 sc1
 s_waitcnt vmcnt(0)
 v_xor_b32_e64 v82, s7, v82
 v_xor_b32_e64 v83, s7, v83
 v_or_b32_e64 v82, v82, v83
 v_cmp_ne_u32 vcc, 0, v82
 s_mov_b32 m0, s83
 s_nop 2
 s_cbranch_vccz Lbk_42
 s_add_u32 s85, s85, 1
 s_cmp_lt_u32 s85, 262144
 s_cbranch_scc1 Llp_43
 s_branch Lbk_42
Lrt_44:
 s_nop 7
 s_nop 7
 s_mov_b32 s85, 0
 s_mov_b32 s83, m0
Llp_46:
 s_mov_b64 exec, vcc
 buffer_load_dwordx4 v[76:79], v74, s[60:63], s88 offen sc1
 buffer_load_dwordx4 v[80:83], v74, s[60:63], s87 offen sc1
 s_mov_b64 exec, -1
 s_waitcnt vmcnt(0)
 v_max3_u32 v75, v76, v77, v78
 v_max3_u32 v85, v79, v80, v81
 v_max3_u32 v75, v75, v82, v83
 v_max_u32_e64 v75, v75, v85
 v_cmp_eq_u32 vcc, -1, v75
 s_mov_b32 m0, s83
 s_nop 2
 s_cbranch_vccz Lbk_45
 s_add_u32 s85, s85, 1
 s_cmp_lt_u32 s85, 262144
 s_cbranch_scc1 Llp_46
 s_branch Lbk_45
Lrt_47:
 s_nop 7
 s_nop 7
 s_mov_b32 s85, 0
 s_mov_b32 s83, m0
Llp_49:
 s_add_u32 s86, s77, 0
 s_add_u32 s87, s78, 0
 s_add_u32 m0, s101, 0
 s_nop 0
 buffer_load_dwordx4 v138, s[60:63], s86 offen offset:0 sc0 sc1 lds
 s_add_u32 m0, s101, 32
 s_nop 0
 buffer_load_dwordx4 v138, s[60:63], s86 offen offset:1024 sc0 sc1 lds
 s_add_u32 m0, s101, 64
 s_nop 0
 buffer_load_dwordx4 v138, s[60:63], s86 offen offset:2048 sc0 sc1 lds
 s_add_u32 m0, s101, 96
 s_nop 0
 buffer_load_dwordx4 v138, s[60:63], s86 offen offset:3072 sc0 sc1 lds
 s_add_u32 m0, s101, 4224
 s_nop 0
 buffer_load_dwordx4 v138, s[60:63], s87 offen offset:0 sc0 sc1 lds
 s_add_u32 m0, s101, 4256
 s_nop 0
 buffer_load_dwordx4 v138, s[60:63], s87 offen offset:1024 sc0 sc1 lds
 s_add_u32 m0, s101, 4288
 s_nop 0
 buffer_load_dwordx4 v138, s[60:63], s87 offen offset:2048 sc0 sc1 lds
 s_add_u32 m0, s101, 4320
 s_nop 0
 buffer_load_dwordx4 v138, s[60:63], s87 offen offset:3072 sc0 sc1 lds
 s_waitcnt vmcnt(0)
 v_add_u32 v71, s101, v139
 ds_read_b128 v[2:5], v71 offset:0
 ds_read_b128 v[6:9], v71 offset:1056
 ds_read_b128 v[10:13], v71 offset:2112
 ds_read_b128 v[14:17], v71 offset:3168
 ds_read_b128 v[18:21], v71 offset:4224
 ds_read_b128 v[22:25], v71 offset:5280
 ds_read_b128 v[26:29], v71 offset:6336
 ds_read_b128 v[30:33], v71 offset:7392
 s_waitcnt lgkmcnt(0)
 v_max_u32 v70, v2, v3
 v_max3_u32 v70, v70, v4, v5
 v_max3_u32 v70, v70, v6, v7
 v_max3_u32 v70, v70, v8, v9
 v_max3_u32 v70, v70, v10, v11
 v_max3_u32 v70, v70, v12, v13
 v_max3_u32 v70, v70, v14, v15
 v_max3_u32 v70, v70, v16, v17
 v_max3_u32 v70, v70, v18, v19
 v_max3_u32 v70, v70, v20, v21
 v_max3_u32 v70, v70, v22, v23
 v_max3_u32 v70, v70, v24, v25
 v_max3_u32 v70, v70, v26, v27
 v_max3_u32 v70, v70, v28, v29
 v_max3_u32 v70, v70, v30, v31
 v_max3_u32 v70, v70, v32, v33
 v_cmp_eq_u32 vcc, -1, v70
 s_mov_b32 m0, s83
 s_nop 2
 s_cbranch_vccz Lbk_48
 s_add_u32 s85, s85, 1
 s_cmp_lt_u32 s85, 262144
 s_cbranch_scc1 Llp_49
 s_branch Lbk_48
Lrt_51:
 s_nop 7
 s_nop 7
 s_mov_b32 s85, 0
 s_mov_b32 s83, m0
Llp_53:
 s_add_u32 s86, s77, 4096
 s_add_u32 s87, s78, 4096
 s_add_u32 m0, s101, 33792
 s_nop 0
 buffer_load_dwordx4 v138, s[60:63], s86 offen offset:0 sc0 sc1 lds
 s_add_u32 m0, s101, 33824
 s_nop 0
 buffer_load_dwordx4 v138, s[60:63], s86 offen offset:1024 sc0 sc1 lds
 s_add_u32 m0, s101, 33856
 s_nop 0
 buffer_load_dwordx4 v138, s[60:63], s86 offen offset:2048 sc0 sc1 lds
 s_add_u32 m0, s101, 33888
 s_nop 0
 buffer_load_dwordx4 v138, s[60:63], s86 offen offset:3072 sc0 sc1 lds
 s_add_u32 m0, s101, 38016
 s_nop 0
 buffer_load_dwordx4 v138, s[60:63], s87 offen offset:0 sc0 sc1 lds
 s_add_u32 m0, s101, 38048
 s_nop 0
 buffer_load_dwordx4 v138, s[60:63], s87 offen offset:1024 sc0 sc1 lds
 s_add_u32 m0, s101, 38080
 s_nop 0
 buffer_load_dwordx4 v138, s[60:63], s87 offen offset:2048 sc0 sc1 lds
 s_add_u32 m0, s101, 38112
 s_nop 0
 buffer_load_dwordx4 v138, s[60:63], s87 offen offset:3072 sc0 sc1 lds
 s_waitcnt vmcnt(0)
 v_add_u32 v75, s101, v139
 ds_read_b128 v[76:79], v75 offset:33792
 ds_read_b128 v[80:83], v75 offset:34848
 s_waitcnt lgkmcnt(0)
 v_max_u32_e64 v74, v76, v77
 v_max3_u32 v74, v74, v78, v79
 v_max3_u32 v74, v74, v80, v81
 v_max3_u32 v74, v74, v82, v83
 ds_read_b128 v[76:79], v75 offset:35904
 ds_read_b128 v[80:83], v75 offset:36960
 s_waitcnt lgkmcnt(0)
 v_max3_u32 v74, v74, v76, v77
 v_max3_u32 v74, v74, v78, v79
 v_max3_u32 v74, v74, v80, v81
 v_max3_u32 v74, v74, v82, v83
 ds_read_b128 v[76:79], v75 offset:38016
 ds_read_b128 v[80:83], v75 offset:39072
 s_waitcnt lgkmcnt(0)
 v_max3_u32 v74, v74, v76, v77
 v_max3_u32 v74, v74, v78, v79
 v_max3_u32 v74, v74, v80, v81
 v_max3_u32 v74, v74, v82, v83
 ds_read_b128 v[76:79], v75 offset:40128
 ds_read_b128 v[80:83], v75 offset:41184
 s_waitcnt lgkmcnt(0)
 v_max3_u32 v74, v74, v76, v77
 v_max3_u32 v74, v74, v78, v79
 v_max3_u32 v74, v74, v80, v81
 v_max3_u32 v74, v74, v82, v83
 v_cmp_eq_u32 vcc, -1, v74
 s_mov_b32 m0, s83
 s_nop 2
 s_cbranch_vccz Lbk_52
 s_add_u32 s85, s85, 1
 s_cmp_lt_u32 s85, 262144
 s_cbranch_scc1 Llp_53
 s_branch Lbk_52
Lrt_54:
 s_nop 7
 s_nop 7
 s_mov_b32 s85, 0
 s_mov_b32 s83, m0
Llp_56:
 buffer_load_dword v87, v142, s[60:63], s82 offen offset:0 sc0 sc1
 s_waitcnt vmcnt(0)
 v_cmp_ne_u32 vcc, s7, v87
 s_mov_b32 m0, s83
 s_nop 2
 s_cbranch_vccz Lbk_55
 s_add_u32 s85, s85, 1
 s_cmp_lt_u32 s85, 262144
 s_cbranch_scc1 Llp_56
 s_branch Lbk_55
Lrt_57:
 s_nop 7
 s_nop 7
 s_mov_b32 s85, 0
 s_mov_b32 s83, m0
Llp_59:
 buffer_load_dword v87, v142, s[60:63], s82 offen offset:512 sc0 sc1
 s_waitcnt vmcnt(0)
 v_cmp_ne_u32 vcc, s7, v87
 s_mov_b32 m0, s83
 s_nop 2
 s_cbranch_vccz Lbk_58
 s_add_u32 s85, s85, 1
 s_cmp_lt_u32 s85, 262144
 s_cbranch_scc1 Llp_59
 s_branch Lbk_58
Lrt_60:
 s_nop 7
 s_nop 7
 s_mov_b32 s85, 0
 s_mov_b32 s83, m0
Llp_62:
 s_add_u32 s86, s77, 0
 s_add_u32 s87, s78, 0
 s_add_u32 m0, s101, 0
 s_nop 0
 buffer_load_dwordx4 v138, s[60:63], s86 offen offset:0 sc0 sc1 lds
 s_add_u32 m0, s101, 32
 s_nop 0
 buffer_load_dwordx4 v138, s[60:63], s86 offen offset:1024 sc0 sc1 lds
 s_add_u32 m0, s101, 64
 s_nop 0
 buffer_load_dwordx4 v138, s[60:63], s86 offen offset:2048 sc0 sc1 lds
 s_add_u32 m0, s101, 96
 s_nop 0
 buffer_load_dwordx4 v138, s[60:63], s86 offen offset:3072 sc0 sc1 lds
 s_add_u32 m0, s101, 4224
 s_nop 0
 buffer_load_dwordx4 v138, s[60:63], s87 offen offset:0 sc0 sc1 lds
 s_add_u32 m0, s101, 4256
 s_nop 0
 buffer_load_dwordx4 v138, s[60:63], s87 offen offset:1024 sc0 sc1 lds
 s_add_u32 m0, s101, 4288
 s_nop 0
 buffer_load_dwordx4 v138, s[60:63], s87 offen offset:2048 sc0 sc1 lds
 s_add_u32 m0, s101, 4320
 s_nop 0
 buffer_load_dwordx4 v138, s[60:63], s87 offen offset:3072 sc0 sc1 lds
 s_waitcnt vmcnt(0)
 v_add_u32_e64 v37, s101, v139
 ds_read_b128 v[38:41], v37 offset:0
 ds_read_b128 v[42:45], v37 offset:1056
 ds_read_b128 v[46:49], v37 offset:2112
 ds_read_b128 v[50:53], v37 offset:3168
 ds_read_b128 v[54:57], v37 offset:4224
 ds_read_b128 v[58:61], v37 offset:5280
 ds_read_b128 v[62:65], v37 offset:6336
 ds_read_b128 v[66:69], v37 offset:7392
 s_waitcnt lgkmcnt(0)
 v_max_u32 v36, v38, v39
 v_max3_u32 v36, v36, v40, v41
 v_max3_u32 v36, v36, v42, v43
 v_max3_u32 v36, v36, v44, v45
 v_max3_u32 v36, v36, v46, v47
 v_max3_u32 v36, v36, v48, v49
 v_max3_u32 v36, v36, v50, v51
 v_max3_u32 v36, v36, v52, v53
 v_max3_u32 v36, v36, v54, v55
 v_max3_u32 v36, v36, v56, v57
 v_max3_u32 v36, v36, v58, v59
 v_max3_u32 v36, v36, v60, v61
 v_max3_u32 v36, v36, v62, v63
 v_max3_u32 v36, v36, v64, v65
 v_max3_u32 v36, v36, v66, v67
 v_max3_u32 v36, v36, v68, v69
 v_cmp_eq_u32 vcc, -1, v36
 s_mov_b32 m0, s83
 s_nop 2
 s_cbranch_vccz Lbk_61
 s_add_u32 s85, s85, 1
 s_cmp_lt_u32 s85, 262144
 s_cbranch_scc1 Llp_62
 s_branch Lbk_61
Lrt_63:
 s_nop 7
 s_nop 7
 s_mov_b32 s85, 0
 s_mov_b32 s83, m0
Llp_65:
 s_add_u32 s86, s77, 4096
 s_add_u32 s87, s78, 4096
 s_add_u32 m0, s101, 33792
 s_nop 0
 buffer_load_dwordx4 v138, s[60:63], s86 offen offset:0 sc0 sc1 lds
 s_add_u32 m0, s101, 33824
 s_nop 0
 buffer_load_dwordx4 v138, s[60:63], s86 offen offset:1024 sc0 sc1 lds
 s_add_u32 m0, s101, 33856
 s_nop 0
 buffer_load_dwordx4 v138, s[60:63], s86 offen offset:2048 sc0 sc1 lds
 s_add_u32 m0, s101, 33888
 s_nop 0
 buffer_load_dwordx4 v138, s[60:63], s86 offen offset:3072 sc0 sc1 lds
 s_add_u32 m0, s101, 38016
 s_nop 0
 buffer_load_dwordx4 v138, s[60:63], s87 offen offset:0 sc0 sc1 lds
 s_add_u32 m0, s101, 38048
 s_nop 0
 buffer_load_dwordx4 v138, s[60:63], s87 offen offset:1024 sc0 sc1 lds
 s_add_u32 m0, s101, 38080
 s_nop 0
 buffer_load_dwordx4 v138, s[60:63], s87 offen offset:2048 sc0 sc1 lds
 s_add_u32 m0, s101, 38112
 s_nop 0
 buffer_load_dwordx4 v138, s[60:63], s87 offen offset:3072 sc0 sc1 lds
 s_waitcnt vmcnt(0)
 v_add_u32_e64 v75, s101, v139
 ds_read_b128 v[76:79], v75 offset:33792
 ds_read_b128 v[80:83], v75 offset:34848
 s_waitcnt lgkmcnt(0)
 v_max_u32 v74, v76, v77
 v_max3_u32 v74, v74, v78, v79
 v_max3_u32 v74, v74, v80, v81
 v_max3_u32 v74, v74, v82, v83
 ds_read_b128 v[76:79], v75 offset:35904
 ds_read_b128 v[80:83], v75 offset:36960
 s_waitcnt lgkmcnt(0)
 v_max3_u32 v74, v74, v76, v77
 v_max3_u32 v74, v74, v78, v79
 v_max3_u32 v74, v74, v80, v81
 v_max3_u32 v74, v74, v82, v83
 ds_read_b128 v[76:79], v75 offset:38016
 ds_read_b128 v[80:83], v75 offset:39072
 s_waitcnt lgkmcnt(0)
 v_max3_u32 v74, v74, v76, v77
 v_max3_u32 v74, v74, v78, v79
 v_max3_u32 v74, v74, v80, v81
 v_max3_u32 v74, v74, v82, v83
 ds_read_b128 v[76:79], v75 offset:40128
 ds_read_b128 v[80:83], v75 offset:41184
 s_waitcnt lgkmcnt(0)
 v_max3_u32 v74, v74, v76, v77
 v_max3_u32 v74, v74, v78, v79
 v_max3_u32 v74, v74, v80, v81
 v_max3_u32 v74, v74, v82, v83
 v_cmp_eq_u32 vcc, -1, v74
 s_mov_b32 m0, s83
 s_nop 2
 s_cbranch_vccz Lbk_64
 s_add_u32 s85, s85, 1
 s_cmp_lt_u32 s85, 262144
 s_cbranch_scc1 Llp_65
 s_branch Lbk_64
Lrt_66:
 s_nop 7
 s_nop 7
 s_mov_b32 s85, 0
 s_mov_b32 s83, m0
Llp_68:
 buffer_load_dword v87, v142, s[60:63], s82 offen offset:0 sc0 sc1
 s_waitcnt vmcnt(0)
 v_cmp_ne_u32 vcc, s7, v87
 s_mov_b32 m0, s83
 s_nop 2
 s_cbranch_vccz Lbk_67
 s_add_u32 s85, s85, 1
 s_cmp_lt_u32 s85, 262144
 s_cbranch_scc1 Llp_68
 s_branch Lbk_67
Lrt_69:
 s_nop 7
 s_nop 7
 s_mov_b32 s85, 0
 s_mov_b32 s83, m0
Llp_71:
 buffer_load_dword v87, v142, s[60:63], s82 offen offset:512 sc0 sc1
 s_waitcnt vmcnt(0)
 v_cmp_ne_u32 vcc, s7, v87
 s_mov_b32 m0, s83
 s_nop 2
 s_cbranch_vccz Lbk_70
 s_add_u32 s85, s85, 1
 s_cmp_lt_u32 s85, 262144
 s_cbranch_scc1 Llp_71
 s_branch Lbk_70
Lend:
 s_endpgm
.section .rodata,"a"
.p2align 6
.amdhsa_kernel interleave_layers__ssm_conv_h3__dense_activation_gelu__prompt_kernel
  .amdhsa_next_free_vgpr 512
  .amdhsa_next_free_sgpr 102
  .amdhsa_accum_offset 256
  .amdhsa_group_segment_fixed_size 0
  .amdhsa_kernarg_size 112
  .amdhsa_user_sgpr_count 2
  .amdhsa_user_sgpr_kernarg_segment_ptr 1
  .amdhsa_system_sgpr_workgroup_id_x 1
  .amdhsa_float_denorm_mode_32 3
.end_amdhsa_kernel
```
